```python
import torch

def _softmax(x, axis=-1):
    return torch.softmax(x, dim=axis)
def _gelu(x):
    return torch.nn.functional.gelu(x, approximate="tanh")
def _silu(x):
    return torch.nn.functional.silu(x)
def _sigmoid(x):
    return torch.sigmoid(x)
def _layernorm(x, axis=-1, eps=1e-5):
    m = x.mean(dim=axis, keepdim=True)
    v = x.var(dim=axis, keepdim=True, unbiased=False)
    return (x - m) / torch.sqrt(v + eps)
def _scatter_add(tgt, idx, src, axis=0):
    return tgt.clone().index_add_(axis, idx, src)
def _segment_sum(src, seg, n):
    out = torch.zeros((n,) + src.shape[1:], dtype=src.dtype)
    return out.index_add_(0, seg, src)
def _pad(x, pw):
    flat = tuple(v for pair in reversed(pw) for v in pair)
    return torch.nn.functional.pad(x, flat)

kernel_name = 'gated_mix__ssm_conv_s4__glu_gated_bilinear__prompt'

def setup_inputs():

    _w = (lambda a: (lambda t: t.to(torch.bfloat16) if t.is_floating_point() else t)(torch.as_tensor(a)))
    def _A_setup():
        B, L, D, N = 1, 2048, 576, 128
        A_re = -(lambda _x: torch.exp(torch.as_tensor(_x)))((lambda *s: torch.randn(*s, dtype=torch.bfloat16) * 3.2)(D, N))
        A_im = torch.pi * (lambda *s: torch.randn(*s, dtype=torch.bfloat16) * 0.05)(D, N)
        B_re = (lambda *s: torch.randn(*s, dtype=torch.bfloat16) * 0.1)(D, N)
        B_im = (lambda *s: torch.randn(*s, dtype=torch.bfloat16) * 0.1)(D, N)
        C_re = (lambda *s: torch.randn(*s, dtype=torch.bfloat16) * 0.1)(D, N)
        C_im = (lambda *s: torch.randn(*s, dtype=torch.bfloat16) * 0.1)(D, N)
        log_dt = (lambda *s: torch.randn(*s, dtype=torch.bfloat16) * 0.05)(D) * 0.5 - 4.0
        Dskip = (lambda *s: torch.randn(*s, dtype=torch.bfloat16) * 0.05)(D)
        return {
            "u": _w((lambda *s: torch.randn(*s, dtype=torch.bfloat16) * 0.05)(B, L, D)),
            "A_re": _w(A_re),
            "A_im": _w(A_im),
            "B_re": _w(B_re),
            "B_im": _w(B_im),
            "C_re": _w(C_re),
            "C_im": _w(C_im),
            "log_dt": _w(log_dt),
            "Dskip": _w(Dskip),
        }
    _A_in = _A_setup()

    def _B_setup():
        B, S, D, F = 1, 2048, 576, 4608
        return {
            "x": _w((lambda *s: torch.randn(*s, dtype=torch.bfloat16) * 0.05)(B, S, D)),
            "w_gate": _w((lambda *s: torch.randn(*s, dtype=torch.bfloat16) * 0.8)(D, F) * (D ** -0.5)),
            "w_up": _w((lambda *s: torch.randn(*s, dtype=torch.bfloat16) * 0.8)(D, F) * (D ** -0.5)),
            "w_down": _w((lambda *s: torch.randn(*s, dtype=torch.bfloat16) * 0.8)(F, D) * (F ** -0.5)),
        }
    _B_in = _B_setup()

    return {
        "A_u": _A_in["u"],
        "A_A_re": _A_in["A_re"],
        "A_A_im": _A_in["A_im"],
        "A_B_re": _A_in["B_re"],
        "A_B_im": _A_in["B_im"],
        "A_C_re": _A_in["C_re"],
        "A_C_im": _A_in["C_im"],
        "A_log_dt": _A_in["log_dt"],
        "A_Dskip": _A_in["Dskip"],
        "B_x": _B_in["x"],
        "B_w_gate": _B_in["w_gate"],
        "B_w_up": _B_in["w_up"],
        "B_w_down": _B_in["w_down"],
        "gate_w": _w((lambda *s: torch.randn(*s, dtype=torch.bfloat16) * 0.05)(576) * 16.0),
    }

def reference(A_u, A_A_re, A_A_im, A_B_re, A_B_im, A_C_re, A_C_im, A_log_dt, A_Dskip, B_x, B_w_gate, B_w_up, B_w_down, gate_w):
    def _A_ref(u, A_re, A_im, B_re, B_im, C_re, C_im, log_dt, Dskip):
        Bsz, L, D = u.shape
        dt = torch.exp(log_dt)[:, None]
        A = A_re + 1j * A_im
        Bc = B_re + 1j * B_im
        Cc = C_re + 1j * C_im
        logdA = dt * A
        dB = dt * Bc
        l = (lambda x, dt: x.to(dt))(torch.arange(L), A_re.dtype)
        P = torch.exp(logdA[:, :, None] * l[None, None, :])
        K = torch.einsum("dn,dnl,dn->dl", Cc, P, dB).real
        L2 = 2 * L
        Kp = _pad(K, ((0, 0), (0, L)))
        up = (lambda x, *d: x.permute(*d))(u, 0, 2, 1)
        up = _pad(up, ((0, 0), (0, 0), (0, L)))
        Kf = (lambda x, axes=(-2,-1): torch.fft.rfft2(x.float(), dim=axes))(Kp[:, None, :], axes=(-2, -1))
        Uf = (lambda x, axes=(-2,-1): torch.fft.rfft2(x.float(), dim=axes))(up[:, :, None, :], axes=(-2, -1))
        Yf = Uf * Kf[None, :, :, :]
        y = (lambda x, s, axes=(-2,-1): torch.fft.irfft2(x, s=s, dim=axes).to(torch.bfloat16))(Yf, (1, L2), axes=(-2, -1))[:, :, 0, :L]
        y = (lambda x, *d: x.permute(*d))(y, 0, 2, 1) + u * Dskip[None, None, :]
        return y

    def _B_ref(x, w_gate, w_up, w_down):
        g = torch.einsum("bsd,df->bsf", x, w_gate)
        u = torch.einsum("bsd,df->bsf", x, w_up)
        h = g * u
        return torch.einsum("bsf,fd->bsd", h, w_down)

    x = A_u
    g = _sigmoid((x * gate_w).sum(-1, keepdims=True))
    a = _A_ref(x, A_A_re, A_A_im, A_B_re, A_B_im, A_C_re, A_C_im, A_log_dt, A_Dskip)
    b = _B_ref(x, B_w_gate, B_w_up, B_w_down)
    return g * a + (1 - g) * b
```

```asm
; @launch kernel=kf_kernel grid=(256,1,1) block=(256,1,1) lds=163840
.amdgcn_target "amdgcn-amd-amdhsa--gfx950"
.text
.globl kf_kernel
.p2align 12
.type kf_kernel,@function
kf_kernel:
    s_cmp_ge_u32 s2, 256
    s_cbranch_scc1 kf_kernel_end
    s_load_dwordx16 s[64:79], s[0:1], 0
    s_load_dwordx8 s[84:91], s[0:1], 80
    s_load_dwordx2 s[6:7], s[0:1], 128
    s_load_dwordx2 s[80:81], s[0:1], 64
    s_load_dwordx4 s[92:95], s[0:1], 112
    s_getpc_b64 s[96:97]
    cp_1:
    s_sub_u32 s96, s96, cp_1-kf_kernel
    s_subb_u32 s97, s97, 0
    s_mov_b32 s98, cp_end-kf_kernel
    s_mov_b32 s99, 0x20000
    s_bfe_u32 s3, s2, 0x40003
    s_lshl_b32 s3, s3, 12
    v_and_b32 v2, 7, v0
    v_lshrrev_b32 v3, 6, v0
    v_lshl_add_u32 v2, v3, 3, v2
    v_lshlrev_b32 v2, 7, v2
    buffer_load_dword v63, v2, s[96:99], s3 offen
    v_lshrrev_b32 v1, 6, v0
    v_and_b32 v0, 63, v0
    s_nop 0
    v_readfirstlane_b32 s20, v1
    s_bfe_u32 s21, s2, 0x20001
    s_lshl_b32 s21, s21, 3
    s_bfe_u32 s29, s2, 0x30003
    s_add_u32 s21, s21, s29
    s_and_b32 s22, s2, 1
    s_lshl_b32 s22, s22, 2
    s_lshr_b32 s29, s2, 6
    s_add_u32 s22, s22, s29
    s_and_b32 s62, s20, 1
    s_lshr_b32 s29, s20, 1
    s_lshl_b32 s28, s2, 1
    s_add_u32 s28, s28, s29
    s_lshr_b32 s63, s2, 2
    s_add_u32 s63, s63, 512
    s_lshl_b32 s30, s28, 8
    s_lshl_b32 s31, s62, 7
    s_add_u32 s30, s30, s31
    v_lshlrev_b32 v2, 1, v0
    v_add_u32 v60, s30, v2
    s_lshl_b32 s30, s63, 8
    s_lshl_b32 s31, s20, 6
    s_add_u32 s30, s30, s31
    v_and_b32 v2, 62, v2
    v_add_u32 v61, s30, v2
    s_lshl_b32 s48, s28, 1
    s_and_b32 s48, s48, -4
    s_lshl_b32 s49, s63, 1
    s_and_b32 s49, s49, -4
    s_lshr_b32 s4, s21, 2
    s_cmp_lt_u32 s21, 4
    s_cselect_b32 s4, 8, s4
    s_and_b32 s29, s22, 3
    s_mul_i32 s29, s29, 3
    s_add_u32 s4, s4, s29
    s_sub_u32 s29, s4, 9
    s_min_u32 s4, s4, s29
    s_lshl_b32 s54, s4, 18
    s_mul_i32 s25, s4, 589824
    s_lshl_b32 s4, s4, 7
    s_lshl_b32 s29, s22, 8
    s_lshl_b32 s30, s20, 6
    s_add_u32 s29, s29, s30
    s_mul_i32 s29, s29, 1152
    v_lshrrev_b32 v2, 3, v0
    s_movk_i32 s37, 1152
    v_mul_u32_u24 v3, s37, v2
    v_add_u32 v3, s29, v3
    v_lshrrev_b32 v4, 4, v0
    v_and_b32 v5, 7, v0
    v_xor_b32 v5, v5, v4
    v_xor_b32 v6, 4, v5
    v_lshl_add_u32 v5, v5, 4, v3
    v_lshl_add_u32 v6, v6, 4, v3
    v_add_u32 v17, 0, v5
    v_add_u32 v18, 8192, v6
    v_add_u32 v19, 16384, v5
    v_add_u32 v20, 24576, v6
    v_add_u32 v21, 36864, v5
    v_add_u32 v22, 45056, v6
    v_add_u32 v23, 53248, v5
    v_add_u32 v24, 61440, v6
    s_mul_i32 s24, s20, 12288
    s_add_u32 s24, s24, 110592
    s_mul_i32 s29, s62, 576
    s_mul_i32 s23, s20, 9216
    s_and_b32 s31, s21, 1
    s_lshl_b32 s31, s31, 1
    s_mul_i32 s36, s21, 288
    s_movk_i32 s37, 3641
    s_movk_i32 s38, 9216
    s_add_u32 s39, s29, 0
    v_add_u32 v2, s39, v0
    v_mul_u32_u24 v3, s37, v2
    v_lshrrev_b32 v3, 16, v3
    v_mul_u32_u24 v4, 18, v3
    v_sub_u32 v4, v2, v4
    v_add_u32 v4, s31, v4
    v_subrev_u32 v5, 18, v4
    v_min_u32 v4, v4, v5
    v_lshrrev_b32 v5, 1, v3
    v_xor_b32 v5, v5, v3
    v_bfe_u32 v5, v5, 2, 1
    v_mul_u32_u24 v5, 12, v5
    v_xor_b32 v5, v5, v3
    v_mul_u32_u24 v5, s38, v5
    v_lshl_add_u32 v5, v4, 4, v5
    s_sub_u32 s39, s36, 0
    v_add_u32 v8, s39, v5
    s_add_u32 s39, s29, 64
    v_add_u32 v2, s39, v0
    v_mul_u32_u24 v3, s37, v2
    v_lshrrev_b32 v3, 16, v3
    v_mul_u32_u24 v4, 18, v3
    v_sub_u32 v4, v2, v4
    v_add_u32 v4, s31, v4
    v_subrev_u32 v5, 18, v4
    v_min_u32 v4, v4, v5
    v_lshrrev_b32 v5, 1, v3
    v_xor_b32 v5, v5, v3
    v_bfe_u32 v5, v5, 2, 1
    v_mul_u32_u24 v5, 12, v5
    v_xor_b32 v5, v5, v3
    v_mul_u32_u24 v5, s38, v5
    v_lshl_add_u32 v5, v4, 4, v5
    s_sub_u32 s39, s36, 1024
    v_add_u32 v9, s39, v5
    v_lshlrev_b32 v1, 4, v0
    s_waitcnt lgkmcnt(0)
    global_load_ushort v242, v60, s[70:71]
    global_load_ushort v243, v60, s[72:73]
    global_load_ushort v244, v60, s[74:75]
    global_load_ushort v245, v60, s[76:77]
    global_load_ushort v240, v60, s[66:67]
    global_load_ushort v241, v60, s[68:69]
    s_mov_b32 s8, s64
    s_mov_b32 s9, s65
    s_mov_b32 s10, 0x240000
    s_mov_b32 s11, 0x20000
    s_cmp_ge_u32 s20, 2
    s_cselect_b32 s84, s86, s84
    s_cselect_b32 s85, s87, s85
    s_mov_b32 s12, s84
    s_mov_b32 s13, s85
    s_mov_b32 s14, 0x510000
    s_mov_b32 s15, 0x20000
    global_load_ushort v250, v61, s[70:71]
    global_load_ushort v251, v61, s[72:73]
    global_load_ushort v252, v61, s[74:75]
    global_load_ushort v253, v61, s[76:77]
    global_load_ushort v248, v61, s[66:67]
    global_load_ushort v249, v61, s[68:69]
    s_load_dword s96, s[80:81], s48
    s_load_dword s97, s[80:81], s49
    s_load_dword s48, s[78:79], s48
    s_load_dword s49, s[78:79], s49
    s_add_u32 m0, s23, 0
    s_nop 0
    buffer_load_dwordx4 v8, s[12:15], s25 offen offset:0 lds
    buffer_load_dwordx4 v9, s[12:15], s25 offen offset:1024 lds
    s_add_u32 s39, s29, 128
    v_add_u32 v2, s39, v0
    v_mul_u32_u24 v3, s37, v2
    v_lshrrev_b32 v3, 16, v3
    v_mul_u32_u24 v4, 18, v3
    v_sub_u32 v4, v2, v4
    v_add_u32 v4, s31, v4
    v_subrev_u32 v5, 18, v4
    v_min_u32 v4, v4, v5
    v_lshrrev_b32 v5, 1, v3
    v_xor_b32 v5, v5, v3
    v_bfe_u32 v5, v5, 2, 1
    v_mul_u32_u24 v5, 12, v5
    v_xor_b32 v5, v5, v3
    v_mul_u32_u24 v5, s38, v5
    v_lshl_add_u32 v5, v4, 4, v5
    s_sub_u32 s39, s36, 2048
    v_add_u32 v10, s39, v5
    buffer_load_dwordx4 v10, s[12:15], s25 offen offset:2048 lds
    s_add_u32 s39, s29, 192
    v_add_u32 v2, s39, v0
    v_mul_u32_u24 v3, s37, v2
    v_lshrrev_b32 v3, 16, v3
    v_mul_u32_u24 v4, 18, v3
    v_sub_u32 v4, v2, v4
    v_add_u32 v4, s31, v4
    v_subrev_u32 v5, 18, v4
    v_min_u32 v4, v4, v5
    v_lshrrev_b32 v5, 1, v3
    v_xor_b32 v5, v5, v3
    v_bfe_u32 v5, v5, 2, 1
    v_mul_u32_u24 v5, 12, v5
    v_xor_b32 v5, v5, v3
    v_mul_u32_u24 v5, s38, v5
    v_lshl_add_u32 v5, v4, 4, v5
    s_sub_u32 s39, s36, 3072
    v_add_u32 v11, s39, v5
    buffer_load_dwordx4 v11, s[12:15], s25 offen offset:3072 lds
    s_add_u32 m0, s24, 0
    s_nop 0
    buffer_load_dwordx4 v17, s[8:11], s4 offen offset:0 lds
    buffer_load_dwordx4 v18, s[8:11], s4 offen offset:1024 lds
    buffer_load_dwordx4 v19, s[8:11], s4 offen offset:2048 lds
    buffer_load_dwordx4 v20, s[8:11], s4 offen offset:3072 lds
    s_add_u32 m0, s23, 4096
    s_add_u32 s39, s29, 256
    v_add_u32 v2, s39, v0
    v_mul_u32_u24 v3, s37, v2
    v_lshrrev_b32 v3, 16, v3
    v_mul_u32_u24 v4, 18, v3
    v_sub_u32 v4, v2, v4
    v_add_u32 v4, s31, v4
    v_subrev_u32 v5, 18, v4
    v_min_u32 v4, v4, v5
    v_lshrrev_b32 v5, 1, v3
    v_xor_b32 v5, v5, v3
    v_bfe_u32 v5, v5, 2, 1
    v_mul_u32_u24 v5, 12, v5
    v_xor_b32 v5, v5, v3
    v_mul_u32_u24 v5, s38, v5
    v_lshl_add_u32 v5, v4, 4, v5
    s_sub_u32 s39, s36, 0
    v_add_u32 v12, s39, v5
    buffer_load_dwordx4 v12, s[12:15], s25 offen offset:0 lds
    s_add_u32 s39, s29, 320
    v_add_u32 v2, s39, v0
    v_mul_u32_u24 v3, s37, v2
    v_lshrrev_b32 v3, 16, v3
    v_mul_u32_u24 v4, 18, v3
    v_sub_u32 v4, v2, v4
    v_add_u32 v4, s31, v4
    v_subrev_u32 v5, 18, v4
    v_min_u32 v4, v4, v5
    v_lshrrev_b32 v5, 1, v3
    v_xor_b32 v5, v5, v3
    v_bfe_u32 v5, v5, 2, 1
    v_mul_u32_u24 v5, 12, v5
    v_xor_b32 v5, v5, v3
    v_mul_u32_u24 v5, s38, v5
    v_lshl_add_u32 v5, v4, 4, v5
    s_sub_u32 s39, s36, 1024
    v_add_u32 v13, s39, v5
    s_add_u32 s39, s29, 384
    v_add_u32 v2, s39, v0
    v_mul_u32_u24 v3, s37, v2
    v_lshrrev_b32 v3, 16, v3
    v_mul_u32_u24 v4, 18, v3
    v_sub_u32 v4, v2, v4
    v_add_u32 v4, s31, v4
    v_subrev_u32 v5, 18, v4
    v_min_u32 v4, v4, v5
    v_lshrrev_b32 v5, 1, v3
    v_xor_b32 v5, v5, v3
    v_bfe_u32 v5, v5, 2, 1
    v_mul_u32_u24 v5, 12, v5
    v_xor_b32 v5, v5, v3
    v_mul_u32_u24 v5, s38, v5
    v_lshl_add_u32 v5, v4, 4, v5
    s_sub_u32 s39, s36, 2048
    v_add_u32 v14, s39, v5
    s_add_u32 s39, s29, 448
    v_add_u32 v2, s39, v0
    v_mul_u32_u24 v3, s37, v2
    v_lshrrev_b32 v3, 16, v3
    v_mul_u32_u24 v4, 18, v3
    v_sub_u32 v4, v2, v4
    v_add_u32 v4, s31, v4
    v_subrev_u32 v5, 18, v4
    v_min_u32 v4, v4, v5
    v_lshrrev_b32 v5, 1, v3
    v_xor_b32 v5, v5, v3
    v_bfe_u32 v5, v5, 2, 1
    v_mul_u32_u24 v5, 12, v5
    v_xor_b32 v5, v5, v3
    v_mul_u32_u24 v5, s38, v5
    v_lshl_add_u32 v5, v4, 4, v5
    s_sub_u32 s39, s36, 3072
    v_add_u32 v15, s39, v5
    s_add_u32 s39, s29, 512
    v_add_u32 v2, s39, v0
    v_mul_u32_u24 v3, s37, v2
    v_lshrrev_b32 v3, 16, v3
    v_mul_u32_u24 v4, 18, v3
    v_sub_u32 v4, v2, v4
    v_add_u32 v4, s31, v4
    v_subrev_u32 v5, 18, v4
    v_min_u32 v4, v4, v5
    v_lshrrev_b32 v5, 1, v3
    v_xor_b32 v5, v5, v3
    v_bfe_u32 v5, v5, 2, 1
    v_mul_u32_u24 v5, 12, v5
    v_xor_b32 v5, v5, v3
    v_mul_u32_u24 v5, s38, v5
    v_lshl_add_u32 v5, v4, 4, v5
    s_sub_u32 s39, s36, 0
    v_add_u32 v16, s39, v5
    s_add_u32 s32, s6, 0x1800000
    s_addc_u32 s33, s7, 0
    s_mov_b32 s34, 0x6e0000
    s_mov_b32 s35, 0x20000
    s_mov_b32 s44, s94
    s_mov_b32 s45, s95
    s_mov_b32 s46, 0x100
    s_mov_b32 s47, 0x20000
    v_bfe_u32 v2, v0, 2, 3
    v_lshrrev_b32 v3, 5, v0
    v_lshl_add_u32 v2, v3, 4, v2
    s_movk_i32 s37, 288
    v_mul_u32_u24 v2, s37, v2
    v_and_b32 v3, 3, v0
    v_lshl_add_u32 v25, v3, 3, v2
    v_add_u32 v26, 36864, v25
    v_add_u32 v27, 73728, v25
    v_and_b32 v2, 15, v0
    v_lshrrev_b32 v3, 4, v0
    v_lshrrev_b32 v4, 1, v2
    v_xor_b32 v4, v3, v4
    v_lshlrev_b32 v5, 7, v2
    v_lshl_add_u32 v5, v4, 4, v5
    v_add_u32 v28, s24, v5
    v_xor_b32 v29, 64, v28
    s_add_u32 s60, s23, 73728
    s_movk_i32 s37, 272
    v_mul_u32_u24 v4, s37, v2
    v_lshl_add_u32 v4, v3, 4, v4
    v_add_u32 v56, s60, v4
    s_add_u32 s37, s24, 8192
    v_lshl_add_u32 v52, v0, 2, s37
    v_cmp_gt_u32 vcc, 15, v2
    v_add_u32 v5, s37, v4
    v_add_u32 v6, 4624, v56
    v_cndmask_b32 v54, v6, v5, vcc
    v_cmp_gt_u32 vcc, 8, v2
    v_mov_b32 v5, 2176
    v_mov_b32 v6, 4480
    v_cndmask_b32 v5, v5, v6, vcc
    v_add_u32 v57, v56, v5
    s_movk_i32 s37, 144
    v_mul_u32_u24 v5, s37, v2
    v_lshlrev_b32 v6, 4, v3
    v_sub_u32 v5, v6, v5
    s_add_u32 s37, s60, 7952
    v_add_u32 v5, s37, v5
    v_cmp_gt_u32 vcc, 10, v2
    v_subrev_u32 v6, 2320, v56
    s_nop 0
    v_cndmask_b32 v58, v6, v5, vcc
    v_add_u32 v59, s60, v1
    s_lshr_b32 s29, s20, 1
    s_mul_i32 s37, s29, 18432
    s_add_u32 s37, s37, 75776
    v_add_u32 v33, s37, v1
    s_lshl_b32 s38, s62, 10
    s_add_u32 s37, s37, s38
    s_sub_u32 s37, s37, 2048
    v_add_u32 v32, s37, v1
    s_min_u32 s38, s20, 2
    s_lshl_b32 s37, s38, 10
    s_add_u32 s37, s37, 76800
    v_add_u32 v34, s37, v1
    s_mul_i32 s53, s29, 1320
    s_add_u32 s53, s53, 159744
    s_mul_i32 s51, s29, 16640
    s_mul_i32 s52, s29, 4608
    s_add_u32 s52, s52, 147456
    v_lshrrev_b32 v4, 1, v3
    v_lshlrev_b32 v4, 8, v4
    v_lshl_add_u32 v4, v2, 4, v4
    v_and_b32 v5, 1, v3
    v_lshl_add_u32 v4, v5, 3, v4
    v_add_u32 v4, 8, v4
    v_lshlrev_b32 v5, 5, v2
    v_lshl_add_u32 v5, v3, 3, v5
    v_add_u32 v6, 1032, v5
    v_add_u32 v5, 520, v5
    s_cmp_eq_u32 s62, 1
    s_cselect_b64 s[36:37], -1, 0
    v_cndmask_b32 v35, v4, v5, s[36:37]
    v_add_u32 v35, s53, v35
    s_cmp_eq_u32 s20, 1
    s_cselect_b64 s[36:37], -1, 0
    v_cndmask_b32 v37, v4, v5, s[36:37]
    v_add_u32 v37, 162384, v37
    v_cmp_gt_u32 vcc, 9, v2
    v_mov_b32 v4, 163704
    v_add_u32 v5, s53, v6
    v_cndmask_b32 v36, v4, v5, vcc
    v_add_u32 v5, 162384, v6
    v_cndmask_b32 v5, v4, v5, vcc
    s_cmp_ge_u32 s20, 2
    s_cselect_b64 s[36:37], -1, 0
    v_cndmask_b32 v37, v37, v5, s[36:37]
    v_min_u32 v4, 2, v0
    s_movk_i32 s37, 1320
    v_mul_u32_u24 v4, s37, v4
    v_add_u32 v4, 159744, v4
    v_mov_b32 v38, 0
    v_mov_b32 v39, 0
    ds_write_b64 v4, v[38:39]
    v_bfe_u32 v2, v0, 4, 1
    v_bfe_u32 v3, v0, 1, 1
    v_lshl_add_u32 v2, v2, 1, v3
    v_bfe_u32 v3, v0, 2, 2
    v_lshl_add_u32 v3, v2, 3, v3
    s_and_b32 s36, s21, 3
    s_lshl_b32 s36, s36, 1
    v_lshrrev_b32 v4, 5, v0
    v_add_u32 v4, s36, v4
    v_lshrrev_b32 v5, 1, v3
    v_and_b32 v5, 7, v5
    v_xor_b32 v4, v4, v5
    v_lshlrev_b32 v3, 7, v3
    v_lshl_add_u32 v3, v4, 4, v3
    v_and_b32 v4, 1, v0
    v_lshl_add_u32 v3, v4, 3, v3
    v_add_u32 v4, 512, v3
    v_xor_b32 v4, 32, v4
    v_add_u32 v41, s24, v3
    v_add_u32 v42, s24, v4
    v_and_b32 v3, 7, v0
    v_lshlrev_b32 v3, 12, v3
    v_lshrrev_b32 v4, 3, v0
    v_lshl_add_u32 v43, v4, 4, v3
    s_lshl_b32 s29, s22, 9
    s_lshl_b32 s30, s20, 7
    s_add_u32 s29, s29, s30
    s_and_b32 s30, s21, 3
    s_lshl_b32 s30, s30, 16
    s_add_u32 s29, s29, s30
    s_add_u32 s55, s54, 262144
    s_cmp_eq_u32 s55, 2359296
    s_cselect_b32 s55, 0, s55
    s_add_u32 s54, s54, s29
    s_add_u32 s55, s55, s29
    s_mov_b32 s36, s90
    s_mov_b32 s37, s91
    s_mov_b32 s38, 0x480
    s_mov_b32 s39, 0x20000
    s_mov_b32 s40, s88
    s_mov_b32 s41, s89
    s_mov_b32 s42, 0x510000
    s_mov_b32 s43, 0x20000
    s_mov_b32 s16, s6
    s_mov_b32 s17, s7
    s_mov_b32 s18, 0x1290000
    s_mov_b32 s19, 0x20000
    s_or_b32 s29, s2, s20
    s_cmp_lg_u32 s29, 0
    s_cbranch_scc1 nz_2
    s_memrealtime s[30:31]
    s_waitcnt lgkmcnt(0)
    s_or_b32 s30, s30, 1
    v_mov_b32 v40, s30
    s_mov_b64 exec, 1
    buffer_store_dword v40, off, s[44:47], 0 sc1
    s_mov_b64 exec, -1
nz_2:
    s_waitcnt lgkmcnt(0)
    s_mov_b32 s64, s92
    s_mov_b32 s65, s93
    s_mov_b32 s66, 0x240000
    s_mov_b32 s67, 0x20000
    s_bitcmp1_b32 s28, 0
    s_cselect_b32 s29, 0, 16
    s_cselect_b32 s30, 16, 0
    s_lshl_b32 s48, s48, s29
    s_and_b32 s48, s48, 0xffff0000
    s_lshr_b32 s96, s96, s30
    s_and_b32 s96, s96, 0xffff
    s_bitcmp1_b32 s63, 0
    s_cselect_b32 s29, 0, 16
    s_cselect_b32 s30, 16, 0
    s_lshl_b32 s49, s49, s29
    s_and_b32 s49, s49, 0xffff0000
    s_lshr_b32 s97, s97, s30
    s_and_b32 s97, s97, 0xffff
    s_bfe_u32 s83, s21, 0x20001
    s_lshr_b32 s82, s21, 3
    s_mul_i32 s59, s82, 1327104
    s_mul_i32 s29, s20, 331776
    s_lshl_b32 s30, s83, 8
    s_add_u32 s29, s29, s30
    s_lshl_b32 s30, s82, 1
    s_xor_b32 s30, s30, 6
    s_movk_i32 s31, 1152
    v_lshrrev_b32 v3, 4, v0
    v_bfe_u32 v6, v0, 1, 3
    v_xor_b32 v4, v6, v3
    v_xor_b32 v4, s30, v4
    v_and_b32 v2, 16, v1
    v_lshl_add_u32 v4, v4, 5, v2
    v_xor_b32 v5, 128, v4
    v_mul_u32_u24 v38, s31, v3
    v_add_u32 v38, s29, v38
    v_add_u32 v4, v38, v4
    v_add_u32 v5, v38, v5
    v_accvgpr_write_b32 a236, v4
    v_add_u32 v38, 3584, v5
    v_accvgpr_write_b32 a237, v38
    v_add_u32 v38, 7168, v4
    v_accvgpr_write_b32 a238, v38
    v_add_u32 v38, 10752, v5
    v_accvgpr_write_b32 a239, v38
    v_add_u32 v38, 18432, v4
    v_accvgpr_write_b32 a248, v38
    v_add_u32 v38, 22016, v5
    v_accvgpr_write_b32 a249, v38
    v_add_u32 v38, 25600, v4
    v_accvgpr_write_b32 a250, v38
    v_add_u32 v38, 29184, v5
    v_accvgpr_write_b32 a251, v38
    s_lshl_b32 s29, s20, 6
    s_and_b32 s30, s21, 7
    s_lshl_b32 s30, s30, 3
    s_add_u32 s29, s29, s30
    s_add_u32 s29, s29, s22
    s_lshl_b32 s30, s29, 4
    s_mul_i32 s94, s82, 1152
    s_add_u32 s30, s30, s94
    s_mul_i32 s94, s30, 1152
    s_add_u32 s94, s94, 1024
    s_lshl_b32 s95, s30, 5
    s_add_u32 s95, s95, 18874368
    s_cmp_lt_u32 s29, 72
    s_cselect_b32 s94, s94, 0x7f000000
    s_cselect_b32 s95, s95, 0x7f000000
    v_mul_u32_u24 v6, s31, v6
    v_lshl_add_u32 v6, v3, 5, v6
    v_add_u32 v6, v6, v2
    v_accvgpr_write_b32 a253, v6
    s_mov_b32 s31, 147456
    v_mul_u32_u24 v6, s31, v3
    v_and_b32 v4, 15, v0
    v_lshl_add_u32 v6, v4, 4, v6
    v_accvgpr_write_b32 a254, v6
    s_mul_i32 s29, s20, 18
    v_min_u32 v3, 17, v0
    v_add_u32 v3, s29, v3
    v_and_b32 v4, 7, v3
    v_bfe_u32 v5, v3, 3, 3
    v_lshrrev_b32 v3, 6, v3
    v_lshl_add_u32 v3, v5, 2, v3
    v_lshl_add_u32 v3, v4, 7, v3
    s_lshl_b32 s29, s82, 12
    s_add_u32 s29, s29, 0x610000
    v_lshl_add_u32 v3, v3, 7, s29
    v_accvgpr_write_b32 a255, v3
    v_min_u32 v3, 8, v0
    v_lshlrev_b32 v3, 7, v3
    v_accvgpr_write_b32 a252, v3
    s_waitcnt vmcnt(15)
    v_mov_b32 v72, s48
    s_add_u32 m0, s23, 4096
    s_nop 0
    buffer_load_dwordx4 v13, s[12:15], s25 offen offset:1024 lds
    v_mul_f32 v72, 0x3fb8aa3b, v72
    v_exp_f32 v72, v72
    v_lshlrev_b32 v80, 16, v242
    s_waitcnt vmcnt(10)
    v_mov_b32 v136, s49
    v_lshlrev_b32 v81, 16, v243
    v_mul_f32 v136, 0x3fb8aa3b, v136
    v_lshlrev_b32 v82, 16, v244
    v_exp_f32 v136, v136
    v_lshlrev_b32 v83, 16, v245
    v_lshlrev_b32 v144, 16, v250
    v_cvt_pk_bf16_f32 v72, v72, v72
    v_lshlrev_b32 v145, 16, v251
    v_pk_mul_f32 v[76:77], v[80:81], v[82:83] op_sel:[0,0] op_sel_hi:[0,1]
    v_lshlrev_b32 v146, 16, v252
    v_pk_fma_f32 v[76:77], v[80:81], v[82:83], v[76:77] op_sel:[1,1,0] op_sel_hi:[1,0,1] neg_lo:[1,0,0]
    v_lshlrev_b32 v147, 16, v253
    v_lshlrev_b32 v103, 16, v72
    v_cvt_pk_bf16_f32 v136, v136, v136
    buffer_load_dwordx4 v14, s[12:15], s25 offen offset:2048 lds
    v_lshlrev_b32 v74, 16, v240
    v_pk_mul_f32 v[140:141], v[144:145], v[146:147] op_sel:[0,0] op_sel_hi:[0,1]
    v_lshlrev_b32 v75, 16, v241
    v_pk_fma_f32 v[140:141], v[144:145], v[146:147], v[140:141] op_sel:[1,1,0] op_sel_hi:[1,0,1] neg_lo:[1,0,0]
    v_max_f32 v80, |v76|, |v77|
    v_lshlrev_b32 v167, 16, v136
    v_mul_f32 v74, v74, v103
    v_lshlrev_b32 v138, 16, v248
    v_mul_f32 v75, v75, v103
    v_lshlrev_b32 v139, 16, v249
    v_max_f32_dpp v80, v80, v80 row_shr:1 row_mask:0xf bank_mask:0xf
    v_mul_f32 v74, 0x3fb8aa3b, v74
    v_mul_f32 v75, 0x3e22f983, v75
    v_max_f32 v144, |v140|, |v141|
    v_max_f32_dpp v80, v80, v80 row_shr:2 row_mask:0xf bank_mask:0xf
    v_mul_f32 v86, 0x41000000, v74
    v_mul_f32 v87, 0x41000000, v75
    v_mul_f32 v138, v138, v167
    v_max_f32_dpp v80, v80, v80 row_shr:4 row_mask:0xf bank_mask:0xf
    v_mul_f32 v88, 0x43000000, v74
    v_mul_f32 v89, 0x43000000, v75
    v_mul_f32 v139, v139, v167
    v_max_f32_dpp v80, v80, v80 row_shr:8 row_mask:0xf bank_mask:0xf
    v_fract_f32 v75, v75
    v_fract_f32 v87, v87
    v_max_f32_dpp v144, v144, v144 row_shr:1 row_mask:0xf bank_mask:0xf
    v_mul_f32 v138, 0x3fb8aa3b, v138
    v_mul_f32 v139, 0x3e22f983, v139
    v_max_f32_dpp v80, v80, v80 row_bcast:15 row_mask:0xa bank_mask:0xf
    v_fract_f32 v89, v89
    v_exp_f32 v74, v74
    v_max_f32_dpp v144, v144, v144 row_shr:2 row_mask:0xf bank_mask:0xf
    v_mul_f32 v150, 0x41000000, v138
    v_mul_f32 v151, 0x41000000, v139
    buffer_load_dwordx4 v15, s[12:15], s25 offen offset:3072 lds
    s_add_u32 m0, s24, 4096
    v_max_f32_dpp v80, v80, v80 row_bcast:31 row_mask:0xc bank_mask:0xf
    v_exp_f32 v86, v86
    v_exp_f32 v88, v88
    v_max_f32_dpp v144, v144, v144 row_shr:4 row_mask:0xf bank_mask:0xf
    v_mul_f32 v152, 0x43000000, v138
    v_mul_f32 v153, 0x43000000, v139
    v_readlane_b32 s29, v80, 63
    v_max_f32_dpp v144, v144, v144 row_shr:8 row_mask:0xf bank_mask:0xf
    v_fract_f32 v139, v139
    v_fract_f32 v151, v151
    v_cos_f32 v80, v75
    v_max_f32_dpp v144, v144, v144 row_bcast:15 row_mask:0xa bank_mask:0xf
    v_fract_f32 v153, v153
    v_exp_f32 v138, v138
    v_sin_f32 v81, v75
    v_max_f32_dpp v144, v144, v144 row_bcast:31 row_mask:0xc bank_mask:0xf
    v_exp_f32 v150, v150
    v_exp_f32 v152, v152
    v_frexp_exp_i32_f32 v90, s29
    v_readlane_b32 s30, v144, 63
    v_cos_f32 v82, v87
    v_cos_f32 v144, v139
    v_sin_f32 v83, v87
    v_sin_f32 v145, v139
    v_sub_u32 v91, 12, v90
    v_frexp_exp_i32_f32 v154, s30
    v_subrev_u32 v90, 12, v90
    v_cos_f32 v146, v151
    v_cos_f32 v84, v89
    v_sin_f32 v147, v151
    buffer_load_dwordx4 v21, s[8:11], s4 offen offset:0 lds
    v_sin_f32 v85, v89
    v_sub_u32 v155, 12, v154
    v_ldexp_f32 v123, v103, v90
    v_subrev_u32 v154, 12, v154
    v_ldexp_f32 v76, v76, v91
    v_cos_f32 v148, v153
    v_ldexp_f32 v77, -v77, v91
    v_sin_f32 v149, v153
    v_mul_f32 v80, v80, v74
    v_ldexp_f32 v187, v167, v154
    v_mul_f32 v81, v81, v74
    v_ldexp_f32 v140, v140, v155
    v_mul_f32 v82, v82, v86
    v_ldexp_f32 v141, -v141, v155
    v_mul_f32 v83, v83, -v86
    v_mul_f32 v144, v144, v138
    v_mul_f32 v84, v84, v88
    v_mul_f32 v145, v145, v138
    v_mul_f32 v85, v85, v88
    v_mul_f32 v146, v146, v150
    buffer_load_dwordx4 v22, s[8:11], s4 offen offset:1024 lds
    s_mov_b32 m0, s60
    v_readfirstlane_b32 s74, v123
    v_mul_f32 v147, v147, -v150
    v_cvt_pk_f16_f32 v118, v76, v77
    v_cvt_pk_f16_f32 v111, v84, v85
    v_mov_b32 v122, 0x3c00
    v_mul_f32 v148, v148, v152
    v_mul_f32 v149, v149, v152
    ds_write_addtid_b32 v118 offset:0
    v_pk_mul_f32 v[94:95], v[76:77], v[82:83] op_sel:[0,0] op_sel_hi:[0,1]
    ds_write_addtid_b32 v111 offset:6528
    v_pk_mul_f32 v[92:93], v[84:85], v[84:85] op_sel:[0,0] op_sel_hi:[0,1]
    ds_write_addtid_b32 v122 offset:4352
    v_cvt_pk_f16_f32 v104, v80, v81
    v_readfirstlane_b32 s75, v187
    v_cmp_lt_u32 vcc, 31, v0
    v_mov_b32 v150, 1.0
    v_pk_fma_f32 v[94:95], v[76:77], v[82:83], v[94:95] op_sel:[1,1,0] op_sel_hi:[1,0,1] neg_lo:[1,0,0]
    v_pk_fma_f32 v[92:93], v[84:85], v[84:85], v[92:93] op_sel:[1,1,0] op_sel_hi:[1,0,1] neg_lo:[1,0,0]
    ds_write_addtid_b32 v104 offset:4624
    s_add_u32 m0, s24, 4096
    v_pk_mul_f32 v[88:89], v[80:81], v[80:81] op_sel:[0,0] op_sel_hi:[0,1]
    v_pk_mul_f16 v100, v104, v111 op_sel:[0,0] op_sel_hi:[0,1]
    v_cndmask_b32 v140, v140, v148, vcc
    v_cndmask_b32 v141, v141, v149, vcc
    buffer_load_dwordx4 v23, s[8:11], s4 offen offset:2048 lds
    s_mov_b32 m0, s60
    v_cvt_pk_f16_f32 v119, v94, v95
    v_cvt_pk_f16_f32 v112, v92, v93
    v_pk_fma_f32 v[88:89], v[80:81], v[80:81], v[88:89] op_sel:[1,1,0] op_sel_hi:[1,0,1] neg_lo:[1,0,0]
    v_pk_fma_f16 v100, v104, v111, v100 op_sel:[1,1,0] op_sel_hi:[1,0,1] neg_lo:[1,0,0]
    v_cndmask_b32 v146, v146, v148, vcc
    v_cndmask_b32 v147, v147, v149, vcc
    v_cndmask_b32 v148, v148, v150, vcc
    ds_write_addtid_b32 v119 offset:272
    v_pk_mul_f32 v[96:97], v[94:95], v[82:83] op_sel:[0,0] op_sel_hi:[0,1]
    ds_write_b32 v52, v112 offset:2720
    v_pk_mul_f32 v[90:91], v[92:93], v[84:85] op_sel:[0,0] op_sel_hi:[0,1]
    v_cvt_pk_f16_f32 v105, v88, v89
    ds_write_addtid_b32 v100 offset:6800
    v_cndmask_b32 v149, v149, 0, vcc
    v_cvt_pk_f16_f32 v240, v148, v149
    v_pk_fma_f32 v[96:97], v[94:95], v[82:83], v[96:97] op_sel:[1,1,0] op_sel_hi:[1,0,1] neg_lo:[1,0,0]
    v_pk_fma_f32 v[90:91], v[92:93], v[84:85], v[90:91] op_sel:[1,1,0] op_sel_hi:[1,0,1] neg_lo:[1,0,0]
    ds_write_addtid_b32 v105 offset:4896
    s_add_u32 m0, s24, 4096
    v_pk_mul_f32 v[86:87], v[88:89], v[80:81] op_sel:[0,0] op_sel_hi:[0,1]
    v_pk_mul_f16 v98, v105, v111 op_sel:[0,0] op_sel_hi:[0,1]
    v_cvt_pk_f16_f32 v224, v140, v141
    v_pk_mul_f32 v[150:151], v[148:149], v[144:145] op_sel:[0,0] op_sel_hi:[0,1]
    v_pk_mul_f32 v[158:159], v[140:141], v[146:147] op_sel:[0,0] op_sel_hi:[0,1]
    buffer_load_dwordx4 v24, s[8:11], s4 offen offset:3072 lds
    s_mov_b32 m0, s60
    s_add_u32 s4, s4, 128
    s_cmp_eq_u32 s4, 1152
    s_cselect_b32 s4, 0, s4
    v_cvt_pk_f16_f32 v118, v96, v97
    v_cvt_pk_f16_f32 v113, v90, v91
    v_pk_fma_f32 v[86:87], v[88:89], v[80:81], v[86:87] op_sel:[1,1,0] op_sel_hi:[1,0,1] neg_lo:[1,0,0]
    v_pk_fma_f16 v98, v105, v111, v98 op_sel:[1,1,0] op_sel_hi:[1,0,1] neg_lo:[1,0,0]
    v_pk_fma_f32 v[150:151], v[148:149], v[144:145], v[150:151] op_sel:[1,1,0] op_sel_hi:[1,0,1] neg_lo:[1,0,0]
    v_pk_fma_f32 v[158:159], v[140:141], v[146:147], v[158:159] op_sel:[1,1,0] op_sel_hi:[1,0,1] neg_lo:[1,0,0]
    ds_write_addtid_b32 v118 offset:544
    v_pk_mul_f32 v[94:95], v[96:97], v[82:83] op_sel:[0,0] op_sel_hi:[0,1]
    ds_write_b32 v52, v113 offset:2992
    v_pk_mul_f32 v[92:93], v[90:91], v[84:85] op_sel:[0,0] op_sel_hi:[0,1]
    v_cvt_pk_f16_f32 v106, v86, v87
    ds_write_addtid_b32 v98 offset:7072
    v_cvt_pk_f16_f32 v241, v150, v151
    v_cvt_pk_f16_f32 v225, v158, v159
    v_pk_mul_f32 v[152:153], v[150:151], v[144:145] op_sel:[0,0] op_sel_hi:[0,1]
    v_pk_fma_f32 v[94:95], v[96:97], v[82:83], v[94:95] op_sel:[1,1,0] op_sel_hi:[1,0,1] neg_lo:[1,0,0]
    v_pk_fma_f32 v[92:93], v[90:91], v[84:85], v[92:93] op_sel:[1,1,0] op_sel_hi:[1,0,1] neg_lo:[1,0,0]
    ds_write_addtid_b32 v106 offset:5168
    s_add_u32 m0, s23, 8192
    v_pk_mul_f32 v[88:89], v[86:87], v[80:81] op_sel:[0,0] op_sel_hi:[0,1]
    v_pk_mul_f16 v100, v106, v111 op_sel:[0,0] op_sel_hi:[0,1]
    v_pk_mul_f32 v[160:161], v[158:159], v[146:147] op_sel:[0,0] op_sel_hi:[0,1]
    v_pk_fma_f32 v[152:153], v[150:151], v[144:145], v[152:153] op_sel:[1,1,0] op_sel_hi:[1,0,1] neg_lo:[1,0,0]
    buffer_load_dwordx4 v16, s[12:15], s25 offen offset:0 lds
    s_mov_b32 m0, s60
    s_add_u32 s25, s25, 589824
    s_cmp_eq_u32 s25, 5308416
    s_cselect_b32 s25, 0, s25
    v_cvt_pk_f16_f32 v119, v94, v95
    v_cvt_pk_f16_f32 v114, v92, v93
    v_pk_fma_f32 v[88:89], v[86:87], v[80:81], v[88:89] op_sel:[1,1,0] op_sel_hi:[1,0,1] neg_lo:[1,0,0]
    v_pk_fma_f16 v100, v106, v111, v100 op_sel:[1,1,0] op_sel_hi:[1,0,1] neg_lo:[1,0,0]
    v_pk_fma_f32 v[160:161], v[158:159], v[146:147], v[160:161] op_sel:[1,1,0] op_sel_hi:[1,0,1] neg_lo:[1,0,0]
    v_cvt_pk_f16_f32 v242, v152, v153
    v_cvt_pk_f16_f32 v226, v160, v161
    ds_write_addtid_b32 v119 offset:816
    v_pk_mul_f32 v[96:97], v[94:95], v[82:83] op_sel:[0,0] op_sel_hi:[0,1]
    ds_write_b32 v52, v114 offset:3264
    v_pk_mul_f32 v[90:91], v[92:93], v[84:85] op_sel:[0,0] op_sel_hi:[0,1]
    v_cvt_pk_f16_f32 v107, v88, v89
    ds_write_addtid_b32 v100 offset:7344
    v_pk_mul_f32 v[150:151], v[152:153], v[144:145] op_sel:[0,0] op_sel_hi:[0,1]
    v_pk_mul_f32 v[158:159], v[160:161], v[146:147] op_sel:[0,0] op_sel_hi:[0,1]
    v_pk_fma_f32 v[96:97], v[94:95], v[82:83], v[96:97] op_sel:[1,1,0] op_sel_hi:[1,0,1] neg_lo:[1,0,0]
    v_pk_fma_f32 v[90:91], v[92:93], v[84:85], v[90:91] op_sel:[1,1,0] op_sel_hi:[1,0,1] neg_lo:[1,0,0]
    ds_write_addtid_b32 v107 offset:5440
    s_add_u32 m0, s23, 36864
    v_pk_mul_f32 v[86:87], v[88:89], v[80:81] op_sel:[0,0] op_sel_hi:[0,1]
    v_pk_mul_f16 v98, v107, v111 op_sel:[0,0] op_sel_hi:[0,1]
    v_pk_fma_f32 v[150:151], v[152:153], v[144:145], v[150:151] op_sel:[1,1,0] op_sel_hi:[1,0,1] neg_lo:[1,0,0]
    v_pk_fma_f32 v[158:159], v[160:161], v[146:147], v[158:159] op_sel:[1,1,0] op_sel_hi:[1,0,1] neg_lo:[1,0,0]
    v_cvt_pk_f16_f32 v243, v150, v151
    buffer_load_dwordx4 v8, s[12:15], s25 offen offset:0 lds
    s_mov_b32 m0, s60
    v_cvt_pk_f16_f32 v118, v96, v97
    v_cvt_pk_f16_f32 v115, v90, v91
    v_pk_fma_f32 v[86:87], v[88:89], v[80:81], v[86:87] op_sel:[1,1,0] op_sel_hi:[1,0,1] neg_lo:[1,0,0]
    v_pk_fma_f16 v98, v107, v111, v98 op_sel:[1,1,0] op_sel_hi:[1,0,1] neg_lo:[1,0,0]
    v_cvt_pk_f16_f32 v227, v158, v159
    v_pk_mul_f32 v[152:153], v[150:151], v[144:145] op_sel:[0,0] op_sel_hi:[0,1]
    ds_write_addtid_b32 v118 offset:1088
    v_pk_mul_f32 v[94:95], v[96:97], v[82:83] op_sel:[0,0] op_sel_hi:[0,1]
    ds_write_b32 v52, v115 offset:3536
    v_pk_mul_f32 v[92:93], v[90:91], v[84:85] op_sel:[0,0] op_sel_hi:[0,1]
    v_cvt_pk_f16_f32 v108, v86, v87
    ds_write_addtid_b32 v98 offset:7616
    v_pk_mul_f32 v[160:161], v[158:159], v[146:147] op_sel:[0,0] op_sel_hi:[0,1]
    v_pk_fma_f32 v[152:153], v[150:151], v[144:145], v[152:153] op_sel:[1,1,0] op_sel_hi:[1,0,1] neg_lo:[1,0,0]
    v_pk_fma_f32 v[160:161], v[158:159], v[146:147], v[160:161] op_sel:[1,1,0] op_sel_hi:[1,0,1] neg_lo:[1,0,0]
    v_pk_fma_f32 v[94:95], v[96:97], v[82:83], v[94:95] op_sel:[1,1,0] op_sel_hi:[1,0,1] neg_lo:[1,0,0]
    v_pk_fma_f32 v[92:93], v[90:91], v[84:85], v[92:93] op_sel:[1,1,0] op_sel_hi:[1,0,1] neg_lo:[1,0,0]
    ds_write_addtid_b32 v108 offset:5712
    s_add_u32 m0, s23, 36864
    v_pk_mul_f32 v[88:89], v[86:87], v[80:81] op_sel:[0,0] op_sel_hi:[0,1]
    v_pk_mul_f16 v100, v108, v111 op_sel:[0,0] op_sel_hi:[0,1]
    v_cvt_pk_f16_f32 v244, v152, v153
    v_cvt_pk_f16_f32 v228, v160, v161
    buffer_load_dwordx4 v9, s[12:15], s25 offen offset:1024 lds
    s_mov_b32 m0, s60
    v_cvt_pk_f16_f32 v119, v94, v95
    v_cvt_pk_f16_f32 v116, v92, v93
    v_pk_fma_f32 v[88:89], v[86:87], v[80:81], v[88:89] op_sel:[1,1,0] op_sel_hi:[1,0,1] neg_lo:[1,0,0]
    v_pk_fma_f16 v100, v108, v111, v100 op_sel:[1,1,0] op_sel_hi:[1,0,1] neg_lo:[1,0,0]
    v_pk_mul_f32 v[150:151], v[152:153], v[144:145] op_sel:[0,0] op_sel_hi:[0,1]
    v_pk_mul_f32 v[158:159], v[160:161], v[146:147] op_sel:[0,0] op_sel_hi:[0,1]
    v_pk_fma_f32 v[150:151], v[152:153], v[144:145], v[150:151] op_sel:[1,1,0] op_sel_hi:[1,0,1] neg_lo:[1,0,0]
    ds_write_addtid_b32 v119 offset:1360
    v_pk_mul_f32 v[96:97], v[94:95], v[82:83] op_sel:[0,0] op_sel_hi:[0,1]
    ds_write_b32 v52, v116 offset:3808
    v_pk_mul_f32 v[90:91], v[92:93], v[84:85] op_sel:[0,0] op_sel_hi:[0,1]
    v_cvt_pk_f16_f32 v109, v88, v89
    ds_write_addtid_b32 v100 offset:7888
    v_pk_fma_f32 v[158:159], v[160:161], v[146:147], v[158:159] op_sel:[1,1,0] op_sel_hi:[1,0,1] neg_lo:[1,0,0]
    v_cvt_pk_f16_f32 v245, v150, v151
    v_pk_fma_f32 v[96:97], v[94:95], v[82:83], v[96:97] op_sel:[1,1,0] op_sel_hi:[1,0,1] neg_lo:[1,0,0]
    v_pk_fma_f32 v[90:91], v[92:93], v[84:85], v[90:91] op_sel:[1,1,0] op_sel_hi:[1,0,1] neg_lo:[1,0,0]
    ds_write_addtid_b32 v109 offset:5984
    s_add_u32 m0, s23, 36864
    v_pk_mul_f32 v[86:87], v[88:89], v[80:81] op_sel:[0,0] op_sel_hi:[0,1]
    v_pk_mul_f16 v98, v109, v111 op_sel:[0,0] op_sel_hi:[0,1]
    v_cvt_pk_f16_f32 v229, v158, v159
    v_pk_mul_f32 v[152:153], v[150:151], v[144:145] op_sel:[0,0] op_sel_hi:[0,1]
    v_pk_mul_f32 v[160:161], v[158:159], v[146:147] op_sel:[0,0] op_sel_hi:[0,1]
    buffer_load_dwordx4 v10, s[12:15], s25 offen offset:2048 lds
    s_mov_b32 m0, s60
    v_cvt_pk_f16_f32 v118, v96, v97
    v_cvt_pk_f16_f32 v117, v90, v91
    v_pk_fma_f32 v[86:87], v[88:89], v[80:81], v[86:87] op_sel:[1,1,0] op_sel_hi:[1,0,1] neg_lo:[1,0,0]
    v_pk_fma_f16 v98, v109, v111, v98 op_sel:[1,1,0] op_sel_hi:[1,0,1] neg_lo:[1,0,0]
    v_pk_fma_f32 v[152:153], v[150:151], v[144:145], v[152:153] op_sel:[1,1,0] op_sel_hi:[1,0,1] neg_lo:[1,0,0]
    v_pk_fma_f32 v[160:161], v[158:159], v[146:147], v[160:161] op_sel:[1,1,0] op_sel_hi:[1,0,1] neg_lo:[1,0,0]
    ds_write_addtid_b32 v118 offset:1632
    v_pk_mul_f32 v[94:95], v[96:97], v[82:83] op_sel:[0,0] op_sel_hi:[0,1]
    ds_write_addtid_b32 v117 offset:8704
    v_pk_mul_f32 v[92:93], v[90:91], v[84:85] op_sel:[0,0] op_sel_hi:[0,1]
    v_cvt_pk_f16_f32 v110, v86, v87
    ds_write_addtid_b32 v98 offset:8160
    v_cvt_pk_f16_f32 v246, v152, v153
    v_cvt_pk_f16_f32 v230, v160, v161
    v_pk_mul_f32 v[150:151], v[152:153], v[144:145] op_sel:[0,0] op_sel_hi:[0,1]
    v_pk_fma_f32 v[94:95], v[96:97], v[82:83], v[94:95] op_sel:[1,1,0] op_sel_hi:[1,0,1] neg_lo:[1,0,0]
    v_pk_fma_f32 v[92:93], v[90:91], v[84:85], v[92:93] op_sel:[1,1,0] op_sel_hi:[1,0,1] neg_lo:[1,0,0]
    ds_write_addtid_b32 v110 offset:6256
    s_add_u32 m0, s23, 36864
    v_pk_mul_f16 v122, v105, v112 op_sel:[0,0] op_sel_hi:[0,1]
    v_pk_mul_f16 v100, v110, v111 op_sel:[0,0] op_sel_hi:[0,1]
    v_pk_mul_f32 v[158:159], v[160:161], v[146:147] op_sel:[0,0] op_sel_hi:[0,1]
    v_pk_fma_f32 v[150:151], v[152:153], v[144:145], v[150:151] op_sel:[1,1,0] op_sel_hi:[1,0,1] neg_lo:[1,0,0]
    buffer_load_dwordx4 v11, s[12:15], s25 offen offset:3072 lds
    s_mov_b32 m0, s60
    v_cvt_pk_f16_f32 v119, v94, v95
    v_cvt_pk_f16_f32 v120, v92, v93
    v_pk_fma_f16 v122, v105, v112, v122 op_sel:[1,1,0] op_sel_hi:[1,0,1] neg_lo:[1,0,0]
    v_pk_fma_f16 v100, v110, v111, v100 op_sel:[1,1,0] op_sel_hi:[1,0,1] neg_lo:[1,0,0]
    v_pk_fma_f32 v[158:159], v[160:161], v[146:147], v[158:159] op_sel:[1,1,0] op_sel_hi:[1,0,1] neg_lo:[1,0,0]
    v_cvt_pk_f16_f32 v247, v150, v151
    v_cvt_pk_f16_f32 v231, v158, v159
    ds_write_addtid_b32 v119 offset:1904
    v_pk_mul_f32 v[96:97], v[94:95], v[82:83] op_sel:[0,0] op_sel_hi:[0,1]
    v_pk_mul_f32 v[90:91], v[92:93], v[84:85] op_sel:[0,0] op_sel_hi:[0,1]
    ds_write_b32 v52, v122 offset:1632
    v_pk_mul_f16 v99, v109, v112 op_sel:[0,0] op_sel_hi:[0,1]
    ds_write_addtid_b32 v100 offset:8432
    s_add_u32 m0, s23, 40960
    v_pk_mul_f16 v248, v244, v227 op_sel:[0,0] op_sel_hi:[0,1]
    v_pk_mul_f32 v[160:161], v[158:159], v[146:147] op_sel:[0,0] op_sel_hi:[0,1]
    v_pk_fma_f32 v[96:97], v[94:95], v[82:83], v[96:97] op_sel:[1,1,0] op_sel_hi:[1,0,1] neg_lo:[1,0,0]
    v_pk_fma_f32 v[90:91], v[92:93], v[84:85], v[90:91] op_sel:[1,1,0] op_sel_hi:[1,0,1] neg_lo:[1,0,0]
    v_pk_fma_f16 v99, v109, v112, v99 op_sel:[1,1,0] op_sel_hi:[1,0,1] neg_lo:[1,0,0]
    ds_read_b128 a[16:19], v56 offset:4352
    ds_read_b128 a[20:23], v56 offset:4416
    ds_read_b128 a[24:27], v56 offset:4480
    ds_read_b128 a[28:31], v56 offset:4544
    v_pk_fma_f16 v248, v244, v227, v248 op_sel:[1,1,0] op_sel_hi:[1,0,1] neg_lo:[1,0,0]
    v_pk_fma_f32 v[160:161], v[158:159], v[146:147], v[160:161] op_sel:[1,1,0] op_sel_hi:[1,0,1] neg_lo:[1,0,0]
    v_pk_mul_f16 v249, v244, v228 op_sel:[0,0] op_sel_hi:[0,1]
    buffer_load_dwordx4 v12, s[12:15], s25 offen offset:0 lds
    s_mov_b32 m0, s60
    v_cvt_pk_f16_f32 v118, v96, v97
    ds_write_addtid_b32 v120 offset:4352
    v_cvt_pk_f16_f32 v121, v90, v91
    ds_write_b32 v52, v99 offset:1088
    v_pk_mul_f16 v122, v107, v113 op_sel:[0,0] op_sel_hi:[0,1]
    v_pk_mul_f16 v98, v107, v112 op_sel:[0,0] op_sel_hi:[0,1]
    v_cvt_pk_f16_f32 v232, v160, v161
    v_pk_fma_f16 v249, v244, v228, v249 op_sel:[1,1,0] op_sel_hi:[1,0,1] neg_lo:[1,0,0]
    ds_write_addtid_b32 v118 offset:2176
    v_pk_mul_f32 v[94:95], v[96:97], v[82:83] op_sel:[0,0] op_sel_hi:[0,1]
    ds_write_addtid_b32 v121 offset:4624
    s_add_u32 m0, s23, 40960
    v_pk_mul_f32 v[92:93], v[90:91], v[84:85] op_sel:[0,0] op_sel_hi:[0,1]
    v_pk_fma_f16 v122, v107, v113, v122 op_sel:[1,1,0] op_sel_hi:[1,0,1] neg_lo:[1,0,0]
    v_pk_fma_f16 v98, v107, v112, v98 op_sel:[1,1,0] op_sel_hi:[1,0,1] neg_lo:[1,0,0]
    v_pk_mul_f32 v[158:159], v[160:161], v[146:147] op_sel:[0,0] op_sel_hi:[0,1]
    v_pk_mul_f16 v250, v244, v229 op_sel:[0,0] op_sel_hi:[0,1]
    v_pk_fma_f32 v[158:159], v[160:161], v[146:147], v[158:159] op_sel:[1,1,0] op_sel_hi:[1,0,1] neg_lo:[1,0,0]
    v_pk_fma_f32 v[94:95], v[96:97], v[82:83], v[94:95] op_sel:[1,1,0] op_sel_hi:[1,0,1] neg_lo:[1,0,0]
    v_pk_fma_f32 v[92:93], v[90:91], v[84:85], v[92:93] op_sel:[1,1,0] op_sel_hi:[1,0,1] neg_lo:[1,0,0]
    ds_write_b32 v52, v122 offset:2448
    v_pk_mul_f16 v99, v107, v114 op_sel:[0,0] op_sel_hi:[0,1]
    ds_write_b32 v52, v98 offset:2176
    v_pk_mul_f16 v100, v105, v113 op_sel:[0,0] op_sel_hi:[0,1]
    v_pk_fma_f16 v250, v244, v229, v250 op_sel:[1,1,0] op_sel_hi:[1,0,1] neg_lo:[1,0,0]
    v_cvt_pk_f16_f32 v233, v158, v159
    buffer_load_dwordx4 v13, s[12:15], s25 offen offset:1024 lds
    s_mov_b32 m0, s60
    v_cvt_pk_f16_f32 v119, v94, v95
    v_cvt_pk_f16_f32 v120, v92, v93
    v_pk_fma_f16 v99, v107, v114, v99 op_sel:[1,1,0] op_sel_hi:[1,0,1] neg_lo:[1,0,0]
    v_pk_fma_f16 v100, v105, v113, v100 op_sel:[1,1,0] op_sel_hi:[1,0,1] neg_lo:[1,0,0]
    v_pk_mul_f16 v251, v244, v230 op_sel:[0,0] op_sel_hi:[0,1]
    v_pk_mul_f32 v[160:161], v[158:159], v[146:147] op_sel:[0,0] op_sel_hi:[0,1]
    v_pk_fma_f16 v251, v244, v230, v251 op_sel:[1,1,0] op_sel_hi:[1,0,1] neg_lo:[1,0,0]
    ds_write_addtid_b32 v119 offset:2448
    v_pk_mul_f32 v[96:97], v[94:95], v[82:83] op_sel:[0,0] op_sel_hi:[0,1]
    ds_write_addtid_b32 v120 offset:4896
    s_add_u32 m0, s23, 40960
    v_pk_mul_f32 v[90:91], v[92:93], v[84:85] op_sel:[0,0] op_sel_hi:[0,1]
    ds_write_b32 v52, v99 offset:0
    v_pk_mul_f16 v122, v107, v116 op_sel:[0,0] op_sel_hi:[0,1]
    ds_write_b32 v52, v100 offset:1904
    v_pk_mul_f16 v98, v109, v113 op_sel:[0,0] op_sel_hi:[0,1]
    v_pk_fma_f32 v[160:161], v[158:159], v[146:147], v[160:161] op_sel:[1,1,0] op_sel_hi:[1,0,1] neg_lo:[1,0,0]
    v_pk_mul_f16 v252, v246, v225 op_sel:[0,0] op_sel_hi:[0,1]
    v_pk_fma_f32 v[96:97], v[94:95], v[82:83], v[96:97] op_sel:[1,1,0] op_sel_hi:[1,0,1] neg_lo:[1,0,0]
    v_pk_fma_f32 v[90:91], v[92:93], v[84:85], v[90:91] op_sel:[1,1,0] op_sel_hi:[1,0,1] neg_lo:[1,0,0]
    v_pk_fma_f16 v122, v107, v116, v122 op_sel:[1,1,0] op_sel_hi:[1,0,1] neg_lo:[1,0,0]
    v_pk_fma_f16 v98, v109, v113, v98 op_sel:[1,1,0] op_sel_hi:[1,0,1] neg_lo:[1,0,0]
    v_cvt_pk_f16_f32 v234, v160, v161
    v_pk_fma_f16 v252, v246, v225, v252 op_sel:[1,1,0] op_sel_hi:[1,0,1] neg_lo:[1,0,0]
    v_pk_mul_f32 v[158:159], v[160:161], v[146:147] op_sel:[0,0] op_sel_hi:[0,1]
    buffer_load_dwordx4 v14, s[12:15], s25 offen offset:2048 lds
    s_mov_b32 m0, s60
    v_cvt_pk_f16_f32 v118, v96, v97
    v_cvt_pk_f16_f32 v121, v90, v91
    ds_write_b32 v52, v122 offset:544
    ds_write_b32 v52, v98 offset:1360
    v_pk_mul_f16 v100, v107, v115 op_sel:[0,0] op_sel_hi:[0,1]
    v_pk_mul_f16 v253, v246, v226 op_sel:[0,0] op_sel_hi:[0,1]
    v_pk_fma_f32 v[158:159], v[160:161], v[146:147], v[158:159] op_sel:[1,1,0] op_sel_hi:[1,0,1] neg_lo:[1,0,0]
    ds_write_addtid_b32 v118 offset:2720
    v_pk_mul_f32 v[94:95], v[96:97], v[82:83] op_sel:[0,0] op_sel_hi:[0,1]
    ds_write_addtid_b32 v121 offset:5168
    s_add_u32 m0, s23, 40960
    v_pk_mul_f32 v[92:93], v[90:91], v[84:85] op_sel:[0,0] op_sel_hi:[0,1]
    v_pk_fma_f16 v100, v107, v115, v100 op_sel:[1,1,0] op_sel_hi:[1,0,1] neg_lo:[1,0,0]
    v_pk_fma_f16 v253, v246, v226, v253 op_sel:[1,1,0] op_sel_hi:[1,0,1] neg_lo:[1,0,0]
    v_cvt_pk_f16_f32 v235, v158, v159
    v_pk_mul_f16 v254, v242, v225 op_sel:[0,0] op_sel_hi:[0,1]
    v_pk_fma_f32 v[94:95], v[96:97], v[82:83], v[94:95] op_sel:[1,1,0] op_sel_hi:[1,0,1] neg_lo:[1,0,0]
    v_pk_fma_f32 v[92:93], v[90:91], v[84:85], v[92:93] op_sel:[1,1,0] op_sel_hi:[1,0,1] neg_lo:[1,0,0]
    ds_write_b32 v52, v100 offset:272
    v_pk_mul_f16 v98, v107, v117 op_sel:[0,0] op_sel_hi:[0,1]
    v_pk_mul_f32 v[160:161], v[158:159], v[146:147] op_sel:[0,0] op_sel_hi:[0,1]
    v_pk_fma_f16 v254, v242, v225, v254 op_sel:[1,1,0] op_sel_hi:[1,0,1] neg_lo:[1,0,0]
    buffer_load_dwordx4 v15, s[12:15], s25 offen offset:3072 lds
    s_mov_b32 m0, s60
    v_cvt_pk_f16_f32 v119, v94, v95
    v_cvt_pk_f16_f32 v120, v92, v93
    v_pk_fma_f16 v98, v107, v117, v98 op_sel:[1,1,0] op_sel_hi:[1,0,1] neg_lo:[1,0,0]
    v_pk_fma_f32 v[160:161], v[158:159], v[146:147], v[160:161] op_sel:[1,1,0] op_sel_hi:[1,0,1] neg_lo:[1,0,0]
    v_pk_mul_f16 v255, v242, v226 op_sel:[0,0] op_sel_hi:[0,1]
    v_cvt_pk_f16_f32 v236, v160, v161
    ds_write_addtid_b32 v119 offset:2992
    v_pk_mul_f32 v[96:97], v[94:95], v[82:83] op_sel:[0,0] op_sel_hi:[0,1]
    ds_write_addtid_b32 v120 offset:5440
    s_add_u32 m0, s23, 45056
    v_pk_mul_f32 v[90:91], v[92:93], v[84:85] op_sel:[0,0] op_sel_hi:[0,1]
    ds_write_b32 v52, v98 offset:816
    v_pk_fma_f16 v255, v242, v226, v255 op_sel:[1,1,0] op_sel_hi:[1,0,1] neg_lo:[1,0,0]
    v_pk_mul_f32 v[158:159], v[160:161], v[146:147] op_sel:[0,0] op_sel_hi:[0,1]
    v_pk_fma_f32 v[96:97], v[94:95], v[82:83], v[96:97] op_sel:[1,1,0] op_sel_hi:[1,0,1] neg_lo:[1,0,0]
    v_pk_fma_f32 v[90:91], v[92:93], v[84:85], v[90:91] op_sel:[1,1,0] op_sel_hi:[1,0,1] neg_lo:[1,0,0]
    v_pk_mul_f16 v220, v244, v225 op_sel:[0,0] op_sel_hi:[0,1]
    v_pk_fma_f32 v[158:159], v[160:161], v[146:147], v[158:159] op_sel:[1,1,0] op_sel_hi:[1,0,1] neg_lo:[1,0,0]
    v_pk_fma_f16 v220, v244, v225, v220 op_sel:[1,1,0] op_sel_hi:[1,0,1] neg_lo:[1,0,0]
    buffer_load_dwordx4 v16, s[12:15], s25 offen offset:0 lds
    s_mov_b32 m0, s60
    s_add_u32 s25, s25, 589824
    s_cmp_eq_u32 s25, 5308416
    s_cselect_b32 s25, 0, s25
    v_cvt_pk_f16_f32 v118, v96, v97
    v_cvt_pk_f16_f32 v121, v90, v91
    v_cvt_pk_f16_f32 v237, v158, v159
    v_pk_mul_f16 v221, v244, v226 op_sel:[0,0] op_sel_hi:[0,1]
    ds_write_addtid_b32 v118 offset:3264
    v_pk_mul_f32 v[94:95], v[96:97], v[82:83] op_sel:[0,0] op_sel_hi:[0,1]
    ds_write_addtid_b32 v121 offset:5712
    v_pk_mul_f32 v[92:93], v[90:91], v[84:85] op_sel:[0,0] op_sel_hi:[0,1]
    v_pk_mul_f32 v[160:161], v[158:159], v[146:147] op_sel:[0,0] op_sel_hi:[0,1]
    v_pk_fma_f16 v221, v244, v226, v221 op_sel:[1,1,0] op_sel_hi:[1,0,1] neg_lo:[1,0,0]
    v_pk_fma_f32 v[160:161], v[158:159], v[146:147], v[160:161] op_sel:[1,1,0] op_sel_hi:[1,0,1] neg_lo:[1,0,0]
    v_pk_fma_f32 v[94:95], v[96:97], v[82:83], v[94:95] op_sel:[1,1,0] op_sel_hi:[1,0,1] neg_lo:[1,0,0]
    v_pk_fma_f32 v[92:93], v[90:91], v[84:85], v[92:93] op_sel:[1,1,0] op_sel_hi:[1,0,1] neg_lo:[1,0,0]
    v_cvt_pk_f16_f32 v238, v160, v161
    v_pk_mul_f32 v[158:159], v[160:161], v[146:147] op_sel:[0,0] op_sel_hi:[0,1]
    v_cvt_pk_f16_f32 v119, v94, v95
    v_cvt_pk_f16_f32 v120, v92, v93
    v_pk_fma_f32 v[158:159], v[160:161], v[146:147], v[158:159] op_sel:[1,1,0] op_sel_hi:[1,0,1] neg_lo:[1,0,0]
    v_cvt_pk_f16_f32 v239, v158, v159
    ds_write_addtid_b32 v119 offset:3536
    v_pk_mul_f32 v[96:97], v[94:95], v[82:83] op_sel:[0,0] op_sel_hi:[0,1]
    ds_write_addtid_b32 v120 offset:5984
    v_pk_mul_f32 v[90:91], v[92:93], v[84:85] op_sel:[0,0] op_sel_hi:[0,1]
    v_pk_fma_f32 v[96:97], v[94:95], v[82:83], v[96:97] op_sel:[1,1,0] op_sel_hi:[1,0,1] neg_lo:[1,0,0]
    v_pk_fma_f32 v[90:91], v[92:93], v[84:85], v[90:91] op_sel:[1,1,0] op_sel_hi:[1,0,1] neg_lo:[1,0,0]
    v_cvt_pk_f16_f32 v118, v96, v97
    v_cvt_pk_f16_f32 v121, v90, v91
    ds_write_addtid_b32 v118 offset:3808
    v_pk_mul_f32 v[94:95], v[96:97], v[82:83] op_sel:[0,0] op_sel_hi:[0,1]
    ds_write_addtid_b32 v121 offset:6256
    v_pk_mul_f32 v[92:93], v[90:91], v[84:85] op_sel:[0,0] op_sel_hi:[0,1]
    v_pk_fma_f32 v[94:95], v[96:97], v[82:83], v[94:95] op_sel:[1,1,0] op_sel_hi:[1,0,1] neg_lo:[1,0,0]
    v_pk_fma_f32 v[92:93], v[90:91], v[84:85], v[92:93] op_sel:[1,1,0] op_sel_hi:[1,0,1] neg_lo:[1,0,0]
    v_cvt_pk_f16_f32 v119, v94, v95
    v_cvt_pk_f16_f32 v120, v92, v93
    ds_write_addtid_b32 v119 offset:4080
    ds_write_addtid_b32 v120 offset:6528
    ds_read_b128 a[0:3], v56 offset:0
    ds_read_b128 a[32:35], v54 offset:0
    ds_read_b128 a[48:51], v56 offset:4352
    ds_read_b128 a[4:7], v56 offset:64
    ds_read_b128 a[36:39], v54 offset:64
    ds_read_b128 a[52:55], v56 offset:4416
    ds_read_b128 a[8:11], v56 offset:128
    ds_read_b128 a[40:43], v54 offset:128
    ds_read_b128 a[56:59], v56 offset:4480
    ds_read_b128 a[12:15], v56 offset:192
    ds_read_b128 a[44:47], v54 offset:192
    ds_read_b128 a[60:63], v56 offset:4544
    s_mov_b64 exec, 0
    s_cmp_eq_u32 s20, 0
    s_cbranch_scc1 pad_0
    s_cmp_eq_u32 s20, 1
    s_cbranch_scc1 pad_1
    s_cmp_eq_u32 s20, 2
    s_cbranch_scc1 pad_2
    s_branch pad_3
pad_ret:
    s_mov_b64 exec, -1
    s_waitcnt vmcnt(9)
    s_barrier
    ds_read_b128 a[96:99], v28 offset:0
    ds_read_b64_tr_b16 a[192:193], v25 offset:0
    ds_read_b64_tr_b16 a[194:195], v25 offset:2304
    ds_read_b128 a[104:107], v28 offset:2048
    ds_read_b128 a[112:115], v28 offset:4096
    ds_read_b128 a[120:123], v28 offset:6144
    ds_read_b64_tr_b16 a[196:197], v25 offset:9216
    ds_read_b64_tr_b16 a[198:199], v25 offset:11520
    ds_read_b128 a[100:103], v29 offset:0
    ds_read_b128 a[108:111], v29 offset:2048
    ds_read_b128 a[116:119], v29 offset:4096
    ds_read_b128 a[124:127], v29 offset:6144
    ds_read_b64_tr_b16 a[200:201], v25 offset:32
    ds_read_b64_tr_b16 a[202:203], v25 offset:2336
    ds_read_b64_tr_b16 a[204:205], v25 offset:9248
    ds_read_b64_tr_b16 a[206:207], v25 offset:11552
    s_waitcnt lgkmcnt(13)
    v_mfma_f32_16x16x32_bf16 v[64:67], a[192:195], a[96:99], 0
    s_waitcnt lgkmcnt(12)
    ds_read_b64_tr_b16 a[208:209], v25 offset:64
    ds_read_b64_tr_b16 a[210:211], v25 offset:2368
    s_mov_b32 m0, s60
    s_nop 0
    ds_write_addtid_b32 v224 offset:0
    v_mfma_f32_16x16x32_f16 v[192:195], a[16:19], a[0:3], 0
    v_mfma_f32_16x16x32_bf16 v[68:71], a[192:195], a[104:107], 0
    s_waitcnt lgkmcnt(14)
    ds_read_b64_tr_b16 v[44:45], v41
    ds_read_b64_tr_b16 v[46:47], v42
    ds_read_b64_tr_b16 v[48:49], v41 offset:4096
    ds_read_b64_tr_b16 v[50:51], v42 offset:4096
    ds_write_addtid_b32 v225 offset:272
    v_mfma_f32_16x16x32_f16 v[196:199], a[0:3], a[32:35], 0
    v_mfma_f32_16x16x32_bf16 v[72:75], a[192:195], a[112:115], 0
    s_waitcnt lgkmcnt(15)
    ds_write_addtid_b32 v226 offset:544
    v_mfma_f32_16x16x32_f16 v[200:203], a[0:3], a[48:51], 0
    v_mfma_f32_16x16x32_bf16 v[76:79], a[192:195], a[120:123], 0
    ds_write_addtid_b32 v227 offset:816
    v_mfma_f32_16x16x32_f16 v[192:195], a[20:23], a[4:7], v[192:195]
    v_mfma_f32_16x16x32_bf16 v[64:67], a[196:199], a[100:103], v[64:67]
    s_waitcnt lgkmcnt(15)
    ds_read_b64_tr_b16 a[212:213], v25 offset:9280
    ds_read_b64_tr_b16 a[214:215], v25 offset:11584
    ds_write_addtid_b32 v228 offset:1088
    v_mfma_f32_16x16x32_f16 v[196:199], a[4:7], a[36:39], v[196:199]
    v_mfma_f32_16x16x32_bf16 v[68:71], a[196:199], a[108:111], v[68:71]
    ds_write_addtid_b32 v229 offset:1360
    v_mfma_f32_16x16x32_f16 v[200:203], a[4:7], a[52:55], v[200:203]
    v_mfma_f32_16x16x32_bf16 v[72:75], a[196:199], a[116:119], v[72:75]
    s_waitcnt lgkmcnt(15)
    ds_write_addtid_b32 v230 offset:1632
    v_mfma_f32_16x16x32_f16 v[192:195], a[24:27], a[8:11], v[192:195]
    v_mfma_f32_16x16x32_bf16 v[76:79], a[196:199], a[124:127], v[76:79]
    ds_write_addtid_b32 v231 offset:1904
    v_mfma_f32_16x16x32_f16 v[196:199], a[8:11], a[40:43], v[196:199]
    v_mfma_f32_16x16x32_bf16 v[80:83], a[200:203], a[96:99], 0
    ds_read_b64_tr_b16 a[216:217], v25 offset:96
    ds_read_b64_tr_b16 a[218:219], v25 offset:2400
    ds_write_addtid_b32 v232 offset:2176
    v_mfma_f32_16x16x32_f16 v[200:203], a[8:11], a[56:59], v[200:203]
    v_mfma_f32_16x16x32_bf16 v[84:87], a[200:203], a[104:107], 0
    ds_write_addtid_b32 v233 offset:2448
    v_mfma_f32_16x16x32_f16 v[192:195], a[28:31], a[12:15], v[192:195]
    v_mfma_f32_16x16x32_bf16 v[88:91], a[200:203], a[112:115], 0
    ds_write_addtid_b32 v234 offset:2720
    v_mfma_f32_16x16x32_f16 v[196:199], a[12:15], a[44:47], v[196:199]
    v_mfma_f32_16x16x32_bf16 v[92:95], a[200:203], a[120:123], 0
    s_waitcnt lgkmcnt(15)
    ds_write_addtid_b32 v235 offset:2992
    v_mfma_f32_16x16x32_f16 v[200:203], a[12:15], a[60:63], v[200:203]
    v_mfma_f32_16x16x32_bf16 v[80:83], a[204:207], a[100:103], v[80:83]
    ds_read_b64_tr_b16 a[220:221], v25 offset:9312
    ds_read_b64_tr_b16 a[222:223], v25 offset:11616
    ds_write_addtid_b32 v236 offset:3264
    v_mfma_f32_16x16x32_bf16 v[84:87], a[204:207], a[108:111], v[84:87]
    ds_write_addtid_b32 v237 offset:3536
    ds_write_addtid_b32 v238 offset:3808
    ds_write_addtid_b32 v239 offset:4080
    v_mfma_f32_16x16x32_bf16 v[88:91], a[204:207], a[116:119], v[88:91]
    ds_write_addtid_b32 v240 offset:4352
    ds_write_addtid_b32 v241 offset:4624
    ds_write_addtid_b32 v242 offset:4896
    v_mfma_f32_16x16x32_bf16 v[92:95], a[204:207], a[124:127], v[92:95]
    ds_write_addtid_b32 v243 offset:5168
    ds_write_addtid_b32 v244 offset:5440
    ds_write_addtid_b32 v245 offset:5712
    v_mfma_f32_16x16x32_bf16 v[96:99], a[208:211], a[96:99], 0
    ds_read_b64_tr_b16 a[224:225], v25 offset:128
    ds_read_b64_tr_b16 a[226:227], v25 offset:2432
    ds_write_addtid_b32 v246 offset:5984
    v_mfma_f32_16x16x32_bf16 v[100:103], a[208:211], a[104:107], 0
    s_add_u32 m0, s24, 0
    s_nop 0
    buffer_load_dwordx4 v21, s[8:11], s4 offen offset:0 lds
    s_mov_b32 m0, s60
    s_nop 0
    ds_write_addtid_b32 v247 offset:6256
    s_add_u32 m0, s24, 8192
    s_nop 0
    buffer_load_dwordx4 v17, s[8:11], s4 offen offset:0 lds
    v_mfma_f32_16x16x32_bf16 v[104:107], a[208:211], a[112:115], 0
    buffer_load_dwordx4 v18, s[8:11], s4 offen offset:1024 lds
    buffer_load_dwordx4 v19, s[8:11], s4 offen offset:2048 lds
    buffer_load_dwordx4 v20, s[8:11], s4 offen offset:3072 lds
    v_mfma_f32_16x16x32_bf16 v[108:111], a[208:211], a[120:123], 0
    s_waitcnt lgkmcnt(15)
    s_mov_b32 m0, s60
    s_nop 0
    ds_write_addtid_b32 v248 offset:7824
    ds_write_addtid_b32 v249 offset:7680
    ds_write_addtid_b32 v250 offset:7536
    v_mfma_f32_16x16x32_bf16 v[96:99], a[212:215], a[100:103], v[96:99]
    ds_read_b64_tr_b16 a[228:229], v25 offset:9344
    ds_read_b64_tr_b16 a[230:231], v25 offset:11648
    ds_write_addtid_b32 v251 offset:7392
    v_mfma_f32_16x16x32_bf16 v[100:103], a[212:215], a[108:111], v[100:103]
    s_add_u32 m0, s24, 0
    s_nop 0
    buffer_load_dwordx4 v22, s[8:11], s4 offen offset:1024 lds
    s_mov_b32 m0, s60
    s_nop 0
    ds_write_addtid_b32 v252 offset:7248
    ds_write_addtid_b32 v253 offset:7104
    v_mfma_f32_16x16x32_bf16 v[104:107], a[212:215], a[116:119], v[104:107]
    ds_write_addtid_b32 v254 offset:6960
    ds_write_addtid_b32 v255 offset:6816
    ds_write_addtid_b32 v220 offset:6672
    v_mfma_f32_16x16x32_bf16 v[108:111], a[212:215], a[124:127], v[108:111]
    ds_write_addtid_b32 v221 offset:6528
    ds_read_b128 a[64:67], v56 offset:0
    ds_read_b128 a[72:75], v57 offset:0
    v_mfma_f32_16x16x32_bf16 v[112:115], a[216:219], a[96:99], 0
    s_add_u32 m0, s24, 0
    ds_read_b64_tr_b16 a[192:193], v25 offset:160
    ds_read_b64_tr_b16 a[194:195], v25 offset:2464
    ds_read_b128 a[80:83], v58 offset:0
    v_mfma_f32_16x16x32_bf16 v[116:119], a[216:219], a[104:107], 0
    buffer_load_dwordx4 v23, s[8:11], s4 offen offset:2048 lds
    ds_read_b128 a[88:91], v56 offset:2032
    ds_read_b128 a[68:71], v56 offset:64
    v_mfma_f32_16x16x32_bf16 v[120:123], a[216:219], a[112:115], 0
    ds_read_b128 a[76:79], v57 offset:64
    ds_read_b128 a[84:87], v58 offset:64
    ds_read_b128 a[92:95], v56 offset:2096
    v_mfma_f32_16x16x32_bf16 v[124:127], a[216:219], a[120:123], 0
    s_waitcnt lgkmcnt(15)
    v_permlane32_swap_b32 v44, v48
    v_permlane32_swap_b32 v45, v49
    v_permlane32_swap_b32 v46, v50
    v_mfma_f32_16x16x32_bf16 v[112:115], a[220:223], a[100:103], v[112:115]
    ds_read_b64_tr_b16 a[196:197], v25 offset:9376
    ds_read_b64_tr_b16 a[198:199], v25 offset:11680
    v_permlane32_swap_b32 v47, v51
    v_mfma_f32_16x16x32_bf16 v[116:119], a[220:223], a[108:111], v[116:119]
    buffer_load_dwordx4 v24, s[8:11], s4 offen offset:3072 lds
    buffer_store_dwordx4 v[44:47], v43, s[32:35], s54 offen sc1
    s_add_u32 s54, s54, 32768
    buffer_store_dwordx4 v[48:51], v43, s[32:35], s54 offen sc1
    v_mfma_f32_16x16x32_bf16 v[120:123], a[220:223], a[116:119], v[120:123]
    s_add_u32 m0, s24, 4096
    v_mul_f32 v192, s74, v192
    v_mul_f32 v193, s74, v193
    v_mul_f32 v194, s74, v194
    v_mfma_f32_16x16x32_bf16 v[124:127], a[220:223], a[124:127], v[124:127]
    s_add_u32 s4, s4, 128
    v_mul_f32 v195, s74, v195
    v_mul_f32 v196, s74, v196
    v_mul_f32 v197, s74, v197
    v_mfma_f32_16x16x32_bf16 v[128:131], a[224:227], a[96:99], 0
    s_cmp_eq_u32 s4, 1152
    s_cselect_b32 s4, 0, s4
    ds_read_b64_tr_b16 a[200:201], v25 offset:18432
    ds_read_b64_tr_b16 a[202:203], v25 offset:20736
    v_mfma_f32_16x16x32_bf16 v[132:135], a[224:227], a[104:107], 0
    buffer_load_dwordx4 v17, s[8:11], s4 offen offset:0 lds
    v_mul_f32 v198, s74, v198
    v_mul_f32 v199, s74, v199
    v_mfma_f32_16x16x32_bf16 v[136:139], a[224:227], a[112:115], 0
    v_mul_f32 v200, s74, v200
    v_mul_f32 v201, s74, v201
    v_mul_f32 v202, s74, v202
    v_mfma_f32_16x16x32_bf16 v[140:143], a[224:227], a[120:123], 0
    v_mul_f32 v203, s74, v203
    v_mfma_f32_16x16x32_bf16 v[128:131], a[228:231], a[100:103], v[128:131]
    ds_read_b64_tr_b16 a[204:205], v25 offset:27648
    ds_read_b64_tr_b16 a[206:207], v25 offset:29952
    s_waitcnt lgkmcnt(10)
    v_mfma_f32_16x16x32_f16 v[208:211], a[72:75], a[64:67], 0
    v_mfma_f32_16x16x32_bf16 v[132:135], a[228:231], a[108:111], v[132:135]
    buffer_load_dwordx4 v18, s[8:11], s4 offen offset:1024 lds
    v_mfma_f32_16x16x32_f16 v[212:215], a[64:67], a[80:83], 0
    v_mfma_f32_16x16x32_bf16 v[136:139], a[228:231], a[116:119], v[136:139]
    v_mfma_f32_16x16x32_f16 v[216:219], a[64:67], a[88:91], 0
    v_mfma_f32_16x16x32_bf16 v[140:143], a[228:231], a[124:127], v[140:143]
    s_waitcnt lgkmcnt(6)
    v_mfma_f32_16x16x32_f16 v[208:211], a[76:79], a[68:71], v[208:211]
    v_mfma_f32_16x16x32_bf16 v[144:147], a[192:195], a[96:99], 0
    ds_read_b64_tr_b16 a[208:209], v25 offset:18464
    ds_read_b64_tr_b16 a[210:211], v25 offset:20768
    v_mfma_f32_16x16x32_f16 v[212:215], a[68:71], a[84:87], v[212:215]
    v_mfma_f32_16x16x32_bf16 v[148:151], a[192:195], a[104:107], 0
    buffer_load_dwordx4 v19, s[8:11], s4 offen offset:2048 lds
    v_mfma_f32_16x16x32_f16 v[216:219], a[68:71], a[92:95], v[216:219]
    v_mfma_f32_16x16x32_bf16 v[152:155], a[192:195], a[112:115], 0
    ds_write_b128 v59, v[192:195] offset:0
    ds_write_b128 v59, v[196:199] offset:1024
    ds_write_b128 v59, v[200:203] offset:2048
    v_mfma_f32_16x16x32_bf16 v[156:159], a[192:195], a[120:123], 0
    s_waitcnt lgkmcnt(9)
    v_mul_f32 v208, s75, v208
    v_mul_f32 v209, s75, v209
    v_mul_f32 v210, s75, v210
    v_mfma_f32_16x16x32_bf16 v[144:147], a[196:199], a[100:103], v[144:147]
    ds_read_b64_tr_b16 a[212:213], v25 offset:27680
    ds_read_b64_tr_b16 a[214:215], v25 offset:29984
    v_mul_f32 v211, s75, v211
    v_mfma_f32_16x16x32_bf16 v[148:151], a[196:199], a[108:111], v[148:151]
    buffer_load_dwordx4 v20, s[8:11], s4 offen offset:3072 lds
    ds_write_b128 v59, v[208:211] offset:3072
    v_mul_f32 v212, s75, v212
    v_mfma_f32_16x16x32_bf16 v[152:155], a[196:199], a[116:119], v[152:155]
    s_add_u32 m0, s23, 73728
    v_mul_f32 v213, s75, v213
    v_mul_f32 v214, s75, v214
    v_mul_f32 v215, s75, v215
    v_mfma_f32_16x16x32_bf16 v[156:159], a[196:199], a[124:127], v[156:159]
    s_waitcnt lgkmcnt(10)
    ds_write_b128 v59, v[212:215] offset:4096
    v_mul_f32 v216, s75, v216
    v_mul_f32 v217, s75, v217
    v_mfma_f32_16x16x32_bf16 a[0:3], a[200:203], a[96:99], 0
    ds_read_b64_tr_b16 a[216:217], v25 offset:18496
    ds_read_b64_tr_b16 a[218:219], v25 offset:20800
    v_mul_f32 v218, s75, v218
    v_mfma_f32_16x16x32_bf16 a[4:7], a[200:203], a[104:107], 0
    v_mul_f32 v219, s75, v219
    v_mfma_f32_16x16x32_bf16 a[8:11], a[200:203], a[112:115], 0
    ds_write_b128 v59, v[216:219] offset:5120
pad_0:
    s_cbranch_execz pad_4
    v_mfma_f32_16x16x32_bf16 a[12:15], a[200:203], a[120:123], 0
    s_waitcnt lgkmcnt(12)
    s_waitcnt lgkmcnt(0)
    s_barrier
    v_mfma_f32_16x16x32_bf16 a[0:3], a[204:207], a[100:103], a[0:3]
    ds_read_b64_tr_b16 a[220:221], v25 offset:27712
    ds_read_b64_tr_b16 a[222:223], v25 offset:30016
    v_mfma_f32_16x16x32_bf16 a[4:7], a[204:207], a[108:111], a[4:7]
    ds_read_b128 v[224:227], v32
    ds_read_b128 v[228:231], v32 offset:9216
    ds_read_b128 v[232:235], v33
    ds_read_b128 v[236:239], v33 offset:9216
    ds_read_b128 v[240:243], v34 offset:0
    ds_read_b128 v[244:247], v34 offset:9216
    ds_read_b128 v[248:251], v34 offset:18432
    ds_read_b128 v[252:255], v34 offset:27648
    v_mfma_f32_16x16x32_bf16 a[8:11], a[204:207], a[116:119], a[8:11]
    v_mfma_f32_16x16x32_bf16 a[12:15], a[204:207], a[124:127], a[12:15]
    v_mfma_f32_16x16x32_bf16 a[16:19], a[208:211], a[96:99], 0
    ds_read_b64_tr_b16 a[224:225], v25 offset:18528
    ds_read_b64_tr_b16 a[226:227], v25 offset:20832
    s_waitcnt lgkmcnt(8)
    v_mfma_f32_16x16x32_bf16 a[20:23], a[208:211], a[104:107], 0
    v_add_f32 v224, v224, v228
    v_mfma_f32_16x16x32_bf16 a[24:27], a[208:211], a[112:115], 0
    v_add_f32 v225, v225, v229
    v_mfma_f32_16x16x32_bf16 a[28:31], a[208:211], a[120:123], 0
    v_add_f32 v226, v226, v230
    v_mfma_f32_16x16x32_bf16 a[16:19], a[212:215], a[100:103], a[16:19]
    ds_read_b64_tr_b16 a[228:229], v25 offset:27744
    ds_read_b64_tr_b16 a[230:231], v25 offset:30048
    v_mfma_f32_16x16x32_bf16 a[20:23], a[212:215], a[108:111], a[20:23]
    v_add_f32 v227, v227, v231
    v_mfma_f32_16x16x32_bf16 a[24:27], a[212:215], a[116:119], a[24:27]
    v_cvt_pk_bf16_f32 v224, v224, v225
    v_mfma_f32_16x16x32_bf16 a[28:31], a[212:215], a[124:127], a[28:31]
    v_cvt_pk_bf16_f32 v225, v226, v227
    s_waitcnt lgkmcnt(4)
    s_barrier
    v_mfma_f32_16x16x32_bf16 a[32:35], a[216:219], a[96:99], 0
    ds_read_b64_tr_b16 a[192:193], v25 offset:18560
    ds_read_b64_tr_b16 a[194:195], v25 offset:20864
    v_mfma_f32_16x16x32_bf16 a[36:39], a[216:219], a[104:107], 0
    buffer_load_dwordx4 v8, s[12:15], s25 offen offset:0 lds
    ds_write_b64 v35, v[224:225]
    v_mfma_f32_16x16x32_bf16 a[40:43], a[216:219], a[112:115], 0
    buffer_load_dwordx4 v9, s[12:15], s25 offen offset:1024 lds
    v_add_f32 v232, v232, v236
    v_mfma_f32_16x16x32_bf16 a[44:47], a[216:219], a[120:123], 0
    v_add_f32 v233, v233, v237
    v_mfma_f32_16x16x32_bf16 a[32:35], a[220:223], a[100:103], a[32:35]
    ds_read_b64_tr_b16 a[196:197], v25 offset:27776
    ds_read_b64_tr_b16 a[198:199], v25 offset:30080
    v_mfma_f32_16x16x32_bf16 a[36:39], a[220:223], a[108:111], a[36:39]
    buffer_load_dwordx4 v10, s[12:15], s25 offen offset:2048 lds
    v_add_f32 v234, v234, v238
    v_mfma_f32_16x16x32_bf16 a[40:43], a[220:223], a[116:119], a[40:43]
    buffer_load_dwordx4 v11, s[12:15], s25 offen offset:3072 lds
    v_add_f32 v235, v235, v239
    v_mfma_f32_16x16x32_bf16 a[44:47], a[220:223], a[124:127], a[44:47]
    s_waitcnt lgkmcnt(7)
    s_add_u32 m0, s23, 77824
    v_cvt_pk_bf16_f32 v232, v232, v233
    v_mfma_f32_16x16x32_bf16 a[48:51], a[224:227], a[96:99], 0
    ds_read_b64_tr_b16 a[200:201], v25 offset:18592
    ds_read_b64_tr_b16 a[202:203], v25 offset:20896
    v_mfma_f32_16x16x32_bf16 a[52:55], a[224:227], a[104:107], 0
    s_waitcnt vmcnt(13)
    ds_read_b128 a[128:131], v28 offset:8192
    v_cvt_pk_bf16_f32 v233, v234, v235
    v_mfma_f32_16x16x32_bf16 a[56:59], a[224:227], a[112:115], 0
    ds_read_b128 a[132:135], v29 offset:8192
    ds_write_b64 v36, v[232:233]
    v_mfma_f32_16x16x32_bf16 a[60:63], a[224:227], a[120:123], 0
    s_waitcnt lgkmcnt(10)
    v_add_f32 v240, v240, v244
    v_mfma_f32_16x16x32_bf16 a[48:51], a[228:231], a[100:103], a[48:51]
    ds_read_b64_tr_b16 a[204:205], v25 offset:27808
    ds_read_b64_tr_b16 a[206:207], v25 offset:30112
    v_mfma_f32_16x16x32_bf16 a[52:55], a[228:231], a[108:111], a[52:55]
    ds_read_b128 a[136:139], v28 offset:10240
    v_add_f32 v241, v241, v245
    v_mfma_f32_16x16x32_bf16 a[56:59], a[228:231], a[116:119], a[56:59]
    ds_read_b128 a[140:143], v29 offset:10240
    v_add_f32 v242, v242, v246
    v_mfma_f32_16x16x32_bf16 a[60:63], a[228:231], a[124:127], a[60:63]
    s_waitcnt lgkmcnt(12)
    v_add_f32 v243, v243, v247
    v_mfma_f32_16x16x32_bf16 a[64:67], a[192:195], a[96:99], 0
    ds_read_b64_tr_b16 a[208:209], v25 offset:192
    ds_read_b64_tr_b16 a[210:211], v25 offset:2496
    v_mfma_f32_16x16x32_bf16 a[68:71], a[192:195], a[104:107], 0
    s_cmp_ge_u32 s21, 4
    s_cbranch_scc1 ut_4
    ds_read_b64_tr_b16 v[44:45], v41 offset:8192
    ds_read_b64_tr_b16 v[46:47], v42 offset:8192
    s_waitcnt lgkmcnt(0)
ut_4:
    v_add_f32 v248, v248, v252
    v_mfma_f32_16x16x32_bf16 a[72:75], a[192:195], a[112:115], 0
    v_add_f32 v249, v249, v253
    v_mfma_f32_16x16x32_bf16 a[76:79], a[192:195], a[120:123], 0
    s_waitcnt lgkmcnt(11)
    v_add_f32 v250, v250, v254
    v_mfma_f32_16x16x32_bf16 a[64:67], a[196:199], a[100:103], a[64:67]
    ds_read_b64_tr_b16 a[212:213], v25 offset:9408
    ds_read_b64_tr_b16 a[214:215], v25 offset:11712
    v_mfma_f32_16x16x32_bf16 a[68:71], a[196:199], a[108:111], a[68:71]
    buffer_load_dwordx4 v12, s[12:15], s25 offen offset:0 lds
    v_add_f32 v251, v251, v255
    v_mfma_f32_16x16x32_bf16 a[72:75], a[196:199], a[116:119], a[72:75]
    buffer_load_dwordx4 v13, s[12:15], s25 offen offset:1024 lds
    v_add_f32 v240, v240, v248
    v_mfma_f32_16x16x32_bf16 a[76:79], a[196:199], a[124:127], a[76:79]
    s_waitcnt lgkmcnt(11)
    v_add_f32 v241, v241, v249
    v_mfma_f32_16x16x32_bf16 a[80:83], a[200:203], a[96:99], 0
    ds_read_b64_tr_b16 a[216:217], v25 offset:18624
    ds_read_b64_tr_b16 a[218:219], v25 offset:20928
    v_mfma_f32_16x16x32_bf16 a[84:87], a[200:203], a[104:107], 0
    buffer_load_dwordx4 v14, s[12:15], s25 offen offset:2048 lds
    v_add_f32 v242, v242, v250
    v_mfma_f32_16x16x32_bf16 a[88:91], a[200:203], a[112:115], 0
    v_add_f32 v243, v243, v251
    v_mfma_f32_16x16x32_bf16 a[92:95], a[200:203], a[120:123], 0
    s_waitcnt lgkmcnt(8)
    v_cvt_pk_bf16_f32 v240, v240, v241
    v_mfma_f32_16x16x32_bf16 a[80:83], a[204:207], a[100:103], a[80:83]
    ds_read_b64_tr_b16 a[220:221], v25 offset:27840
    ds_read_b64_tr_b16 a[222:223], v25 offset:30144
    v_mfma_f32_16x16x32_bf16 a[84:87], a[204:207], a[108:111], a[84:87]
    buffer_load_dwordx4 v15, s[12:15], s25 offen offset:3072 lds
    v_cvt_pk_bf16_f32 v241, v242, v243
    v_mfma_f32_16x16x32_bf16 a[88:91], a[204:207], a[116:119], a[88:91]
    s_add_u32 m0, s23, 81920
    ds_write_b64 v37, v[240:241]
    v_mfma_f32_16x16x32_bf16 a[92:95], a[204:207], a[124:127], a[92:95]
    s_waitcnt lgkmcnt(7)
    s_lshl_b32 s50, s21, 2
    s_add_u32 s50, s50, s20
    v_mfma_f32_16x16x32_bf16 v[160:163], a[208:211], a[96:99], 0
    ds_read_b64_tr_b16 a[224:225], v25 offset:224
    ds_read_b64_tr_b16 a[226:227], v25 offset:2528
    v_mfma_f32_16x16x32_bf16 v[164:167], a[208:211], a[104:107], 0
    ds_read_b64_tr_b16 a[228:229], v25 offset:9440
    s_lshl_b32 s29, s22, 7
    v_mfma_f32_16x16x32_bf16 v[168:171], a[208:211], a[112:115], 0
    ds_read_b64_tr_b16 a[230:231], v25 offset:11744
    s_add_u32 s50, s50, s29
    v_mfma_f32_16x16x32_bf16 v[172:175], a[208:211], a[120:123], 0
    s_waitcnt lgkmcnt(9)
    s_lshl_b32 s56, s50, 7
    s_add_u32 s57, s56, 0x630000
    v_mfma_f32_16x16x32_bf16 v[160:163], a[212:215], a[100:103], v[160:163]
    ds_read_b64_tr_b16 a[192:193], v25 offset:18656
    ds_read_b64_tr_b16 a[194:195], v25 offset:20960
    v_mfma_f32_16x16x32_bf16 v[164:167], a[212:215], a[108:111], v[164:167]
    ds_read_b64_tr_b16 a[196:197], v25 offset:27872
    s_add_u32 s58, s56, 0x690000
    v_mfma_f32_16x16x32_bf16 v[168:171], a[212:215], a[116:119], v[168:171]
    ds_read_b64_tr_b16 a[198:199], v25 offset:30176
    s_add_u32 s56, s56, 0x610000
    v_mfma_f32_16x16x32_bf16 v[172:175], a[212:215], a[124:127], v[172:175]
    s_waitcnt lgkmcnt(11)
    v_and_b32 v6, 31, v0
    v_mfma_f32_16x16x32_bf16 v[176:179], a[216:219], a[96:99], 0
    ds_read_b64_tr_b16 a[200:201], v25 offset:256
    ds_read_b64_tr_b16 a[202:203], v25 offset:2560
    v_mfma_f32_16x16x32_bf16 v[180:183], a[216:219], a[104:107], 0
    ds_read_b64_tr_b16 a[204:205], v25 offset:9472
    v_mul_u32_u24 v31, 12, v6
    v_mfma_f32_16x16x32_bf16 v[184:187], a[216:219], a[112:115], 0
    ds_read_b64_tr_b16 a[206:207], v25 offset:11776
    v_lshrrev_b32 v6, 5, v0
    v_mfma_f32_16x16x32_bf16 v[188:191], a[216:219], a[120:123], 0
    s_waitcnt lgkmcnt(13)
    buffer_load_dwordx4 v16, s[12:15], s25 offen offset:0 lds
    s_movk_i32 s72, 1152
    v_mfma_f32_16x16x32_bf16 v[176:179], a[220:223], a[100:103], v[176:179]
    s_add_u32 m0, s24, 8192
    ds_read_b64_tr_b16 a[208:209], v25 offset:18688
    ds_read_b64_tr_b16 a[210:211], v25 offset:20992
    v_mfma_f32_16x16x32_bf16 v[180:183], a[220:223], a[108:111], v[180:183]
    s_add_u32 s25, s25, 589824
    ds_read_b64_tr_b16 a[212:213], v25 offset:27904
    v_mad_u32_u24 v30, v6, s72, v31
    v_mfma_f32_16x16x32_bf16 v[184:187], a[220:223], a[116:119], v[184:187]
    s_cmp_eq_u32 s25, 5308416
    s_cselect_b32 s25, 0, s25
    ds_read_b64_tr_b16 a[214:215], v25 offset:30208
    v_mfma_f32_16x16x32_bf16 v[188:191], a[220:223], a[124:127], v[188:191]
    s_waitcnt lgkmcnt(14)
    s_mul_i32 s72, s50, 2304
    s_lshl_b32 s73, s50, 3
    v_mfma_f32_16x16x32_bf16 v[192:195], a[224:227], a[96:99], 0
    s_waitcnt vmcnt(15)
    ds_read_b128 a[144:147], v28 offset:0
    ds_read_b128 a[148:151], v29 offset:0
    v_mfma_f32_16x16x32_bf16 v[196:199], a[224:227], a[104:107], 0
    s_add_u32 s73, s73, 0x600000
    v_mfma_f32_16x16x32_bf16 v[200:203], a[224:227], a[112:115], 0
    v_mfma_f32_16x16x32_bf16 v[204:207], a[224:227], a[120:123], 0
    s_waitcnt lgkmcnt(14)
    v_mfma_f32_16x16x32_bf16 v[192:195], a[228:231], a[100:103], v[192:195]
    ds_read_b128 a[152:155], v28 offset:2048
    ds_read_b128 a[156:159], v29 offset:2048
    v_mfma_f32_16x16x32_bf16 v[196:199], a[228:231], a[108:111], v[196:199]
    v_mfma_f32_16x16x32_bf16 v[200:203], a[228:231], a[116:119], v[200:203]
    v_mfma_f32_16x16x32_bf16 v[204:207], a[228:231], a[124:127], v[204:207]
    s_waitcnt lgkmcnt(14)
    v_mfma_f32_16x16x32_bf16 v[208:211], a[192:195], a[96:99], 0
    s_cmp_ge_u32 s21, 4
    s_cbranch_scc1 ut_5
    ds_read_b64_tr_b16 v[48:49], v41 offset:0
    ds_read_b64_tr_b16 v[50:51], v42 offset:0
    s_waitcnt lgkmcnt(0)
    v_permlane32_swap_b32 v44, v48
    v_permlane32_swap_b32 v45, v49
    v_permlane32_swap_b32 v46, v50
    v_permlane32_swap_b32 v47, v51
    buffer_store_dwordx4 v[44:47], v43, s[32:35], s55 offen sc1
    s_add_u32 s55, s55, 32768
    buffer_store_dwordx4 v[48:51], v43, s[32:35], s55 offen sc1
ut_5:
    v_mfma_f32_16x16x32_bf16 v[212:215], a[192:195], a[104:107], 0
    v_mov_b32 v3, 0x7f000000
    v_mfma_f32_16x16x32_bf16 v[216:219], a[192:195], a[112:115], 0
    v_cmp_gt_u32 vcc, 16, v0
    v_mfma_f32_16x16x32_bf16 v[220:223], a[192:195], a[120:123], 0
    s_waitcnt lgkmcnt(12)
    v_lshlrev_b32 v52, 3, v0
    v_mfma_f32_16x16x32_bf16 v[208:211], a[196:199], a[100:103], v[208:211]
    buffer_load_dwordx4 v21, s[8:11], s4 offen offset:0 lds
    buffer_load_dwordx4 v22, s[8:11], s4 offen offset:1024 lds
    v_mfma_f32_16x16x32_bf16 v[212:215], a[196:199], a[108:111], v[212:215]
    v_cndmask_b32 v52, v3, v52, vcc
    v_mfma_f32_16x16x32_bf16 v[216:219], a[196:199], a[116:119], v[216:219]
    v_accvgpr_read_b32 v32, a236
    v_mfma_f32_16x16x32_bf16 v[220:223], a[196:199], a[124:127], v[220:223]
    s_waitcnt lgkmcnt(10)
    v_accvgpr_read_b32 v33, a237
    s_waitcnt lgkmcnt(0)
    s_barrier
    v_mfma_f32_16x16x32_bf16 v[224:227], a[200:203], a[96:99], 0
    ds_read_b64_tr_b16 a[216:217], v26 offset:0
    ds_read_b64_tr_b16 a[218:219], v26 offset:2304
    v_mfma_f32_16x16x32_bf16 v[228:231], a[200:203], a[104:107], 0
    v_accvgpr_read_b32 v34, a238
    v_mfma_f32_16x16x32_bf16 v[232:235], a[200:203], a[112:115], 0
    v_accvgpr_read_b32 v35, a239
    v_mfma_f32_16x16x32_bf16 v[236:239], a[200:203], a[120:123], 0
    v_accvgpr_read_b32 v36, a248
    v_mfma_f32_16x16x32_bf16 v[224:227], a[204:207], a[100:103], v[224:227]
    ds_read_b64_tr_b16 a[220:221], v26 offset:18432
    ds_read_b64_tr_b16 a[222:223], v26 offset:20736
    v_mfma_f32_16x16x32_bf16 v[228:231], a[204:207], a[108:111], v[228:231]
    buffer_load_dwordx4 v23, s[8:11], s4 offen offset:2048 lds
    v_mfma_f32_16x16x32_bf16 v[232:235], a[204:207], a[116:119], v[232:235]
    buffer_load_dwordx4 v24, s[8:11], s4 offen offset:3072 lds
    v_mfma_f32_16x16x32_bf16 v[236:239], a[204:207], a[124:127], v[236:239]
    s_add_u32 m0, s24, 0
    v_accvgpr_read_b32 v37, a249
    v_mfma_f32_16x16x32_bf16 v[240:243], a[208:211], a[96:99], 0
    s_add_u32 s4, s4, 128
    ds_read_b64_tr_b16 a[224:225], v26 offset:32
    ds_read_b64_tr_b16 a[226:227], v26 offset:2336
    v_mfma_f32_16x16x32_bf16 v[244:247], a[208:211], a[104:107], 0
    s_cmp_eq_u32 s4, 1152
    s_cselect_b32 s4, 0, s4
    buffer_load_dwordx4 v17, s[8:11], s4 offen offset:0 lds
    v_mfma_f32_16x16x32_bf16 v[248:251], a[208:211], a[112:115], 0
    buffer_load_dwordx4 v18, s[8:11], s4 offen offset:1024 lds
    v_mfma_f32_16x16x32_bf16 v[252:255], a[208:211], a[120:123], 0
    v_accvgpr_read_b32 v38, a250
    v_mfma_f32_16x16x32_bf16 v[240:243], a[212:215], a[100:103], v[240:243]
    ds_read_b64_tr_b16 a[228:229], v26 offset:18464
    ds_read_b64_tr_b16 a[230:231], v26 offset:20768
    v_mfma_f32_16x16x32_bf16 v[244:247], a[212:215], a[108:111], v[244:247]
    buffer_load_dwordx4 v19, s[8:11], s4 offen offset:2048 lds
    v_mfma_f32_16x16x32_bf16 v[248:251], a[212:215], a[116:119], v[248:251]
    v_accvgpr_read_b32 v39, a251
    v_mfma_f32_16x16x32_bf16 v[252:255], a[212:215], a[124:127], v[252:255]
    s_waitcnt lgkmcnt(6)
    v_accvgpr_read_b32 v40, a252
    v_mfma_f32_16x16x32_bf16 v[64:67], a[216:219], a[128:131], v[64:67]
    ds_read_b64_tr_b16 a[192:193], v26 offset:64
    ds_read_b64_tr_b16 a[194:195], v26 offset:2368
    v_mfma_f32_16x16x32_bf16 v[68:71], a[216:219], a[136:139], v[68:71]
    buffer_load_dwordx4 v20, s[8:11], s4 offen offset:3072 lds
    v_mfma_f32_16x16x32_bf16 v[72:75], a[216:219], a[144:147], v[72:75]
    s_add_u32 m0, s23, 0
    v_accvgpr_read_b32 v54, a253
    v_mfma_f32_16x16x32_bf16 v[76:79], a[216:219], a[152:155], v[76:79]
    s_waitcnt lgkmcnt(6)
    v_accvgpr_read_b32 v55, a254
    v_mfma_f32_16x16x32_bf16 a[0:3], a[220:223], a[128:131], a[0:3]
    ds_read_b64_tr_b16 a[196:197], v26 offset:18496
    ds_read_b64_tr_b16 a[198:199], v26 offset:20800
    v_mfma_f32_16x16x32_bf16 a[4:7], a[220:223], a[136:139], a[4:7]
    s_waitcnt vmcnt(17)
    ds_read_b128 a[160:163], v28 offset:4096
    v_mfma_f32_16x16x32_bf16 a[8:11], a[220:223], a[144:147], a[8:11]
    ds_read_b128 a[164:167], v29 offset:4096
    v_mfma_f32_16x16x32_bf16 a[12:15], a[220:223], a[152:155], a[12:15]
    s_waitcnt lgkmcnt(8)
    buffer_load_dwordx4 v8, s[12:15], s25 offen offset:0 lds
    v_mfma_f32_16x16x32_bf16 v[80:83], a[224:227], a[128:131], v[80:83]
    ds_read_b64_tr_b16 a[200:201], v26 offset:96
    ds_read_b64_tr_b16 a[202:203], v26 offset:2400
    v_mfma_f32_16x16x32_bf16 v[84:87], a[224:227], a[136:139], v[84:87]
    ds_read_b128 a[168:171], v28 offset:6144
    v_mfma_f32_16x16x32_bf16 v[88:91], a[224:227], a[144:147], v[88:91]
    ds_read_b128 a[172:175], v29 offset:6144
    v_mfma_f32_16x16x32_bf16 v[92:95], a[224:227], a[152:155], v[92:95]
    s_waitcnt lgkmcnt(10)
    v_accvgpr_read_b32 v61, a255
    v_mfma_f32_16x16x32_bf16 a[16:19], a[228:231], a[128:131], a[16:19]
    ds_read_b64_tr_b16 a[204:205], v26 offset:18528
    ds_read_b64_tr_b16 a[206:207], v26 offset:20832
    v_mfma_f32_16x16x32_bf16 a[20:23], a[228:231], a[136:139], a[20:23]
    s_and_b32 s29, s22, 3
    v_mfma_f32_16x16x32_bf16 a[24:27], a[228:231], a[144:147], a[24:27]
    s_mul_i32 s29, s29, 288
    v_mfma_f32_16x16x32_bf16 a[28:31], a[228:231], a[152:155], a[28:31]
    s_waitcnt lgkmcnt(10)
    s_and_b32 s30, s50, 31
    v_mfma_f32_16x16x32_bf16 v[96:99], a[192:195], a[128:131], v[96:99]
    ds_read_b64_tr_b16 a[208:209], v26 offset:128
    ds_read_b64_tr_b16 a[210:211], v26 offset:2432
    v_mfma_f32_16x16x32_bf16 v[100:103], a[192:195], a[136:139], v[100:103]
    s_add_u32 s29, s29, s30
    v_mfma_f32_16x16x32_bf16 v[104:107], a[192:195], a[144:147], v[104:107]
    s_mul_i32 s29, s29, 1152
    v_mfma_f32_16x16x32_bf16 v[108:111], a[192:195], a[152:155], v[108:111]
    s_waitcnt lgkmcnt(10)
    s_add_u32 s61, s29, s59
    v_lshrrev_b32 v3, 3, v0
    v_mfma_f32_16x16x32_bf16 a[32:35], a[196:199], a[128:131], a[32:35]
    ds_read_b64_tr_b16 a[212:213], v26 offset:18560
    ds_read_b64_tr_b16 a[214:215], v26 offset:20864
    v_mfma_f32_16x16x32_bf16 a[36:39], a[196:199], a[136:139], a[36:39]
    v_and_b32 v4, 7, v0
    v_mfma_f32_16x16x32_bf16 a[40:43], a[196:199], a[144:147], a[40:43]
    s_mov_b32 s31, 36864
    v_mul_u32_u24 v3, s31, v3
    v_mfma_f32_16x16x32_bf16 a[44:47], a[196:199], a[152:155], a[44:47]
    s_waitcnt lgkmcnt(8)
    v_cmp_gt_u32 vcc, 16, v0
    v_mfma_f32_16x16x32_bf16 v[112:115], a[200:203], a[128:131], v[112:115]
    ds_read_b64_tr_b16 a[216:217], v26 offset:160
    ds_read_b64_tr_b16 a[218:219], v26 offset:2464
    v_mfma_f32_16x16x32_bf16 v[116:119], a[200:203], a[136:139], v[116:119]
    v_lshl_add_u32 v3, v4, 7, v3
    v_mfma_f32_16x16x32_bf16 v[120:123], a[200:203], a[144:147], v[120:123]
    v_mov_b32 v4, 0x7f000000
    v_mfma_f32_16x16x32_bf16 v[124:127], a[200:203], a[152:155], v[124:127]
    s_waitcnt lgkmcnt(6)
    v_cndmask_b32 v56, v4, v3, vcc
    v_mfma_f32_16x16x32_bf16 a[48:51], a[204:207], a[128:131], a[48:51]
    ds_read_b64_tr_b16 a[220:221], v26 offset:18592
    ds_read_b64_tr_b16 a[222:223], v26 offset:20896
    v_mfma_f32_16x16x32_bf16 a[52:55], a[204:207], a[136:139], a[52:55]
    buffer_load_dwordx3 a[96:98], v30, s[8:11], s72 offen offset:0
    buffer_load_dwordx3 a[100:102], v31, s[36:39], 0 offen offset:0
    v_mfma_f32_16x16x32_bf16 a[56:59], a[204:207], a[144:147], a[56:59]
    buffer_load_dwordx3 a[104:106], v30, s[8:11], s72 offen offset:384
    buffer_load_dwordx3 a[108:110], v31, s[36:39], 0 offen offset:384
    v_mfma_f32_16x16x32_bf16 a[60:63], a[204:207], a[152:155], a[60:63]
    s_waitcnt lgkmcnt(6)
    buffer_load_dwordx3 a[112:114], v30, s[8:11], s72 offen offset:768
    buffer_load_dwordx3 a[116:118], v31, s[36:39], 0 offen offset:768
    v_mfma_f32_16x16x32_bf16 v[128:131], a[208:211], a[128:131], v[128:131]
    ds_read_b64_tr_b16 a[224:225], v26 offset:192
    ds_read_b64_tr_b16 a[226:227], v26 offset:2496
    v_mfma_f32_16x16x32_bf16 v[132:135], a[208:211], a[136:139], v[132:135]
    buffer_load_dwordx4 v9, s[12:15], s25 offen offset:1024 lds
    v_mfma_f32_16x16x32_bf16 v[136:139], a[208:211], a[144:147], v[136:139]
    v_mfma_f32_16x16x32_bf16 v[140:143], a[208:211], a[152:155], v[140:143]
    s_waitcnt lgkmcnt(6)
    v_mfma_f32_16x16x32_bf16 a[64:67], a[212:215], a[128:131], a[64:67]
    ds_read_b64_tr_b16 a[228:229], v26 offset:18624
    ds_read_b64_tr_b16 a[230:231], v26 offset:20928
    v_mfma_f32_16x16x32_bf16 a[68:71], a[212:215], a[136:139], a[68:71]
    buffer_load_dwordx4 v10, s[12:15], s25 offen offset:2048 lds
    buffer_load_dword v62, off, s[44:47], 0 sc1
    v_mfma_f32_16x16x32_bf16 a[72:75], a[212:215], a[144:147], a[72:75]
    buffer_load_dwordx4 v11, s[12:15], s25 offen offset:3072 lds
    v_mfma_f32_16x16x32_bf16 a[76:79], a[212:215], a[152:155], a[76:79]
    s_waitcnt lgkmcnt(6)
    s_add_u32 m0, s24, 4096
    v_mfma_f32_16x16x32_bf16 v[144:147], a[216:219], a[128:131], v[144:147]
    ds_read_b64_tr_b16 a[192:193], v26 offset:224
    ds_read_b64_tr_b16 a[194:195], v26 offset:2528
    v_mfma_f32_16x16x32_bf16 v[148:151], a[216:219], a[136:139], v[148:151]
    buffer_load_dwordx4 v21, s[8:11], s4 offen offset:0 lds
    v_mfma_f32_16x16x32_bf16 v[152:155], a[216:219], a[144:147], v[152:155]
    v_mfma_f32_16x16x32_bf16 v[156:159], a[216:219], a[152:155], v[156:159]
    s_waitcnt lgkmcnt(6)
    v_mfma_f32_16x16x32_bf16 a[80:83], a[220:223], a[128:131], a[80:83]
    ds_read_b64_tr_b16 a[196:197], v26 offset:18656
    ds_read_b64_tr_b16 a[198:199], v26 offset:20960
    v_mfma_f32_16x16x32_bf16 a[84:87], a[220:223], a[136:139], a[84:87]
    buffer_load_dwordx4 v22, s[8:11], s4 offen offset:1024 lds
    v_mfma_f32_16x16x32_bf16 a[88:91], a[220:223], a[144:147], a[88:91]
    v_mfma_f32_16x16x32_bf16 a[92:95], a[220:223], a[152:155], a[92:95]
    s_waitcnt lgkmcnt(6)
    v_mfma_f32_16x16x32_bf16 v[160:163], a[224:227], a[128:131], v[160:163]
    ds_read_b64_tr_b16 a[200:201], v26 offset:256
    ds_read_b64_tr_b16 a[202:203], v26 offset:2560
    v_mfma_f32_16x16x32_bf16 v[164:167], a[224:227], a[136:139], v[164:167]
    buffer_load_dwordx4 v23, s[8:11], s4 offen offset:2048 lds
    v_mfma_f32_16x16x32_bf16 v[168:171], a[224:227], a[144:147], v[168:171]
    v_mfma_f32_16x16x32_bf16 v[172:175], a[224:227], a[152:155], v[172:175]
    s_waitcnt lgkmcnt(6)
    v_mfma_f32_16x16x32_bf16 v[176:179], a[228:231], a[128:131], v[176:179]
    ds_read_b64_tr_b16 a[204:205], v26 offset:18688
    ds_read_b64_tr_b16 a[206:207], v26 offset:20992
    v_mfma_f32_16x16x32_bf16 v[180:183], a[228:231], a[136:139], v[180:183]
    buffer_load_dwordx4 v24, s[8:11], s4 offen offset:3072 lds
    v_mfma_f32_16x16x32_bf16 v[184:187], a[228:231], a[144:147], v[184:187]
    s_add_u32 m0, s23, 4096
    v_mfma_f32_16x16x32_bf16 v[188:191], a[228:231], a[152:155], v[188:191]
    s_waitcnt lgkmcnt(6)
    s_add_u32 s4, s4, 128
    v_mfma_f32_16x16x32_bf16 v[192:195], a[192:195], a[128:131], v[192:195]
    s_cmp_eq_u32 s4, 1152
    s_cselect_b32 s4, 0, s4
    ds_read_b64_tr_b16 a[208:209], v26 offset:9216
    ds_read_b64_tr_b16 a[210:211], v26 offset:11520
    v_mfma_f32_16x16x32_bf16 v[196:199], a[192:195], a[136:139], v[196:199]
    buffer_load_dwordx4 v12, s[12:15], s25 offen offset:0 lds
    v_mfma_f32_16x16x32_bf16 v[200:203], a[192:195], a[144:147], v[200:203]
    v_mfma_f32_16x16x32_bf16 v[204:207], a[192:195], a[152:155], v[204:207]
    s_waitcnt lgkmcnt(6)
    v_mfma_f32_16x16x32_bf16 v[208:211], a[196:199], a[128:131], v[208:211]
    ds_read_b64_tr_b16 a[212:213], v26 offset:27648
    ds_read_b64_tr_b16 a[214:215], v26 offset:29952
    v_mfma_f32_16x16x32_bf16 v[212:215], a[196:199], a[136:139], v[212:215]
    v_mfma_f32_16x16x32_bf16 v[216:219], a[196:199], a[144:147], v[216:219]
    v_mfma_f32_16x16x32_bf16 v[220:223], a[196:199], a[152:155], v[220:223]
    s_waitcnt lgkmcnt(6)
    v_mfma_f32_16x16x32_bf16 v[224:227], a[200:203], a[128:131], v[224:227]
    ds_read_b64_tr_b16 a[216:217], v26 offset:9248
    ds_read_b64_tr_b16 a[218:219], v26 offset:11552
    v_mfma_f32_16x16x32_bf16 v[228:231], a[200:203], a[136:139], v[228:231]
    buffer_load_dwordx4 v13, s[12:15], s25 offen offset:1024 lds
    v_mfma_f32_16x16x32_bf16 v[232:235], a[200:203], a[144:147], v[232:235]
    v_mfma_f32_16x16x32_bf16 v[236:239], a[200:203], a[152:155], v[236:239]
    s_waitcnt lgkmcnt(6)
    v_mfma_f32_16x16x32_bf16 v[240:243], a[204:207], a[128:131], v[240:243]
    ds_read_b64_tr_b16 a[220:221], v26 offset:27680
    ds_read_b64_tr_b16 a[222:223], v26 offset:29984
    v_mfma_f32_16x16x32_bf16 v[244:247], a[204:207], a[136:139], v[244:247]
    s_waitcnt vmcnt(21)
    ds_read_b128 a[176:179], v28 offset:8192
    v_mfma_f32_16x16x32_bf16 v[248:251], a[204:207], a[144:147], v[248:251]
    ds_read_b128 a[180:183], v29 offset:8192
    v_mfma_f32_16x16x32_bf16 v[252:255], a[204:207], a[152:155], v[252:255]
    s_waitcnt lgkmcnt(8)
    v_mfma_f32_16x16x32_bf16 v[64:67], a[208:211], a[132:135], v[64:67]
    ds_read_b64_tr_b16 a[224:225], v26 offset:9280
    ds_read_b64_tr_b16 a[226:227], v26 offset:11584
    v_mfma_f32_16x16x32_bf16 v[68:71], a[208:211], a[140:143], v[68:71]
    ds_read_b128 a[184:187], v28 offset:10240
    v_mfma_f32_16x16x32_bf16 v[72:75], a[208:211], a[148:151], v[72:75]
    ds_read_b128 a[188:191], v29 offset:10240
    v_mfma_f32_16x16x32_bf16 v[76:79], a[208:211], a[156:159], v[76:79]
    s_waitcnt lgkmcnt(10)
    v_mfma_f32_16x16x32_bf16 a[0:3], a[212:215], a[132:135], a[0:3]
    ds_read_b64_tr_b16 a[228:229], v26 offset:27712
    ds_read_b64_tr_b16 a[230:231], v26 offset:30016
    v_mfma_f32_16x16x32_bf16 a[4:7], a[212:215], a[140:143], a[4:7]
    buffer_load_dwordx4 v14, s[12:15], s25 offen offset:2048 lds
    v_mfma_f32_16x16x32_bf16 a[8:11], a[212:215], a[148:151], a[8:11]
    v_mfma_f32_16x16x32_bf16 a[12:15], a[212:215], a[156:159], a[12:15]
    s_waitcnt lgkmcnt(10)
    v_mfma_f32_16x16x32_bf16 v[80:83], a[216:219], a[132:135], v[80:83]
    ds_read_b64_tr_b16 a[192:193], v26 offset:9312
    ds_read_b64_tr_b16 a[194:195], v26 offset:11616
    v_mfma_f32_16x16x32_bf16 v[84:87], a[216:219], a[140:143], v[84:87]
    v_mfma_f32_16x16x32_bf16 v[88:91], a[216:219], a[148:151], v[88:91]
    v_mfma_f32_16x16x32_bf16 v[92:95], a[216:219], a[156:159], v[92:95]
    s_waitcnt lgkmcnt(10)
    v_mfma_f32_16x16x32_bf16 a[16:19], a[220:223], a[132:135], a[16:19]
    ds_read_b64_tr_b16 a[196:197], v26 offset:27744
    ds_read_b64_tr_b16 a[198:199], v26 offset:30048
    v_mfma_f32_16x16x32_bf16 a[20:23], a[220:223], a[140:143], a[20:23]
    buffer_load_dwordx4 v15, s[12:15], s25 offen offset:3072 lds
    v_mfma_f32_16x16x32_bf16 a[24:27], a[220:223], a[148:151], a[24:27]
    s_add_u32 m0, s24, 8192
    v_mfma_f32_16x16x32_bf16 a[28:31], a[220:223], a[156:159], a[28:31]
    s_waitcnt lgkmcnt(8)
    v_mfma_f32_16x16x32_bf16 v[96:99], a[224:227], a[132:135], v[96:99]
    ds_read_b64_tr_b16 a[200:201], v26 offset:9344
    ds_read_b64_tr_b16 a[202:203], v26 offset:11648
    v_mfma_f32_16x16x32_bf16 v[100:103], a[224:227], a[140:143], v[100:103]
    v_mov_b32 v2, 0
    v_mfma_f32_16x16x32_bf16 v[104:107], a[224:227], a[148:151], v[104:107]
    s_waitcnt vmcnt(12)
    v_accvgpr_read_b32 v3, a96
    v_mfma_f32_16x16x32_bf16 v[108:111], a[224:227], a[156:159], v[108:111]
    s_waitcnt lgkmcnt(6)
    v_accvgpr_read_b32 v4, a100
    v_mfma_f32_16x16x32_bf16 a[32:35], a[228:231], a[132:135], a[32:35]
    ds_read_b64_tr_b16 a[204:205], v26 offset:27776
    ds_read_b64_tr_b16 a[206:207], v26 offset:30080
    v_mfma_f32_16x16x32_bf16 a[36:39], a[228:231], a[140:143], a[36:39]
    buffer_load_dwordx4 v17, s[8:11], s4 offen offset:0 lds
    v_dot2c_f32_bf16 v2, v3, v4
    v_mfma_f32_16x16x32_bf16 a[40:43], a[228:231], a[148:151], a[40:43]
    v_accvgpr_read_b32 v5, a97
    v_mfma_f32_16x16x32_bf16 a[44:47], a[228:231], a[156:159], a[44:47]
    s_waitcnt lgkmcnt(6)
    v_accvgpr_read_b32 v6, a101
    v_mfma_f32_16x16x32_bf16 v[112:115], a[192:195], a[132:135], v[112:115]
    ds_read_b64_tr_b16 a[208:209], v26 offset:9376
    ds_read_b64_tr_b16 a[210:211], v26 offset:11680
    v_mfma_f32_16x16x32_bf16 v[116:119], a[192:195], a[140:143], v[116:119]
    ds_read_b64_tr_b16 a[212:213], v26 offset:27808
    v_dot2c_f32_bf16 v2, v5, v6
    v_mfma_f32_16x16x32_bf16 v[120:123], a[192:195], a[148:151], v[120:123]
    ds_read_b64_tr_b16 a[214:215], v26 offset:30112
    v_accvgpr_read_b32 v3, a98
    v_mfma_f32_16x16x32_bf16 v[124:127], a[192:195], a[156:159], v[124:127]
    s_waitcnt lgkmcnt(8)
    v_accvgpr_read_b32 v4, a102
    v_mfma_f32_16x16x32_bf16 a[48:51], a[196:199], a[132:135], a[48:51]
    ds_read_b64_tr_b16 a[216:217], v26 offset:9408
    ds_read_b64_tr_b16 a[218:219], v26 offset:11712
    v_mfma_f32_16x16x32_bf16 a[52:55], a[196:199], a[140:143], a[52:55]
    ds_read_b64_tr_b16 a[220:221], v26 offset:27840
    v_dot2c_f32_bf16 v2, v3, v4
    v_mfma_f32_16x16x32_bf16 a[56:59], a[196:199], a[148:151], a[56:59]
    ds_read_b64_tr_b16 a[222:223], v26 offset:30144
    v_accvgpr_read_b32 v5, a104
    v_mfma_f32_16x16x32_bf16 a[60:63], a[196:199], a[156:159], a[60:63]
    s_waitcnt lgkmcnt(10)
    buffer_load_dwordx4 v18, s[8:11], s4 offen offset:1024 lds
    v_accvgpr_read_b32 v6, a108
    v_mfma_f32_16x16x32_bf16 v[128:131], a[200:203], a[132:135], v[128:131]
    ds_read_b64_tr_b16 a[224:225], v26 offset:9440
    ds_read_b64_tr_b16 a[226:227], v26 offset:11744
    v_mfma_f32_16x16x32_bf16 v[132:135], a[200:203], a[140:143], v[132:135]
    ds_read_b64_tr_b16 a[228:229], v26 offset:27872
    v_dot2c_f32_bf16 v2, v5, v6
    v_mfma_f32_16x16x32_bf16 v[136:139], a[200:203], a[148:151], v[136:139]
    ds_read_b64_tr_b16 a[230:231], v26 offset:30176
    v_accvgpr_read_b32 v3, a105
    v_mfma_f32_16x16x32_bf16 v[140:143], a[200:203], a[156:159], v[140:143]
    s_waitcnt lgkmcnt(12)
    v_accvgpr_read_b32 v4, a109
    v_mfma_f32_16x16x32_bf16 a[64:67], a[204:207], a[132:135], a[64:67]
    ds_read_b64_tr_b16 a[192:193], v26 offset:9472
    ds_read_b64_tr_b16 a[194:195], v26 offset:11776
    v_mfma_f32_16x16x32_bf16 a[68:71], a[204:207], a[140:143], a[68:71]
    ds_read_b64_tr_b16 a[196:197], v26 offset:27904
    v_dot2c_f32_bf16 v2, v3, v4
    v_mfma_f32_16x16x32_bf16 a[72:75], a[204:207], a[148:151], a[72:75]
    ds_read_b64_tr_b16 a[198:199], v26 offset:30208
    v_accvgpr_read_b32 v5, a106
    v_mfma_f32_16x16x32_bf16 a[76:79], a[204:207], a[156:159], a[76:79]
    s_waitcnt lgkmcnt(14)
    buffer_load_dwordx4 v19, s[8:11], s4 offen offset:2048 lds
    v_accvgpr_read_b32 v6, a110
    v_mfma_f32_16x16x32_bf16 v[144:147], a[208:211], a[132:135], v[144:147]
    v_dot2c_f32_bf16 v2, v5, v6
    v_mfma_f32_16x16x32_bf16 v[148:151], a[208:211], a[140:143], v[148:151]
    v_accvgpr_read_b32 v3, a112
    v_mfma_f32_16x16x32_bf16 v[152:155], a[208:211], a[148:151], v[152:155]
    v_accvgpr_read_b32 v4, a116
    v_mfma_f32_16x16x32_bf16 v[156:159], a[208:211], a[156:159], v[156:159]
    s_waitcnt lgkmcnt(12)
    v_dot2c_f32_bf16 v2, v3, v4
    v_mfma_f32_16x16x32_bf16 a[80:83], a[212:215], a[132:135], a[80:83]
    buffer_load_dwordx4 v20, s[8:11], s4 offen offset:3072 lds
pad_1:
    s_cbranch_execz pad_5
    v_accvgpr_read_b32 v5, a113
    v_mfma_f32_16x16x32_bf16 a[84:87], a[212:215], a[140:143], a[84:87]
    s_add_u32 m0, s23, 8192
    v_accvgpr_read_b32 v6, a117
    v_mfma_f32_16x16x32_bf16 a[88:91], a[212:215], a[148:151], a[88:91]
    v_dot2c_f32_bf16 v2, v5, v6
    v_mfma_f32_16x16x32_bf16 a[92:95], a[212:215], a[156:159], a[92:95]
    s_waitcnt lgkmcnt(10)
    v_accvgpr_read_b32 v3, a114
    v_mfma_f32_16x16x32_bf16 v[160:163], a[216:219], a[132:135], v[160:163]
    v_accvgpr_read_b32 v4, a118
    v_mfma_f32_16x16x32_bf16 v[164:167], a[216:219], a[140:143], v[164:167]
    v_dot2c_f32_bf16 v2, v3, v4
    v_mfma_f32_16x16x32_bf16 v[168:171], a[216:219], a[148:151], v[168:171]
    v_mfma_f32_16x16x32_bf16 v[172:175], a[216:219], a[156:159], v[172:175]
    s_waitcnt lgkmcnt(8)
    v_mfma_f32_16x16x32_bf16 v[176:179], a[220:223], a[132:135], v[176:179]
    buffer_load_dwordx4 v16, s[12:15], s25 offen offset:0 lds
    v_mfma_f32_16x16x32_bf16 v[180:183], a[220:223], a[140:143], v[180:183]
    s_add_u32 m0, s23, 36864
    v_mfma_f32_16x16x32_bf16 v[184:187], a[220:223], a[148:151], v[184:187]
    s_add_u32 s25, s25, 589824
    v_mfma_f32_16x16x32_bf16 v[188:191], a[220:223], a[156:159], v[188:191]
    s_waitcnt lgkmcnt(6)
    s_cmp_eq_u32 s25, 5308416
    s_cselect_b32 s25, 0, s25
    s_waitcnt lgkmcnt(0)
    s_barrier
    v_mfma_f32_16x16x32_bf16 v[192:195], a[224:227], a[132:135], v[192:195]
    ds_read_b64_tr_b16 a[200:201], v27 offset:0
    ds_read_b64_tr_b16 a[202:203], v27 offset:2304
    v_mfma_f32_16x16x32_bf16 v[196:199], a[224:227], a[140:143], v[196:199]
    v_add_f32_dpp v2, v2, v2 row_shr:1 row_mask:0xf bank_mask:0xf bound_ctrl:0
    v_mfma_f32_16x16x32_bf16 v[200:203], a[224:227], a[148:151], v[200:203]
    s_nop 0
    v_add_f32_dpp v2, v2, v2 row_shr:2 row_mask:0xf bank_mask:0xf bound_ctrl:0
    v_mfma_f32_16x16x32_bf16 v[204:207], a[224:227], a[156:159], v[204:207]
    s_nop 0
    v_add_f32_dpp v2, v2, v2 row_shr:4 row_mask:0xf bank_mask:0xf bound_ctrl:0
    v_mfma_f32_16x16x32_bf16 v[208:211], a[228:231], a[132:135], v[208:211]
    ds_read_b64_tr_b16 a[204:205], v27 offset:18432
    ds_read_b64_tr_b16 a[206:207], v27 offset:20736
    v_mfma_f32_16x16x32_bf16 v[212:215], a[228:231], a[140:143], v[212:215]
    buffer_load_dwordx4 v8, s[12:15], s25 offen offset:0 lds
    v_add_f32_dpp v2, v2, v2 row_shr:8 row_mask:0xf bank_mask:0xf bound_ctrl:0
    v_mfma_f32_16x16x32_bf16 v[216:219], a[228:231], a[148:151], v[216:219]
    s_nop 0
    v_add_f32_dpp v2, v2, v2 row_bcast:15 row_mask:0xa bank_mask:0xf
    v_mfma_f32_16x16x32_bf16 v[220:223], a[228:231], a[156:159], v[220:223]
    v_cvt_pk_bf16_f32 v2, v2, v2
    v_mfma_f32_16x16x32_bf16 v[224:227], a[192:195], a[132:135], v[224:227]
    ds_read_b64_tr_b16 a[208:209], v27 offset:32
    ds_read_b64_tr_b16 a[210:211], v27 offset:2336
    v_mfma_f32_16x16x32_bf16 v[228:231], a[192:195], a[140:143], v[228:231]
    buffer_load_dwordx4 v9, s[12:15], s25 offen offset:1024 lds
    v_lshlrev_b32 v2, 16, v2
    v_mfma_f32_16x16x32_bf16 v[232:235], a[192:195], a[148:151], v[232:235]
    v_mul_f32 v2, 0xbfb8aa3b, v2
    v_mfma_f32_16x16x32_bf16 v[236:239], a[192:195], a[156:159], v[236:239]
    v_exp_f32 v2, v2
    v_mfma_f32_16x16x32_bf16 v[240:243], a[196:199], a[132:135], v[240:243]
    ds_read_b64_tr_b16 a[212:213], v27 offset:18464
    ds_read_b64_tr_b16 a[214:215], v27 offset:20768
    v_mfma_f32_16x16x32_bf16 v[244:247], a[196:199], a[140:143], v[244:247]
    buffer_load_dwordx4 v10, s[12:15], s25 offen offset:2048 lds
    v_add_f32 v2, 1.0, v2
    v_mfma_f32_16x16x32_bf16 v[248:251], a[196:199], a[148:151], v[248:251]
    v_rcp_f32 v2, v2
    v_mfma_f32_16x16x32_bf16 v[252:255], a[196:199], a[156:159], v[252:255]
    s_waitcnt lgkmcnt(6)
    v_cvt_pk_bf16_f32 v2, v2, v2
    v_mfma_f32_16x16x32_bf16 v[64:67], a[200:203], a[160:163], v[64:67]
    ds_read_b64_tr_b16 a[216:217], v27 offset:64
    ds_read_b64_tr_b16 a[218:219], v27 offset:2368
    v_mfma_f32_16x16x32_bf16 v[68:71], a[200:203], a[168:171], v[68:71]
    buffer_load_dwordx4 v11, s[12:15], s25 offen offset:3072 lds
    v_lshlrev_b32 v2, 16, v2
    v_mfma_f32_16x16x32_bf16 v[72:75], a[200:203], a[176:179], v[72:75]
    s_add_u32 m0, s23, 40960
    v_cmp_eq_u32 vcc, 372, v31
    v_mfma_f32_16x16x32_bf16 v[76:79], a[200:203], a[184:187], v[76:79]
    s_waitcnt lgkmcnt(6)
    v_lshrrev_b32 v3, 5, v0
    v_mfma_f32_16x16x32_bf16 a[0:3], a[204:207], a[160:163], a[0:3]
    ds_read_b64_tr_b16 a[220:221], v27 offset:18496
    ds_read_b64_tr_b16 a[222:223], v27 offset:20800
    v_mfma_f32_16x16x32_bf16 a[4:7], a[204:207], a[168:171], a[4:7]
    ds_read_b128 a[96:99], v28 offset:0
    v_mfma_f32_16x16x32_bf16 a[8:11], a[204:207], a[176:179], a[8:11]
    ds_read_b128 a[100:103], v29 offset:0
    v_mfma_f32_16x16x32_bf16 a[12:15], a[204:207], a[184:187], a[12:15]
    s_waitcnt lgkmcnt(8)
    v_lshlrev_b32 v3, 2, v3
    v_mfma_f32_16x16x32_bf16 v[80:83], a[208:211], a[160:163], v[80:83]
    ds_read_b64_tr_b16 a[224:225], v27 offset:96
    ds_read_b64_tr_b16 a[226:227], v27 offset:2400
    v_mfma_f32_16x16x32_bf16 v[84:87], a[208:211], a[168:171], v[84:87]
    ds_read_b128 a[104:107], v28 offset:2048
    v_mfma_f32_16x16x32_bf16 v[88:91], a[208:211], a[176:179], v[88:91]
    ds_read_b128 a[108:111], v29 offset:2048
    v_mfma_f32_16x16x32_bf16 v[92:95], a[208:211], a[184:187], v[92:95]
    s_waitcnt lgkmcnt(10)
    buffer_load_dwordx4 v12, s[12:15], s25 offen offset:0 lds
    v_mfma_f32_16x16x32_bf16 a[16:19], a[212:215], a[160:163], a[16:19]
    ds_read_b64_tr_b16 a[228:229], v27 offset:18528
    ds_read_b64_tr_b16 a[230:231], v27 offset:20832
    v_mfma_f32_16x16x32_bf16 a[20:23], a[212:215], a[168:171], a[20:23]
    s_waitcnt vmcnt(14)
    ds_read_b128 a[112:115], v28 offset:4096
    v_mfma_f32_16x16x32_bf16 a[24:27], a[212:215], a[176:179], a[24:27]
    ds_read_b128 a[116:119], v29 offset:4096
    v_mfma_f32_16x16x32_bf16 a[28:31], a[212:215], a[184:187], a[28:31]
    s_waitcnt lgkmcnt(12)
    buffer_load_dwordx4 v13, s[12:15], s25 offen offset:1024 lds
    v_mfma_f32_16x16x32_bf16 v[96:99], a[216:219], a[160:163], v[96:99]
    ds_read_b64_tr_b16 a[192:193], v27 offset:128
    ds_read_b64_tr_b16 a[194:195], v27 offset:2432
    v_mfma_f32_16x16x32_bf16 v[100:103], a[216:219], a[168:171], v[100:103]
    ds_read_b128 a[120:123], v28 offset:6144
    v_mfma_f32_16x16x32_bf16 v[104:107], a[216:219], a[176:179], v[104:107]
    ds_read_b128 a[124:127], v29 offset:6144
    v_mfma_f32_16x16x32_bf16 v[108:111], a[216:219], a[184:187], v[108:111]
    s_waitcnt lgkmcnt(14)
    buffer_load_dwordx4 v14, s[12:15], s25 offen offset:2048 lds
    v_mfma_f32_16x16x32_bf16 a[32:35], a[220:223], a[160:163], a[32:35]
    s_add_u32 m0, s24, 0
    ds_read_b64_tr_b16 a[196:197], v27 offset:18560
    ds_read_b64_tr_b16 a[198:199], v27 offset:20864
    v_mfma_f32_16x16x32_bf16 a[36:39], a[220:223], a[168:171], a[36:39]
    s_waitcnt lgkmcnt(10)
    buffer_load_dwordx4 v21, s[8:11], s4 offen offset:0 lds
    v_mfma_f32_16x16x32_bf16 a[40:43], a[220:223], a[176:179], a[40:43]
    v_mov_b32 v4, 0x7f000000
    v_mfma_f32_16x16x32_bf16 a[44:47], a[220:223], a[184:187], a[44:47]
    v_cndmask_b32 v3, v4, v3, vcc
    v_mfma_f32_16x16x32_bf16 v[112:115], a[224:227], a[160:163], v[112:115]
    ds_read_b64_tr_b16 a[200:201], v27 offset:160
    ds_read_b64_tr_b16 a[202:203], v27 offset:2464
    v_mfma_f32_16x16x32_bf16 v[116:119], a[224:227], a[168:171], v[116:119]
    buffer_store_dword v2, v3, s[32:35], s73 offen sc1
    v_mfma_f32_16x16x32_bf16 v[120:123], a[224:227], a[176:179], v[120:123]
    s_mul_i32 s29, s21, 9
    v_mfma_f32_16x16x32_bf16 v[124:127], a[224:227], a[184:187], v[124:127]
    s_waitcnt lgkmcnt(10)
    s_add_u32 s29, s29, 1
    v_mfma_f32_16x16x32_bf16 a[48:51], a[228:231], a[160:163], a[48:51]
    ds_read_b64_tr_b16 a[204:205], v27 offset:18592
    ds_read_b64_tr_b16 a[206:207], v27 offset:20896
    v_mfma_f32_16x16x32_bf16 a[52:55], a[228:231], a[168:171], a[52:55]
    buffer_load_dwordx4 v22, s[8:11], s4 offen offset:1024 lds
    v_mfma_f32_16x16x32_bf16 a[56:59], a[228:231], a[176:179], a[56:59]
    s_lshr_b32 s29, s29, 1
    v_mfma_f32_16x16x32_bf16 a[60:63], a[228:231], a[184:187], a[60:63]
    s_waitcnt lgkmcnt(8)
    s_lshl_b32 s29, s29, 12
    v_mfma_f32_16x16x32_bf16 v[128:131], a[192:195], a[160:163], v[128:131]
    ds_read_b64_tr_b16 a[208:209], v27 offset:192
    ds_read_b64_tr_b16 a[210:211], v27 offset:2496
    v_mfma_f32_16x16x32_bf16 v[132:135], a[192:195], a[168:171], v[132:135]
    buffer_load_dwordx4 v23, s[8:11], s4 offen offset:2048 lds
    v_mfma_f32_16x16x32_bf16 v[136:139], a[192:195], a[176:179], v[136:139]
    s_lshl_b32 s30, s22, 2
    v_mfma_f32_16x16x32_bf16 v[140:143], a[192:195], a[184:187], v[140:143]
    s_waitcnt lgkmcnt(6)
    s_add_u32 s30, s30, s20
    v_mfma_f32_16x16x32_bf16 a[64:67], a[196:199], a[160:163], a[64:67]
    ds_read_b64_tr_b16 a[212:213], v27 offset:18624
    ds_read_b64_tr_b16 a[214:215], v27 offset:20928
    v_mfma_f32_16x16x32_bf16 a[68:71], a[196:199], a[168:171], a[68:71]
    buffer_load_dwordx4 v24, s[8:11], s4 offen offset:3072 lds
    v_mfma_f32_16x16x32_bf16 a[72:75], a[196:199], a[176:179], a[72:75]
    s_add_u32 m0, s24, 4096
    v_mfma_f32_16x16x32_bf16 a[76:79], a[196:199], a[184:187], a[76:79]
    s_waitcnt lgkmcnt(6)
    s_add_u32 s4, s4, 128
    v_mfma_f32_16x16x32_bf16 v[144:147], a[200:203], a[160:163], v[144:147]
    s_cmp_eq_u32 s4, 1152
    s_cselect_b32 s4, 0, s4
    ds_read_b64_tr_b16 a[216:217], v27 offset:224
    ds_read_b64_tr_b16 a[218:219], v27 offset:2528
    v_mfma_f32_16x16x32_bf16 v[148:151], a[200:203], a[168:171], v[148:151]
    buffer_load_dwordx4 v17, s[8:11], s4 offen offset:0 lds
    v_mfma_f32_16x16x32_bf16 v[152:155], a[200:203], a[176:179], v[152:155]
    s_mul_i32 s30, s30, 589824
    v_mfma_f32_16x16x32_bf16 v[156:159], a[200:203], a[184:187], v[156:159]
    s_waitcnt lgkmcnt(6)
    s_add_u32 s26, s29, s30
    v_mfma_f32_16x16x32_bf16 a[80:83], a[204:207], a[160:163], a[80:83]
    ds_read_b64_tr_b16 a[220:221], v27 offset:18656
    ds_read_b64_tr_b16 a[222:223], v27 offset:20960
    v_mfma_f32_16x16x32_bf16 a[84:87], a[204:207], a[168:171], a[84:87]
    s_movk_i32 s29, 16384
    v_mfma_f32_16x16x32_bf16 a[88:91], a[204:207], a[176:179], a[88:91]
    s_bitcmp1_b32 s21, 0
    s_cselect_b32 s31, 0xfffff800, s29
    v_mfma_f32_16x16x32_bf16 a[92:95], a[204:207], a[184:187], a[92:95]
    s_waitcnt lgkmcnt(6)
    s_add_u32 s27, s26, s31
    v_mfma_f32_16x16x32_bf16 v[160:163], a[208:211], a[160:163], v[160:163]
    ds_read_b64_tr_b16 a[224:225], v27 offset:256
    ds_read_b64_tr_b16 a[226:227], v27 offset:2560
    v_mfma_f32_16x16x32_bf16 v[164:167], a[208:211], a[168:171], v[164:167]
    buffer_load_dwordx4 v18, s[8:11], s4 offen offset:1024 lds
    v_mfma_f32_16x16x32_bf16 v[168:171], a[208:211], a[176:179], v[168:171]
    s_cmp_lt_u32 s20, 2
    s_cselect_b32 s29, s28, s63
    v_mfma_f32_16x16x32_bf16 v[172:175], a[208:211], a[184:187], v[172:175]
    s_waitcnt lgkmcnt(6)
    s_lshr_b32 s30, s29, 6
    v_mfma_f32_16x16x32_bf16 v[176:179], a[212:215], a[160:163], v[176:179]
    ds_read_b64_tr_b16 a[228:229], v27 offset:18688
    ds_read_b64_tr_b16 a[230:231], v27 offset:20992
    v_mfma_f32_16x16x32_bf16 v[180:183], a[212:215], a[168:171], v[180:183]
    buffer_load_dwordx4 v19, s[8:11], s4 offen offset:2048 lds
    v_mfma_f32_16x16x32_bf16 v[184:187], a[212:215], a[176:179], v[184:187]
    s_bfe_u32 s29, s29, 0x20004
    v_bfe_u32 v5, v0, 2, 2
    v_mfma_f32_16x16x32_bf16 v[188:191], a[212:215], a[184:187], v[188:191]
    s_waitcnt lgkmcnt(6)
    v_mul_u32_u24 v4, 3, v5
    v_mfma_f32_16x16x32_bf16 v[192:195], a[216:219], a[160:163], v[192:195]
    ds_read_b64_tr_b16 a[192:193], v27 offset:9216
    ds_read_b64_tr_b16 a[194:195], v27 offset:11520
    v_mfma_f32_16x16x32_bf16 v[196:199], a[216:219], a[168:171], v[196:199]
    buffer_load_dwordx4 v20, s[8:11], s4 offen offset:3072 lds
    v_mfma_f32_16x16x32_bf16 v[200:203], a[216:219], a[176:179], v[200:203]
    s_add_u32 m0, s23, 40960
    v_sub_u32 v4, s30, v4
    v_mfma_f32_16x16x32_bf16 v[204:207], a[216:219], a[184:187], v[204:207]
    s_waitcnt lgkmcnt(6)
    v_add_u32 v3, 9, v4
    v_mfma_f32_16x16x32_bf16 v[208:211], a[220:223], a[160:163], v[208:211]
    ds_read_b64_tr_b16 a[196:197], v27 offset:27648
    ds_read_b64_tr_b16 a[198:199], v27 offset:29952
    v_mfma_f32_16x16x32_bf16 v[212:215], a[220:223], a[168:171], v[212:215]
    buffer_load_dwordx4 v15, s[12:15], s25 offen offset:3072 lds
    v_mfma_f32_16x16x32_bf16 v[216:219], a[220:223], a[176:179], v[216:219]
    s_add_u32 m0, s23, 45056
    v_min_u32 v4, v4, v3
    v_mfma_f32_16x16x32_bf16 v[220:223], a[220:223], a[184:187], v[220:223]
    s_waitcnt lgkmcnt(6)
    v_and_b32 v4, 7, v4
    v_mfma_f32_16x16x32_bf16 v[224:227], a[224:227], a[160:163], v[224:227]
    ds_read_b64_tr_b16 a[200:201], v27 offset:9248
    ds_read_b64_tr_b16 a[202:203], v27 offset:11552
    v_mfma_f32_16x16x32_bf16 v[228:231], a[224:227], a[168:171], v[228:231]
    s_lshl_b32 s30, s62, 7
    v_mfma_f32_16x16x32_bf16 v[232:235], a[224:227], a[176:179], v[232:235]
    s_add_u32 s29, s29, s30
    v_lshl_add_u32 v3, v4, 2, s29
    v_mfma_f32_16x16x32_bf16 v[236:239], a[224:227], a[184:187], v[236:239]
    s_waitcnt lgkmcnt(6)
    v_lshl_add_u32 v3, v5, 5, v3
    v_mfma_f32_16x16x32_bf16 v[240:243], a[228:231], a[160:163], v[240:243]
    ds_read_b64_tr_b16 a[204:205], v27 offset:27680
    ds_read_b64_tr_b16 a[206:207], v27 offset:29984
    v_mfma_f32_16x16x32_bf16 v[244:247], a[228:231], a[168:171], v[244:247]
    buffer_load_dwordx4 v16, s[12:15], s25 offen offset:0 lds
    v_mfma_f32_16x16x32_bf16 v[248:251], a[228:231], a[176:179], v[248:251]
    s_add_u32 m0, s23, 73728
    v_and_b32 v4, 3, v0
    v_mfma_f32_16x16x32_bf16 v[252:255], a[228:231], a[184:187], v[252:255]
    s_waitcnt lgkmcnt(6)
    s_add_u32 s25, s25, 589824
    v_lshl_add_u32 v3, v3, 2, v4
    v_mfma_f32_16x16x32_bf16 v[64:67], a[192:195], a[164:167], v[64:67]
    s_cmp_eq_u32 s25, 5308416
    s_cselect_b32 s25, 0, s25
    ds_read_b64_tr_b16 a[208:209], v27 offset:9280
    ds_read_b64_tr_b16 a[210:211], v27 offset:11584
    v_mfma_f32_16x16x32_bf16 v[68:71], a[192:195], a[172:175], v[68:71]
    s_mov_b32 s29, 0x610000
    v_lshl_add_u32 v53, v3, 7, s29
    v_mfma_f32_16x16x32_bf16 v[72:75], a[192:195], a[180:183], v[72:75]
    s_and_b32 s84, s21, 1
    v_mfma_f32_16x16x32_bf16 v[76:79], a[192:195], a[188:191], v[76:79]
    s_waitcnt lgkmcnt(6)
    s_lshl_b32 s29, s22, 1
    v_mfma_f32_16x16x32_bf16 a[0:3], a[196:199], a[164:167], a[0:3]
    ds_read_b64_tr_b16 a[212:213], v27 offset:27712
    ds_read_b64_tr_b16 a[214:215], v27 offset:30016
    v_mfma_f32_16x16x32_bf16 a[4:7], a[196:199], a[172:175], a[4:7]
    s_getpc_b64 s[36:37]
    cp_3:
    s_sub_u32 s36, s36, cp_3-kf_kernel
    s_subb_u32 s37, s37, 0
    v_mfma_f32_16x16x32_bf16 a[8:11], a[196:199], a[180:183], a[8:11]
    s_mov_b32 s38, cp_end-kf_kernel
    v_mfma_f32_16x16x32_bf16 a[12:15], a[196:199], a[188:191], a[12:15]
    s_waitcnt lgkmcnt(6)
    s_mov_b32 s39, 0x20000
    v_and_b32 v57, 7, v0
    v_mfma_f32_16x16x32_bf16 v[80:83], a[200:203], a[164:167], v[80:83]
    ds_read_b64_tr_b16 a[216:217], v27 offset:9312
    ds_read_b64_tr_b16 a[218:219], v27 offset:11616
    v_mfma_f32_16x16x32_bf16 v[84:87], a[200:203], a[172:175], v[84:87]
    v_lshl_add_u32 v57, s20, 3, v57
    v_mfma_f32_16x16x32_bf16 v[88:91], a[200:203], a[180:183], v[88:91]
    v_lshlrev_b32 v57, 7, v57
    v_mfma_f32_16x16x32_bf16 v[92:95], a[200:203], a[188:191], v[92:95]
    s_waitcnt lgkmcnt(6)
    buffer_load_dword v57, v57, s[36:39], s3 offen
    v_mfma_f32_16x16x32_bf16 a[16:19], a[204:207], a[164:167], a[16:19]
    ds_read_b64_tr_b16 a[220:221], v27 offset:27744
    ds_read_b64_tr_b16 a[222:223], v27 offset:30048
    v_mfma_f32_16x16x32_bf16 a[20:23], a[204:207], a[172:175], a[20:23]
    s_add_u32 s60, s61, 0
    buffer_load_dword v57, v56, s[40:43], s60 offen
    buffer_load_dwordx4 a[232:235], v54, s[40:43], s94 offen
    v_mfma_f32_16x16x32_bf16 a[24:27], a[204:207], a[180:183], a[24:27]
    s_add_u32 s94, s94, 9216
    buffer_load_dwordx4 a[236:239], v54, s[40:43], s94 offen
    v_mfma_f32_16x16x32_bf16 a[28:31], a[204:207], a[188:191], a[28:31]
    s_waitcnt lgkmcnt(6)
    s_add_u32 s84, s84, s29
    v_mfma_f32_16x16x32_bf16 v[96:99], a[208:211], a[164:167], v[96:99]
    ds_read_b64_tr_b16 a[224:225], v27 offset:9344
    ds_read_b64_tr_b16 a[226:227], v27 offset:11648
    v_mfma_f32_16x16x32_bf16 v[100:103], a[208:211], a[172:175], v[100:103]
    s_lshl_b32 s29, s84, 1
    v_mfma_f32_16x16x32_bf16 v[104:107], a[208:211], a[180:183], v[104:107]
    s_lshr_b32 s30, s20, 1
    v_mfma_f32_16x16x32_bf16 v[108:111], a[208:211], a[188:191], v[108:111]
    s_waitcnt lgkmcnt(6)
    s_add_u32 s29, s29, s30
    v_mfma_f32_16x16x32_bf16 a[32:35], a[212:215], a[164:167], a[32:35]
    ds_read_b64_tr_b16 a[228:229], v27 offset:27776
    ds_read_b64_tr_b16 a[230:231], v27 offset:30080
    v_mfma_f32_16x16x32_bf16 a[36:39], a[212:215], a[172:175], a[36:39]
    s_mul_i32 s85, s29, 589824
    v_mfma_f32_16x16x32_bf16 a[40:43], a[212:215], a[180:183], a[40:43]
    s_and_b32 s29, s29, 3
    v_mfma_f32_16x16x32_bf16 a[44:47], a[212:215], a[188:191], a[44:47]
    s_waitcnt lgkmcnt(6)
    s_lshl_b32 s86, s29, 7
    v_mfma_f32_16x16x32_bf16 v[112:115], a[216:219], a[164:167], v[112:115]
    ds_read_b64_tr_b16 a[192:193], v27 offset:9376
    ds_read_b64_tr_b16 a[194:195], v27 offset:11680
    v_mfma_f32_16x16x32_bf16 v[116:119], a[216:219], a[172:175], v[116:119]
    ds_read_b64_tr_b16 a[196:197], v27 offset:27808
    v_mfma_f32_16x16x32_bf16 v[120:123], a[216:219], a[180:183], v[120:123]
    ds_read_b64_tr_b16 a[198:199], v27 offset:30112
    v_mfma_f32_16x16x32_bf16 v[124:127], a[216:219], a[188:191], v[124:127]
    s_waitcnt lgkmcnt(8)
    s_mul_i32 s30, s82, 147456
    v_mfma_f32_16x16x32_bf16 a[48:51], a[220:223], a[164:167], a[48:51]
    ds_read_b64_tr_b16 a[200:201], v27 offset:9408
    ds_read_b64_tr_b16 a[202:203], v27 offset:11712
    v_mfma_f32_16x16x32_bf16 a[52:55], a[220:223], a[172:175], a[52:55]
    ds_read_b64_tr_b16 a[204:205], v27 offset:27840
    v_mfma_f32_16x16x32_bf16 a[56:59], a[220:223], a[180:183], a[56:59]
    ds_read_b64_tr_b16 a[206:207], v27 offset:30144
    v_mfma_f32_16x16x32_bf16 a[60:63], a[220:223], a[188:191], a[60:63]
    s_waitcnt lgkmcnt(10)
    s_add_u32 s85, s85, s30
    v_mfma_f32_16x16x32_bf16 v[128:131], a[224:227], a[164:167], v[128:131]
    ds_read_b64_tr_b16 a[208:209], v27 offset:9440
    ds_read_b64_tr_b16 a[210:211], v27 offset:11744
    v_mfma_f32_16x16x32_bf16 v[132:135], a[224:227], a[172:175], v[132:135]
    ds_read_b64_tr_b16 a[212:213], v27 offset:27872
    v_mfma_f32_16x16x32_bf16 v[136:139], a[224:227], a[180:183], v[136:139]
    ds_read_b64_tr_b16 a[214:215], v27 offset:30176
    v_mfma_f32_16x16x32_bf16 v[140:143], a[224:227], a[188:191], v[140:143]
    s_waitcnt lgkmcnt(12)
    s_mul_i32 s30, s62, 75776
    v_mfma_f32_16x16x32_bf16 a[64:67], a[228:231], a[164:167], a[64:67]
    ds_read_b64_tr_b16 a[216:217], v27 offset:9472
    ds_read_b64_tr_b16 a[218:219], v27 offset:11776
    v_mfma_f32_16x16x32_bf16 a[68:71], a[228:231], a[172:175], a[68:71]
    ds_read_b64_tr_b16 a[220:221], v27 offset:27904
    v_mfma_f32_16x16x32_bf16 a[72:75], a[228:231], a[180:183], a[72:75]
    ds_read_b64_tr_b16 a[222:223], v27 offset:30208
    v_mfma_f32_16x16x32_bf16 a[76:79], a[228:231], a[188:191], a[76:79]
    s_waitcnt lgkmcnt(14)
    s_add_u32 s85, s85, s30
    v_mfma_f32_16x16x32_bf16 v[144:147], a[192:195], a[164:167], v[144:147]
    s_lshl_b32 s30, s62, 11
    v_mfma_f32_16x16x32_bf16 v[148:151], a[192:195], a[172:175], v[148:151]
    s_add_u32 s86, s86, s30
    v_mfma_f32_16x16x32_bf16 v[152:155], a[192:195], a[180:183], v[152:155]
    s_lshl_b32 s30, s22, 14
    v_mfma_f32_16x16x32_bf16 v[156:159], a[192:195], a[188:191], v[156:159]
    s_waitcnt lgkmcnt(12)
    s_add_u32 s86, s86, s30
    v_mfma_f32_16x16x32_bf16 a[80:83], a[196:199], a[164:167], a[80:83]
    s_lshl_b32 s30, s82, 12
    v_mfma_f32_16x16x32_bf16 a[84:87], a[196:199], a[172:175], a[84:87]
    s_add_u32 s86, s86, s30
    v_mfma_f32_16x16x32_bf16 a[88:91], a[196:199], a[180:183], a[88:91]
    s_add_u32 s86, s86, 0x630000
    v_add_u32 v58, 36864, v1
    v_mfma_f32_16x16x32_bf16 a[92:95], a[196:199], a[188:191], a[92:95]
    s_waitcnt lgkmcnt(10)
    s_lshl_b32 s29, s84, 2
    v_mfma_f32_16x16x32_bf16 v[160:163], a[200:203], a[164:167], v[160:163]
    s_add_u32 s29, s29, s20
    v_mfma_f32_16x16x32_bf16 v[164:167], a[200:203], a[172:175], v[164:167]
    s_lshl_b32 s29, s29, 11
    v_mfma_f32_16x16x32_bf16 v[168:171], a[200:203], a[180:183], v[168:171]
    s_add_u32 s29, s29, 0x610000
    v_cmp_gt_u32 vcc, 16, v0
    v_mfma_f32_16x16x32_bf16 v[172:175], a[200:203], a[188:191], v[172:175]
    s_waitcnt lgkmcnt(8)
    v_and_b32 v3, 15, v0
    v_mfma_f32_16x16x32_bf16 v[176:179], a[204:207], a[164:167], v[176:179]
    v_lshl_add_u32 v3, v3, 7, s29
    v_mfma_f32_16x16x32_bf16 v[180:183], a[204:207], a[172:175], v[180:183]
    v_cndmask_b32 v53, v3, v53, vcc
    v_mfma_f32_16x16x32_bf16 v[184:187], a[204:207], a[180:183], v[184:187]
    v_lshlrev_b32 v59, 3, v0
    v_mfma_f32_16x16x32_bf16 v[188:191], a[204:207], a[188:191], v[188:191]
    s_waitcnt lgkmcnt(6)
    v_add_u32 v60, 36864, v59
    s_waitcnt vmcnt(22) lgkmcnt(0)
    s_barrier
    v_mfma_f32_16x16x32_bf16 v[192:195], a[208:211], a[164:167], v[192:195]
    ds_read_b64_tr_b16 a[224:225], v25 offset:0
    ds_read_b64_tr_b16 a[226:227], v25 offset:2304
    v_mfma_f32_16x16x32_bf16 v[196:199], a[208:211], a[172:175], v[196:199]
    s_and_b32 s5, s2, 3
    v_mfma_f32_16x16x32_bf16 v[200:203], a[208:211], a[180:183], v[200:203]
    s_lshl_b32 s92, s20, 12
    v_mfma_f32_16x16x32_bf16 v[204:207], a[208:211], a[188:191], v[204:207]
    s_add_u32 s92, s92, 147456
    v_lshlrev_b32 v41, 1, v0
    v_mfma_f32_16x16x32_bf16 v[208:211], a[212:215], a[164:167], v[208:211]
    ds_read_b64_tr_b16 a[228:229], v25 offset:18432
    ds_read_b64_tr_b16 a[230:231], v25 offset:20736
    v_mfma_f32_16x16x32_bf16 v[212:215], a[212:215], a[172:175], v[212:215]
    buffer_load_dwordx4 v8, s[12:15], s25 offen offset:0 lds
    v_mfma_f32_16x16x32_bf16 v[216:219], a[212:215], a[180:183], v[216:219]
    v_add_u32 v41, s53, v41
    v_mfma_f32_16x16x32_bf16 v[220:223], a[212:215], a[188:191], v[220:223]
    s_lshl_b32 s29, s62, 7
    v_add_u32 v42, s29, v41
    v_mfma_f32_16x16x32_bf16 v[224:227], a[216:219], a[164:167], v[224:227]
    ds_read_b64_tr_b16 a[192:193], v25 offset:32
    ds_read_b64_tr_b16 a[194:195], v25 offset:2336
    v_mfma_f32_16x16x32_bf16 v[228:231], a[216:219], a[172:175], v[228:231]
    buffer_load_dwordx4 v9, s[12:15], s25 offen offset:1024 lds
    v_mfma_f32_16x16x32_bf16 v[232:235], a[216:219], a[180:183], v[232:235]
    v_cmp_eq_u32 vcc, 0, v0
    v_mfma_f32_16x16x32_bf16 v[236:239], a[216:219], a[188:191], v[236:239]
    v_add_u32 v3, 320, v41
    v_mfma_f32_16x16x32_bf16 v[240:243], a[220:223], a[164:167], v[240:243]
    ds_read_b64_tr_b16 a[196:197], v25 offset:18464
    ds_read_b64_tr_b16 a[198:199], v25 offset:20768
    v_mfma_f32_16x16x32_bf16 v[244:247], a[220:223], a[172:175], v[244:247]
    buffer_load_dwordx4 v10, s[12:15], s25 offen offset:2048 lds
    v_mfma_f32_16x16x32_bf16 v[248:251], a[220:223], a[180:183], v[248:251]
    v_subrev_u32 v4, 194, v41
    v_mfma_f32_16x16x32_bf16 v[252:255], a[220:223], a[188:191], v[252:255]
    s_waitcnt lgkmcnt(6)
    v_cndmask_b32 v43, v41, v3, vcc
    v_mfma_f32_16x16x32_bf16 v[64:67], a[224:227], a[96:99], v[64:67]
    ds_read_b64_tr_b16 a[200:201], v25 offset:64
    ds_read_b64_tr_b16 a[202:203], v25 offset:2368
    v_mfma_f32_16x16x32_bf16 v[68:71], a[224:227], a[104:107], v[68:71]
    buffer_load_dwordx4 v11, s[12:15], s25 offen offset:3072 lds
    v_mfma_f32_16x16x32_bf16 v[72:75], a[224:227], a[112:115], v[72:75]
    s_add_u32 m0, s23, 77824
    v_cndmask_b32 v44, v41, v4, vcc
    v_mfma_f32_16x16x32_bf16 v[76:79], a[224:227], a[120:123], v[76:79]
    s_waitcnt lgkmcnt(6)
    v_and_b32 v3, 1, v0
    v_mfma_f32_16x16x32_bf16 a[0:3], a[228:231], a[96:99], a[0:3]
    ds_read_b64_tr_b16 a[204:205], v25 offset:18496
    ds_read_b64_tr_b16 a[206:207], v25 offset:20800
    v_mfma_f32_16x16x32_bf16 a[4:7], a[228:231], a[104:107], a[4:7]
    ds_read_b128 a[128:131], v28 offset:8192
    v_mfma_f32_16x16x32_bf16 a[8:11], a[228:231], a[112:115], a[8:11]
    ds_read_b128 a[132:135], v29 offset:8192
    v_mfma_f32_16x16x32_bf16 a[12:15], a[228:231], a[120:123], a[12:15]
    s_waitcnt lgkmcnt(8)
    v_and_b32 v4, 62, v0
    v_mfma_f32_16x16x32_bf16 v[80:83], a[192:195], a[96:99], v[80:83]
    ds_read_b64_tr_b16 a[208:209], v25 offset:96
    ds_read_b64_tr_b16 a[210:211], v25 offset:2400
    v_mfma_f32_16x16x32_bf16 v[84:87], a[192:195], a[104:107], v[84:87]
    ds_read_b128 a[136:139], v28 offset:10240
    v_mfma_f32_16x16x32_bf16 v[88:91], a[192:195], a[112:115], v[88:91]
    ds_read_b128 a[140:143], v29 offset:10240
    v_mfma_f32_16x16x32_bf16 v[92:95], a[192:195], a[120:123], v[92:95]
    s_waitcnt lgkmcnt(10)
    buffer_load_dwordx4 v12, s[12:15], s25 offen offset:0 lds
    v_mfma_f32_16x16x32_bf16 a[16:19], a[196:199], a[96:99], a[16:19]
    ds_read_b64_tr_b16 a[212:213], v25 offset:18528
    ds_read_b64_tr_b16 a[214:215], v25 offset:20832
    v_mfma_f32_16x16x32_bf16 a[20:23], a[196:199], a[104:107], a[20:23]
    s_waitcnt vmcnt(15)
    ds_read_b128 a[144:147], v28 offset:0
    v_mfma_f32_16x16x32_bf16 a[24:27], a[196:199], a[112:115], a[24:27]
    ds_read_b128 a[148:151], v29 offset:0
    v_mfma_f32_16x16x32_bf16 a[28:31], a[196:199], a[120:123], a[28:31]
    s_waitcnt lgkmcnt(12)
    buffer_load_dwordx4 v13, s[12:15], s25 offen offset:1024 lds
    v_mfma_f32_16x16x32_bf16 v[96:99], a[200:203], a[96:99], v[96:99]
    ds_read_b64_tr_b16 a[216:217], v25 offset:128
    ds_read_b64_tr_b16 a[218:219], v25 offset:2432
    s_waitcnt vmcnt(6)
    v_mfma_f32_16x16x32_bf16 v[100:103], a[200:203], a[104:107], v[100:103]
    ds_read_b128 a[152:155], v28 offset:2048
    buffer_store_dwordx4 a[232:235], v55, s[16:19], s95 offen sc1
    v_mfma_f32_16x16x32_bf16 v[104:107], a[200:203], a[112:115], v[104:107]
    ds_read_b128 a[156:159], v29 offset:2048
    buffer_store_dwordx4 a[236:239], v55, s[16:19], s95 offen offset:256 sc1
    v_mfma_f32_16x16x32_bf16 v[108:111], a[200:203], a[120:123], v[108:111]
    s_waitcnt lgkmcnt(14)
    buffer_load_dwordx4 v14, s[12:15], s25 offen offset:2048 lds
    v_mfma_f32_16x16x32_bf16 a[32:35], a[204:207], a[96:99], a[32:35]
    s_add_u32 m0, s24, 8192
    ds_read_b64_tr_b16 a[220:221], v25 offset:18560
    ds_read_b64_tr_b16 a[222:223], v25 offset:20864
    v_mfma_f32_16x16x32_bf16 a[36:39], a[204:207], a[104:107], a[36:39]
    s_waitcnt lgkmcnt(10)
    buffer_load_dwordx4 v21, s[8:11], s4 offen offset:0 lds
    v_mfma_f32_16x16x32_bf16 a[40:43], a[204:207], a[112:115], a[40:43]
    v_add_u32 v4, s53, v4
    v_mfma_f32_16x16x32_bf16 a[44:47], a[204:207], a[120:123], a[44:47]
    v_lshlrev_b32 v5, 6, v3
    v_mfma_f32_16x16x32_bf16 v[112:115], a[208:211], a[96:99], v[112:115]
    ds_read_b64_tr_b16 a[224:225], v25 offset:160
    ds_read_b64_tr_b16 a[226:227], v25 offset:2464
    v_mfma_f32_16x16x32_bf16 v[116:119], a[208:211], a[104:107], v[116:119]
    v_sub_u32 v45, v4, v5
    v_mfma_f32_16x16x32_bf16 v[120:123], a[208:211], a[112:115], v[120:123]
    v_mul_u32_u24 v5, 66, v3
    v_mfma_f32_16x16x32_bf16 v[124:127], a[208:211], a[120:123], v[124:127]
    s_waitcnt lgkmcnt(10)
    v_add_u32 v46, v4, v5
    v_mfma_f32_16x16x32_bf16 a[48:51], a[212:215], a[96:99], a[48:51]
    ds_read_b64_tr_b16 a[228:229], v25 offset:18592
    ds_read_b64_tr_b16 a[230:231], v25 offset:20896
    v_mfma_f32_16x16x32_bf16 a[52:55], a[212:215], a[104:107], a[52:55]
    buffer_load_dwordx4 v22, s[8:11], s4 offen offset:1024 lds
    v_mfma_f32_16x16x32_bf16 a[56:59], a[212:215], a[112:115], a[56:59]
    v_lshlrev_b32 v50, 3, v0
    v_mfma_f32_16x16x32_bf16 a[60:63], a[212:215], a[120:123], a[60:63]
    s_waitcnt lgkmcnt(8)
    v_add_u32 v47, s53, v50
    v_mfma_f32_16x16x32_bf16 v[128:131], a[216:219], a[96:99], v[128:131]
    ds_read_b64_tr_b16 a[192:193], v25 offset:192
    ds_read_b64_tr_b16 a[194:195], v25 offset:2496
    v_mfma_f32_16x16x32_bf16 v[132:135], a[216:219], a[104:107], v[132:135]
    buffer_load_dwordx4 v23, s[8:11], s4 offen offset:2048 lds
    v_mfma_f32_16x16x32_bf16 v[136:139], a[216:219], a[112:115], v[136:139]
    v_add_u32 v50, s51, v50
    v_mfma_f32_16x16x32_bf16 v[140:143], a[216:219], a[120:123], v[140:143]
    s_waitcnt lgkmcnt(6)
    v_add_u32 v49, s51, v1
    v_mfma_f32_16x16x32_bf16 a[64:67], a[220:223], a[96:99], a[64:67]
    ds_read_b64_tr_b16 a[196:197], v25 offset:18624
    ds_read_b64_tr_b16 a[198:199], v25 offset:20928
    v_mfma_f32_16x16x32_bf16 a[68:71], a[220:223], a[104:107], a[68:71]
    buffer_load_dwordx4 v24, s[8:11], s4 offen offset:3072 lds
    v_mfma_f32_16x16x32_bf16 a[72:75], a[220:223], a[112:115], a[72:75]
    s_add_u32 m0, s24, 0
    v_mfma_f32_16x16x32_bf16 a[76:79], a[220:223], a[120:123], a[76:79]
    s_waitcnt lgkmcnt(6)
    s_add_u32 s4, s4, 128
    v_mfma_f32_16x16x32_bf16 v[144:147], a[224:227], a[96:99], v[144:147]
    s_cmp_eq_u32 s4, 1152
    s_cselect_b32 s4, 0, s4
    ds_read_b64_tr_b16 a[200:201], v25 offset:224
    ds_read_b64_tr_b16 a[202:203], v25 offset:2528
    v_mfma_f32_16x16x32_bf16 v[148:151], a[224:227], a[104:107], v[148:151]
    buffer_load_dwordx4 v17, s[8:11], s4 offen offset:0 lds
    v_mfma_f32_16x16x32_bf16 v[152:155], a[224:227], a[112:115], v[152:155]
    s_lshl_b32 s29, s62, 10
    v_add_u32 v48, s29, v49
    v_mfma_f32_16x16x32_bf16 v[156:159], a[224:227], a[120:123], v[156:159]
    s_waitcnt lgkmcnt(6)
    v_cmp_eq_u32 vcc, 1, v3
    v_mfma_f32_16x16x32_bf16 a[80:83], a[228:231], a[96:99], a[80:83]
    ds_read_b64_tr_b16 a[204:205], v25 offset:18656
    ds_read_b64_tr_b16 a[206:207], v25 offset:20960
    v_mfma_f32_16x16x32_bf16 a[84:87], a[228:231], a[104:107], a[84:87]
    v_mov_b32 v4, 0x05040100
    v_mfma_f32_16x16x32_bf16 a[88:91], a[228:231], a[112:115], a[88:91]
    v_mov_b32 v5, 0x05040504
    v_mfma_f32_16x16x32_bf16 a[92:95], a[228:231], a[120:123], a[92:95]
    s_waitcnt lgkmcnt(6)
    v_mov_b32 v6, 0x01000100
    v_mfma_f32_16x16x32_bf16 v[160:163], a[192:195], a[96:99], v[160:163]
    ds_read_b64_tr_b16 a[208:209], v25 offset:256
pad_2:
    s_cbranch_execz pad_6
    ds_read_b64_tr_b16 a[210:211], v25 offset:2560
    v_mfma_f32_16x16x32_bf16 v[164:167], a[192:195], a[104:107], v[164:167]
    buffer_load_dwordx4 v18, s[8:11], s4 offen offset:1024 lds
    v_mfma_f32_16x16x32_bf16 v[168:171], a[192:195], a[112:115], v[168:171]
    v_cndmask_b32 v30, v4, v5, vcc
    v_mfma_f32_16x16x32_bf16 v[172:175], a[192:195], a[120:123], v[172:175]
    s_waitcnt lgkmcnt(6)
    v_cndmask_b32 v31, v6, v4, vcc
    v_mfma_f32_16x16x32_bf16 v[176:179], a[196:199], a[96:99], v[176:179]
    ds_read_b64_tr_b16 a[212:213], v25 offset:18688
    ds_read_b64_tr_b16 a[214:215], v25 offset:20992
    v_mfma_f32_16x16x32_bf16 v[180:183], a[196:199], a[104:107], v[180:183]
    buffer_load_dwordx4 v19, s[8:11], s4 offen offset:2048 lds
    v_mfma_f32_16x16x32_bf16 v[184:187], a[196:199], a[112:115], v[184:187]
    v_bfe_u32 v3, v0, 2, 2
    v_mfma_f32_16x16x32_bf16 v[188:191], a[196:199], a[120:123], v[188:191]
    s_waitcnt lgkmcnt(6)
    s_movk_i32 s29, 4160
    v_mul_u32_u24 v3, s29, v3
    v_mfma_f32_16x16x32_bf16 v[192:195], a[200:203], a[96:99], v[192:195]
    ds_read_b64_tr_b16 a[216:217], v25 offset:9216
    ds_read_b64_tr_b16 a[218:219], v25 offset:11520
    v_mfma_f32_16x16x32_bf16 v[196:199], a[200:203], a[104:107], v[196:199]
    buffer_load_dwordx4 v20, s[8:11], s4 offen offset:3072 lds
    v_mfma_f32_16x16x32_bf16 v[200:203], a[200:203], a[112:115], v[200:203]
    s_add_u32 m0, s23, 77824
    v_and_b32 v4, 3, v0
    v_mfma_f32_16x16x32_bf16 v[204:207], a[200:203], a[120:123], v[204:207]
    s_waitcnt lgkmcnt(6)
    v_lshl_add_u32 v2, v4, 3, v3
    v_mfma_f32_16x16x32_bf16 v[208:211], a[204:207], a[96:99], v[208:211]
    ds_read_b64_tr_b16 a[220:221], v25 offset:27648
    ds_read_b64_tr_b16 a[222:223], v25 offset:29952
    v_mfma_f32_16x16x32_bf16 v[212:215], a[204:207], a[104:107], v[212:215]
    buffer_load_dwordx4 v15, s[12:15], s25 offen offset:3072 lds
    v_mfma_f32_16x16x32_bf16 v[216:219], a[204:207], a[112:115], v[216:219]
    s_add_u32 m0, s23, 81920
    v_add_u32 v51, s51, v2
    v_mfma_f32_16x16x32_bf16 v[220:223], a[204:207], a[120:123], v[220:223]
    s_waitcnt lgkmcnt(6)
    s_lshl_b32 s29, s62, 11
    v_mfma_f32_16x16x32_bf16 v[224:227], a[208:211], a[96:99], v[224:227]
    ds_read_b64_tr_b16 a[224:225], v25 offset:9248
    ds_read_b64_tr_b16 a[226:227], v25 offset:11552
    v_mfma_f32_16x16x32_bf16 v[228:231], a[208:211], a[104:107], v[228:231]
    s_lshl_b32 s75, s28, 12
    v_mfma_f32_16x16x32_bf16 v[232:235], a[208:211], a[112:115], v[232:235]
    s_add_u32 s75, s75, s29
    v_mfma_f32_16x16x32_bf16 v[236:239], a[208:211], a[120:123], v[236:239]
    s_waitcnt lgkmcnt(6)
    s_add_u32 s74, s29, s52
    v_mfma_f32_16x16x32_bf16 v[240:243], a[212:215], a[96:99], v[240:243]
    ds_read_b64_tr_b16 a[228:229], v25 offset:27680
    ds_read_b64_tr_b16 a[230:231], v25 offset:29984
    v_mfma_f32_16x16x32_bf16 v[244:247], a[212:215], a[104:107], v[244:247]
    buffer_load_dwordx4 v16, s[12:15], s25 offen offset:0 lds
    v_mfma_f32_16x16x32_bf16 v[248:251], a[212:215], a[112:115], v[248:251]
    s_add_u32 m0, s23, 0
    v_mfma_f32_16x16x32_bf16 v[252:255], a[212:215], a[120:123], v[252:255]
    s_waitcnt lgkmcnt(6)
    s_add_u32 s25, s25, 589824
    v_mfma_f32_16x16x32_bf16 v[64:67], a[216:219], a[100:103], v[64:67]
    s_cmp_eq_u32 s25, 5308416
    s_cselect_b32 s25, 0, s25
    ds_read_b64_tr_b16 a[192:193], v25 offset:9280
    ds_read_b64_tr_b16 a[194:195], v25 offset:11584
    v_mfma_f32_16x16x32_bf16 v[68:71], a[216:219], a[108:111], v[68:71]
    s_add_u32 s74, s74, 512
    v_mfma_f32_16x16x32_bf16 v[72:75], a[216:219], a[116:119], v[72:75]
    s_lshl_b32 s29, s20, 10
    v_mfma_f32_16x16x32_bf16 v[76:79], a[216:219], a[124:127], v[76:79]
    s_waitcnt lgkmcnt(6)
    s_lshl_b32 s77, s63, 12
    v_mfma_f32_16x16x32_bf16 a[0:3], a[220:223], a[100:103], a[0:3]
    ds_read_b64_tr_b16 a[196:197], v25 offset:27712
    ds_read_b64_tr_b16 a[198:199], v25 offset:30016
    v_mfma_f32_16x16x32_bf16 a[4:7], a[220:223], a[108:111], a[4:7]
    s_waitcnt vmcnt(11)
    v_cmp_eq_u32 vcc, 0, v62
    s_nop 0
    s_cbranch_vccnz dbs_6
dbr_7:
    v_not_b32 v63, v62
    v_mfma_f32_16x16x32_bf16 a[8:11], a[220:223], a[116:119], a[8:11]
    buffer_store_dwordx2 v[62:63], v52, s[32:35], s56 offen sc1
    v_mfma_f32_16x16x32_bf16 a[12:15], a[220:223], a[124:127], a[12:15]
    s_waitcnt lgkmcnt(6)
    s_add_u32 s77, s77, s29
    v_mfma_f32_16x16x32_bf16 v[80:83], a[224:227], a[100:103], v[80:83]
    ds_read_b64_tr_b16 a[200:201], v25 offset:9312
    ds_read_b64_tr_b16 a[202:203], v25 offset:11616
    v_mfma_f32_16x16x32_bf16 v[84:87], a[224:227], a[108:111], v[84:87]
    s_add_u32 s60, s61, 73728
    buffer_load_dword v57, v56, s[40:43], s60 offen
    v_mfma_f32_16x16x32_bf16 v[88:91], a[224:227], a[116:119], v[88:91]
    s_add_u32 s76, s29, 90880
    v_mfma_f32_16x16x32_bf16 v[92:95], a[224:227], a[124:127], v[92:95]
    s_waitcnt lgkmcnt(6)
    s_mov_b32 s80, 0x01000100
    v_mfma_f32_16x16x32_bf16 a[16:19], a[228:231], a[100:103], a[16:19]
    ds_read_b64_tr_b16 a[204:205], v25 offset:27744
    ds_read_b64_tr_b16 a[206:207], v25 offset:30048
    v_mfma_f32_16x16x32_bf16 a[20:23], a[228:231], a[108:111], a[20:23]
    s_mov_b32 s81, 0x05040504
    v_mfma_f32_16x16x32_bf16 a[24:27], a[228:231], a[116:119], a[24:27]
    s_xor_b32 s78, s62, 1
    v_mfma_f32_16x16x32_bf16 a[28:31], a[228:231], a[124:127], a[28:31]
    s_waitcnt lgkmcnt(6)
    s_mov_b32 s79, 0
    v_mfma_f32_16x16x32_bf16 v[96:99], a[192:195], a[100:103], v[96:99]
    ds_read_b64_tr_b16 a[208:209], v25 offset:9344
    ds_read_b64_tr_b16 a[210:211], v25 offset:11648
    v_mfma_f32_16x16x32_bf16 v[100:103], a[192:195], a[108:111], v[100:103]
    s_lshl_b32 s29, s62, 6
    v_and_b32 v2, 1, v0
    v_mfma_f32_16x16x32_bf16 v[104:107], a[192:195], a[116:119], v[104:107]
    v_lshlrev_b32 v2, 4, v2
    v_mfma_f32_16x16x32_bf16 v[108:111], a[192:195], a[124:127], v[108:111]
    s_waitcnt lgkmcnt(6)
    v_lshlrev_b32 v2, v2, s96
    v_mfma_f32_16x16x32_bf16 a[32:35], a[196:199], a[100:103], a[32:35]
    ds_read_b64_tr_b16 a[212:213], v25 offset:27776
    ds_read_b64_tr_b16 a[214:215], v25 offset:30080
    v_mfma_f32_16x16x32_bf16 a[36:39], a[196:199], a[108:111], a[36:39]
    v_lshrrev_b32 v3, 4, v0
    v_mfma_f32_16x16x32_bf16 a[40:43], a[196:199], a[116:119], a[40:43]
    v_lshlrev_b32 v3, 3, v3
    v_mfma_f32_16x16x32_bf16 a[44:47], a[196:199], a[124:127], a[44:47]
    s_waitcnt lgkmcnt(6)
    v_and_b32 v4, 15, v0
    v_mfma_f32_16x16x32_bf16 v[112:115], a[200:203], a[100:103], v[112:115]
    ds_read_b64_tr_b16 a[216:217], v25 offset:9376
    ds_read_b64_tr_b16 a[218:219], v25 offset:11680
    v_mfma_f32_16x16x32_bf16 v[116:119], a[200:203], a[108:111], v[116:119]
    ds_read_b64_tr_b16 a[220:221], v25 offset:27808
    v_mfma_f32_16x16x32_bf16 v[120:123], a[200:203], a[116:119], v[120:123]
    ds_read_b64_tr_b16 a[222:223], v25 offset:30112
    v_mfma_f32_16x16x32_bf16 v[124:127], a[200:203], a[124:127], v[124:127]
    s_waitcnt lgkmcnt(8)
    v_sub_u32 v3, v4, v3
    v_mfma_f32_16x16x32_bf16 a[48:51], a[204:207], a[100:103], a[48:51]
    ds_read_b64_tr_b16 a[224:225], v25 offset:9408
    ds_read_b64_tr_b16 a[226:227], v25 offset:11712
    v_mfma_f32_16x16x32_bf16 a[52:55], a[204:207], a[108:111], a[52:55]
    ds_read_b64_tr_b16 a[228:229], v25 offset:27840
    v_mfma_f32_16x16x32_bf16 a[56:59], a[204:207], a[116:119], a[56:59]
    ds_read_b64_tr_b16 a[230:231], v25 offset:30144
    v_mfma_f32_16x16x32_bf16 a[60:63], a[204:207], a[124:127], a[60:63]
    s_waitcnt lgkmcnt(10)
    v_add_u32 v3, 16, v3
    v_mfma_f32_16x16x32_bf16 v[128:131], a[208:211], a[100:103], v[128:131]
    ds_read_b64_tr_b16 a[192:193], v25 offset:9440
    ds_read_b64_tr_b16 a[194:195], v25 offset:11744
    v_mfma_f32_16x16x32_bf16 v[132:135], a[208:211], a[108:111], v[132:135]
    ds_read_b64_tr_b16 a[196:197], v25 offset:27872
    v_mfma_f32_16x16x32_bf16 v[136:139], a[208:211], a[116:119], v[136:139]
    ds_read_b64_tr_b16 a[198:199], v25 offset:30176
    v_mfma_f32_16x16x32_bf16 v[140:143], a[208:211], a[124:127], v[140:143]
    s_waitcnt lgkmcnt(12)
    v_ashrrev_i32 v3, 1, v3
    v_mfma_f32_16x16x32_bf16 a[64:67], a[212:215], a[100:103], a[64:67]
    ds_read_b64_tr_b16 a[200:201], v25 offset:9472
    ds_read_b64_tr_b16 a[202:203], v25 offset:11776
    v_mfma_f32_16x16x32_bf16 a[68:71], a[212:215], a[108:111], a[68:71]
    ds_read_b64_tr_b16 a[204:205], v25 offset:27904
    v_mfma_f32_16x16x32_bf16 a[72:75], a[212:215], a[116:119], a[72:75]
    ds_read_b64_tr_b16 a[206:207], v25 offset:30208
    v_mfma_f32_16x16x32_bf16 a[76:79], a[212:215], a[124:127], a[76:79]
    s_waitcnt lgkmcnt(14)
    v_add_u32 v3, s29, v3
    v_mfma_f32_16x16x32_bf16 v[144:147], a[216:219], a[100:103], v[144:147]
    v_cmp_eq_u32 vcc, 0, v3
    v_mfma_f32_16x16x32_bf16 v[148:151], a[216:219], a[108:111], v[148:151]
    s_nop 0
    v_cndmask_b32 v4, 0, v2, vcc
    v_mfma_f32_16x16x32_bf16 v[152:155], a[216:219], a[116:119], v[152:155]
    v_accvgpr_write_b32 a240, v4
    v_mfma_f32_16x16x32_bf16 v[156:159], a[216:219], a[124:127], v[156:159]
    s_waitcnt lgkmcnt(12)
    v_cmp_eq_u32 vcc, 1, v3
    v_mfma_f32_16x16x32_bf16 a[80:83], a[220:223], a[100:103], a[80:83]
    s_nop 0
    v_cndmask_b32 v4, 0, v2, vcc
    v_mfma_f32_16x16x32_bf16 a[84:87], a[220:223], a[108:111], a[84:87]
    v_accvgpr_write_b32 a241, v4
    v_mfma_f32_16x16x32_bf16 a[88:91], a[220:223], a[116:119], a[88:91]
    v_cmp_eq_u32 vcc, 2, v3
    v_mfma_f32_16x16x32_bf16 a[92:95], a[220:223], a[124:127], a[92:95]
    s_waitcnt lgkmcnt(10)
    v_cndmask_b32 v4, 0, v2, vcc
    v_mfma_f32_16x16x32_bf16 v[160:163], a[224:227], a[100:103], v[160:163]
    v_accvgpr_write_b32 a242, v4
    v_mfma_f32_16x16x32_bf16 v[164:167], a[224:227], a[108:111], v[164:167]
    v_cmp_eq_u32 vcc, 3, v3
    v_mfma_f32_16x16x32_bf16 v[168:171], a[224:227], a[116:119], v[168:171]
    s_nop 0
    v_cndmask_b32 v4, 0, v2, vcc
    v_mfma_f32_16x16x32_bf16 v[172:175], a[224:227], a[124:127], v[172:175]
    s_waitcnt lgkmcnt(8)
    v_accvgpr_write_b32 a243, v4
    v_mfma_f32_16x16x32_bf16 v[176:179], a[228:231], a[100:103], v[176:179]
    s_lshl_b32 s29, s20, 6
    v_and_b32 v2, 1, v0
    v_mfma_f32_16x16x32_bf16 v[180:183], a[228:231], a[108:111], v[180:183]
    v_lshlrev_b32 v2, 4, v2
    v_mfma_f32_16x16x32_bf16 v[184:187], a[228:231], a[116:119], v[184:187]
    v_lshlrev_b32 v2, v2, s97
    v_mfma_f32_16x16x32_bf16 v[188:191], a[228:231], a[124:127], v[188:191]
    s_waitcnt lgkmcnt(6)
    v_lshrrev_b32 v3, 4, v0
    s_waitcnt lgkmcnt(0)
    s_barrier
    v_mfma_f32_16x16x32_bf16 v[192:195], a[192:195], a[100:103], v[192:195]
    ds_read_b64_tr_b16 a[208:209], v26 offset:0
    ds_read_b64_tr_b16 a[210:211], v26 offset:2304
    v_mfma_f32_16x16x32_bf16 v[196:199], a[192:195], a[108:111], v[196:199]
    v_lshlrev_b32 v3, 3, v3
    v_mfma_f32_16x16x32_bf16 v[200:203], a[192:195], a[116:119], v[200:203]
    v_and_b32 v4, 15, v0
    v_mfma_f32_16x16x32_bf16 v[204:207], a[192:195], a[124:127], v[204:207]
    v_sub_u32 v3, v4, v3
    v_mfma_f32_16x16x32_bf16 v[208:211], a[196:199], a[100:103], v[208:211]
    ds_read_b64_tr_b16 a[212:213], v26 offset:18432
    ds_read_b64_tr_b16 a[214:215], v26 offset:20736
    v_mfma_f32_16x16x32_bf16 v[212:215], a[196:199], a[108:111], v[212:215]
    buffer_load_dwordx4 v8, s[12:15], s25 offen offset:0 lds
    v_mfma_f32_16x16x32_bf16 v[216:219], a[196:199], a[116:119], v[216:219]
    v_add_u32 v3, 16, v3
    v_mfma_f32_16x16x32_bf16 v[220:223], a[196:199], a[124:127], v[220:223]
    v_ashrrev_i32 v3, 1, v3
    v_mfma_f32_16x16x32_bf16 v[224:227], a[200:203], a[100:103], v[224:227]
    ds_read_b64_tr_b16 a[216:217], v26 offset:32
    ds_read_b64_tr_b16 a[218:219], v26 offset:2336
    v_mfma_f32_16x16x32_bf16 v[228:231], a[200:203], a[108:111], v[228:231]
    buffer_load_dwordx4 v9, s[12:15], s25 offen offset:1024 lds
    v_mfma_f32_16x16x32_bf16 v[232:235], a[200:203], a[116:119], v[232:235]
    v_add_u32 v3, s29, v3
    v_mfma_f32_16x16x32_bf16 v[236:239], a[200:203], a[124:127], v[236:239]
    v_cmp_eq_u32 vcc, 0, v3
    v_mfma_f32_16x16x32_bf16 v[240:243], a[204:207], a[100:103], v[240:243]
    ds_read_b64_tr_b16 a[220:221], v26 offset:18464
    ds_read_b64_tr_b16 a[222:223], v26 offset:20768
    v_mfma_f32_16x16x32_bf16 v[244:247], a[204:207], a[108:111], v[244:247]
    buffer_load_dwordx4 v10, s[12:15], s25 offen offset:2048 lds
    v_mfma_f32_16x16x32_bf16 v[248:251], a[204:207], a[116:119], v[248:251]
    v_cndmask_b32 v4, 0, v2, vcc
    v_mfma_f32_16x16x32_bf16 v[252:255], a[204:207], a[124:127], v[252:255]
    s_waitcnt lgkmcnt(6)
    v_accvgpr_write_b32 a244, v4
    v_mfma_f32_16x16x32_bf16 v[64:67], a[208:211], a[128:131], v[64:67]
    ds_read_b64_tr_b16 a[224:225], v26 offset:64
    ds_read_b64_tr_b16 a[226:227], v26 offset:2368
    v_mfma_f32_16x16x32_bf16 v[68:71], a[208:211], a[136:139], v[68:71]
    buffer_load_dwordx4 v11, s[12:15], s25 offen offset:3072 lds
    v_mfma_f32_16x16x32_bf16 v[72:75], a[208:211], a[144:147], v[72:75]
    s_add_u32 m0, s23, 4096
    v_cmp_eq_u32 vcc, 1, v3
    v_mfma_f32_16x16x32_bf16 v[76:79], a[208:211], a[152:155], v[76:79]
    s_waitcnt lgkmcnt(6)
    v_cndmask_b32 v4, 0, v2, vcc
    v_mfma_f32_16x16x32_bf16 a[0:3], a[212:215], a[128:131], a[0:3]
    ds_read_b64_tr_b16 a[228:229], v26 offset:18496
    ds_read_b64_tr_b16 a[230:231], v26 offset:20800
    v_mfma_f32_16x16x32_bf16 a[4:7], a[212:215], a[136:139], a[4:7]
    ds_read_b128 a[160:163], v28 offset:4096
    v_mfma_f32_16x16x32_bf16 a[8:11], a[212:215], a[144:147], a[8:11]
    ds_read_b128 a[164:167], v29 offset:4096
    v_mfma_f32_16x16x32_bf16 a[12:15], a[212:215], a[152:155], a[12:15]
    s_waitcnt lgkmcnt(8)
    v_accvgpr_write_b32 a245, v4
    v_mfma_f32_16x16x32_bf16 v[80:83], a[216:219], a[128:131], v[80:83]
    ds_read_b64_tr_b16 a[192:193], v26 offset:96
    ds_read_b64_tr_b16 a[194:195], v26 offset:2400
    v_mfma_f32_16x16x32_bf16 v[84:87], a[216:219], a[136:139], v[84:87]
    ds_read_b128 a[168:171], v28 offset:6144
    v_mfma_f32_16x16x32_bf16 v[88:91], a[216:219], a[144:147], v[88:91]
    ds_read_b128 a[172:175], v29 offset:6144
    v_mfma_f32_16x16x32_bf16 v[92:95], a[216:219], a[152:155], v[92:95]
    s_waitcnt lgkmcnt(10)
    buffer_load_dwordx4 v12, s[12:15], s25 offen offset:0 lds
    v_mfma_f32_16x16x32_bf16 a[16:19], a[220:223], a[128:131], a[16:19]
    ds_read_b64_tr_b16 a[196:197], v26 offset:18528
    ds_read_b64_tr_b16 a[198:199], v26 offset:20832
    v_mfma_f32_16x16x32_bf16 a[20:23], a[220:223], a[136:139], a[20:23]
    s_waitcnt vmcnt(13)
    ds_read_b128 a[176:179], v28 offset:8192
    v_mfma_f32_16x16x32_bf16 a[24:27], a[220:223], a[144:147], a[24:27]
    ds_read_b128 a[180:183], v29 offset:8192
    v_mfma_f32_16x16x32_bf16 a[28:31], a[220:223], a[152:155], a[28:31]
    s_waitcnt lgkmcnt(12)
    buffer_load_dwordx4 v13, s[12:15], s25 offen offset:1024 lds
    v_mfma_f32_16x16x32_bf16 v[96:99], a[224:227], a[128:131], v[96:99]
    ds_read_b64_tr_b16 a[200:201], v26 offset:128
    ds_read_b64_tr_b16 a[202:203], v26 offset:2432
    v_mfma_f32_16x16x32_bf16 v[100:103], a[224:227], a[136:139], v[100:103]
    ds_read_b128 a[184:187], v28 offset:10240
    v_mfma_f32_16x16x32_bf16 v[104:107], a[224:227], a[144:147], v[104:107]
    ds_read_b128 a[188:191], v29 offset:10240
    v_mfma_f32_16x16x32_bf16 v[108:111], a[224:227], a[152:155], v[108:111]
    s_waitcnt lgkmcnt(14)
    buffer_load_dwordx4 v14, s[12:15], s25 offen offset:2048 lds
    v_mfma_f32_16x16x32_bf16 a[32:35], a[228:231], a[128:131], a[32:35]
    s_add_u32 m0, s24, 4096
    ds_read_b64_tr_b16 a[204:205], v26 offset:18560
    ds_read_b64_tr_b16 a[206:207], v26 offset:20864
    v_mfma_f32_16x16x32_bf16 a[36:39], a[228:231], a[136:139], a[36:39]
    s_waitcnt lgkmcnt(10)
    buffer_load_dwordx4 v21, s[8:11], s4 offen offset:0 lds
    v_mfma_f32_16x16x32_bf16 a[40:43], a[228:231], a[144:147], a[40:43]
    v_cmp_eq_u32 vcc, 2, v3
    v_mfma_f32_16x16x32_bf16 a[44:47], a[228:231], a[152:155], a[44:47]
    s_nop 0
    v_cndmask_b32 v4, 0, v2, vcc
    v_mfma_f32_16x16x32_bf16 v[112:115], a[192:195], a[128:131], v[112:115]
    ds_read_b64_tr_b16 a[208:209], v26 offset:160
    ds_read_b64_tr_b16 a[210:211], v26 offset:2464
    v_mfma_f32_16x16x32_bf16 v[116:119], a[192:195], a[136:139], v[116:119]
    v_accvgpr_write_b32 a246, v4
    v_mfma_f32_16x16x32_bf16 v[120:123], a[192:195], a[144:147], v[120:123]
    v_cmp_eq_u32 vcc, 3, v3
    v_mfma_f32_16x16x32_bf16 v[124:127], a[192:195], a[152:155], v[124:127]
    s_waitcnt lgkmcnt(10)
    v_cndmask_b32 v4, 0, v2, vcc
    v_mfma_f32_16x16x32_bf16 a[48:51], a[196:199], a[128:131], a[48:51]
    ds_read_b64_tr_b16 a[212:213], v26 offset:18592
    ds_read_b64_tr_b16 a[214:215], v26 offset:20896
    v_mfma_f32_16x16x32_bf16 a[52:55], a[196:199], a[136:139], a[52:55]
    buffer_load_dwordx4 v22, s[8:11], s4 offen offset:1024 lds
    v_mfma_f32_16x16x32_bf16 a[56:59], a[196:199], a[144:147], a[56:59]
    v_accvgpr_write_b32 a247, v4
    v_mfma_f32_16x16x32_bf16 a[60:63], a[196:199], a[152:155], a[60:63]
    s_waitcnt lgkmcnt(8)
    s_mul_i32 s29, s83, 147456
    v_mfma_f32_16x16x32_bf16 v[128:131], a[200:203], a[128:131], v[128:131]
    ds_read_b64_tr_b16 a[216:217], v26 offset:192
    ds_read_b64_tr_b16 a[218:219], v26 offset:2496
    v_mfma_f32_16x16x32_bf16 v[132:135], a[200:203], a[136:139], v[132:135]
    buffer_load_dwordx4 v23, s[8:11], s4 offen offset:2048 lds
    v_mfma_f32_16x16x32_bf16 v[136:139], a[200:203], a[144:147], v[136:139]
    s_mul_i32 s30, s82, 36864
    v_mfma_f32_16x16x32_bf16 v[140:143], a[200:203], a[152:155], v[140:143]
    s_waitcnt lgkmcnt(6)
    s_add_u32 s29, s29, s30
    v_mfma_f32_16x16x32_bf16 a[64:67], a[204:207], a[128:131], a[64:67]
    ds_read_b64_tr_b16 a[220:221], v26 offset:18624
    ds_read_b64_tr_b16 a[222:223], v26 offset:20928
    v_mfma_f32_16x16x32_bf16 a[68:71], a[204:207], a[136:139], a[68:71]
    buffer_load_dwordx4 v24, s[8:11], s4 offen offset:3072 lds
    v_mfma_f32_16x16x32_bf16 a[72:75], a[204:207], a[144:147], a[72:75]
    s_add_u32 m0, s24, 8192
    v_mfma_f32_16x16x32_bf16 a[76:79], a[204:207], a[152:155], a[76:79]
    s_waitcnt lgkmcnt(6)
    s_add_u32 s4, s4, 128
    v_mfma_f32_16x16x32_bf16 v[144:147], a[208:211], a[128:131], v[144:147]
    s_cmp_eq_u32 s4, 1152
    s_cselect_b32 s4, 0, s4
    ds_read_b64_tr_b16 a[224:225], v26 offset:224
    ds_read_b64_tr_b16 a[226:227], v26 offset:2528
    v_mfma_f32_16x16x32_bf16 v[148:151], a[208:211], a[136:139], v[148:151]
    buffer_load_dwordx4 v17, s[8:11], s4 offen offset:0 lds
    v_mfma_f32_16x16x32_bf16 v[152:155], a[208:211], a[144:147], v[152:155]
    s_add_u32 s29, s29, s23
    v_mfma_f32_16x16x32_bf16 v[156:159], a[208:211], a[152:155], v[156:159]
    s_waitcnt lgkmcnt(6)
    s_add_u32 s3, s29, 18874368
    v_mfma_f32_16x16x32_bf16 a[80:83], a[212:215], a[128:131], a[80:83]
    ds_read_b64_tr_b16 a[228:229], v26 offset:18656
    ds_read_b64_tr_b16 a[230:231], v26 offset:20960
    v_mfma_f32_16x16x32_bf16 a[84:87], a[212:215], a[136:139], a[84:87]
    s_and_b32 s29, s84, 7
    v_mfma_f32_16x16x32_bf16 a[88:91], a[212:215], a[144:147], a[88:91]
    s_mul_i32 s29, s29, 1152
    v_mfma_f32_16x16x32_bf16 a[92:95], a[212:215], a[152:155], a[92:95]
    s_waitcnt lgkmcnt(6)
    s_add_u32 s87, s3, s29
    v_mfma_f32_16x16x32_bf16 v[160:163], a[216:219], a[128:131], v[160:163]
    ds_read_b64_tr_b16 a[192:193], v26 offset:256
    ds_read_b64_tr_b16 a[194:195], v26 offset:2560
    v_mfma_f32_16x16x32_bf16 v[164:167], a[216:219], a[136:139], v[164:167]
    buffer_load_dwordx4 v18, s[8:11], s4 offen offset:1024 lds
    v_mfma_f32_16x16x32_bf16 v[168:171], a[216:219], a[144:147], v[168:171]
    s_lshl_b32 s72, s84, 2
    v_mfma_f32_16x16x32_bf16 v[172:175], a[216:219], a[152:155], v[172:175]
    s_waitcnt lgkmcnt(6)
    s_add_u32 s72, s72, s83
    v_mfma_f32_16x16x32_bf16 v[176:179], a[220:223], a[128:131], v[176:179]
    ds_read_b64_tr_b16 a[196:197], v26 offset:18688
    ds_read_b64_tr_b16 a[198:199], v26 offset:20992
    v_mfma_f32_16x16x32_bf16 v[180:183], a[220:223], a[136:139], v[180:183]
    buffer_load_dwordx4 v19, s[8:11], s4 offen offset:2048 lds
    v_mfma_f32_16x16x32_bf16 v[184:187], a[220:223], a[144:147], v[184:187]
    s_xor_b32 s29, s82, 3
    v_mfma_f32_16x16x32_bf16 v[188:191], a[220:223], a[152:155], v[188:191]
    s_waitcnt lgkmcnt(6)
    s_lshl_b32 s30, s72, 2
    v_mfma_f32_16x16x32_bf16 v[192:195], a[224:227], a[128:131], v[192:195]
    ds_read_b64_tr_b16 a[200:201], v26 offset:9216
    ds_read_b64_tr_b16 a[202:203], v26 offset:11520
    v_mfma_f32_16x16x32_bf16 v[196:199], a[224:227], a[136:139], v[196:199]
    buffer_load_dwordx4 v20, s[8:11], s4 offen offset:3072 lds
    v_mfma_f32_16x16x32_bf16 v[200:203], a[224:227], a[144:147], v[200:203]
    s_add_u32 m0, s23, 4096
    v_mfma_f32_16x16x32_bf16 v[204:207], a[224:227], a[152:155], v[204:207]
    s_waitcnt lgkmcnt(6)
    s_add_u32 s31, s30, s29
    v_mfma_f32_16x16x32_bf16 v[208:211], a[228:231], a[128:131], v[208:211]
    ds_read_b64_tr_b16 a[204:205], v26 offset:27648
    ds_read_b64_tr_b16 a[206:207], v26 offset:29952
    v_mfma_f32_16x16x32_bf16 v[212:215], a[228:231], a[136:139], v[212:215]
    buffer_load_dwordx4 v15, s[12:15], s25 offen offset:3072 lds
    v_mfma_f32_16x16x32_bf16 v[216:219], a[228:231], a[144:147], v[216:219]
    s_add_u32 m0, s23, 8192
    v_mfma_f32_16x16x32_bf16 v[220:223], a[228:231], a[152:155], v[220:223]
    s_waitcnt lgkmcnt(6)
    s_lshl_b32 s31, s31, 2
    v_mfma_f32_16x16x32_bf16 v[224:227], a[192:195], a[128:131], v[224:227]
    ds_read_b64_tr_b16 a[208:209], v26 offset:9248
    ds_read_b64_tr_b16 a[210:211], v26 offset:11552
    v_mfma_f32_16x16x32_bf16 v[228:231], a[192:195], a[136:139], v[228:231]
    s_add_u32 s31, s31, s82
    v_mfma_f32_16x16x32_bf16 v[232:235], a[192:195], a[144:147], v[232:235]
    s_lshl_b32 s31, s31, 2
    v_mfma_f32_16x16x32_bf16 v[236:239], a[192:195], a[152:155], v[236:239]
    s_waitcnt lgkmcnt(6)
    s_add_u32 s31, s31, s20
    v_mfma_f32_16x16x32_bf16 v[240:243], a[196:199], a[128:131], v[240:243]
    ds_read_b64_tr_b16 a[212:213], v26 offset:27680
    ds_read_b64_tr_b16 a[214:215], v26 offset:29984
    v_mfma_f32_16x16x32_bf16 v[244:247], a[196:199], a[136:139], v[244:247]
    buffer_load_dwordx4 v16, s[12:15], s25 offen offset:0 lds
    v_mfma_f32_16x16x32_bf16 v[248:251], a[196:199], a[144:147], v[248:251]
    s_add_u32 m0, s23, 36864
    v_mfma_f32_16x16x32_bf16 v[252:255], a[196:199], a[152:155], v[252:255]
    s_waitcnt lgkmcnt(6)
    s_add_u32 s25, s25, 589824
    v_mfma_f32_16x16x32_bf16 v[64:67], a[200:203], a[132:135], v[64:67]
    s_cmp_eq_u32 s25, 5308416
    s_cselect_b32 s25, 0, s25
    ds_read_b64_tr_b16 a[216:217], v26 offset:9280
    ds_read_b64_tr_b16 a[218:219], v26 offset:11584
    v_mfma_f32_16x16x32_bf16 v[68:71], a[200:203], a[140:143], v[68:71]
    s_lshl_b32 s50, s31, 12
    v_mfma_f32_16x16x32_bf16 v[72:75], a[200:203], a[148:151], v[72:75]
    s_add_u32 s31, s30, s82
    v_mfma_f32_16x16x32_bf16 v[76:79], a[200:203], a[156:159], v[76:79]
    s_waitcnt lgkmcnt(6)
    s_lshl_b32 s31, s31, 2
    v_mfma_f32_16x16x32_bf16 a[0:3], a[204:207], a[132:135], a[0:3]
    ds_read_b64_tr_b16 a[220:221], v26 offset:27712
    ds_read_b64_tr_b16 a[222:223], v26 offset:30016
    v_mfma_f32_16x16x32_bf16 a[4:7], a[204:207], a[140:143], a[4:7]
    buffer_load_dwordx2 v[54:55], v61, s[32:35], 0 offen sc1
    v_mfma_f32_16x16x32_bf16 a[8:11], a[204:207], a[148:151], a[8:11]
    s_add_u32 s31, s31, s29
    v_mfma_f32_16x16x32_bf16 a[12:15], a[204:207], a[156:159], a[12:15]
    s_waitcnt lgkmcnt(6)
    s_lshl_b32 s31, s31, 2
    v_mfma_f32_16x16x32_bf16 v[80:83], a[208:211], a[132:135], v[80:83]
    ds_read_b64_tr_b16 a[224:225], v26 offset:9312
    ds_read_b64_tr_b16 a[226:227], v26 offset:11616
    v_mfma_f32_16x16x32_bf16 v[84:87], a[208:211], a[140:143], v[84:87]
    s_add_u32 s60, s61, 147456
    buffer_load_dword v57, v56, s[40:43], s60 offen
    v_mfma_f32_16x16x32_bf16 v[88:91], a[208:211], a[148:151], v[88:91]
    s_add_u32 s31, s31, s20
    v_mfma_f32_16x16x32_bf16 v[92:95], a[208:211], a[156:159], v[92:95]
    s_waitcnt lgkmcnt(6)
    s_lshl_b32 s37, s31, 12
    v_mfma_f32_16x16x32_bf16 a[16:19], a[212:215], a[132:135], a[16:19]
    ds_read_b64_tr_b16 a[228:229], v26 offset:27744
    ds_read_b64_tr_b16 a[230:231], v26 offset:30048
    v_mfma_f32_16x16x32_bf16 a[20:23], a[212:215], a[140:143], a[20:23]
    s_xor_b32 s29, s82, 2
    v_mfma_f32_16x16x32_bf16 a[24:27], a[212:215], a[148:151], a[24:27]
    s_lshl_b32 s30, s72, 2
    v_mfma_f32_16x16x32_bf16 a[28:31], a[212:215], a[156:159], a[28:31]
    s_waitcnt lgkmcnt(6)
    s_add_u32 s31, s30, s29
    v_mfma_f32_16x16x32_bf16 v[96:99], a[216:219], a[132:135], v[96:99]
    ds_read_b64_tr_b16 a[192:193], v26 offset:9344
    ds_read_b64_tr_b16 a[194:195], v26 offset:11648
    v_mfma_f32_16x16x32_bf16 v[100:103], a[216:219], a[140:143], v[100:103]
    s_lshl_b32 s31, s31, 2
    v_mfma_f32_16x16x32_bf16 v[104:107], a[216:219], a[148:151], v[104:107]
    s_add_u32 s31, s31, s82
    v_mfma_f32_16x16x32_bf16 v[108:111], a[216:219], a[156:159], v[108:111]
    s_waitcnt lgkmcnt(6)
    s_lshl_b32 s31, s31, 2
    v_mfma_f32_16x16x32_bf16 a[32:35], a[220:223], a[132:135], a[32:35]
    ds_read_b64_tr_b16 a[196:197], v26 offset:27776
    ds_read_b64_tr_b16 a[198:199], v26 offset:30080
    v_mfma_f32_16x16x32_bf16 a[36:39], a[220:223], a[140:143], a[36:39]
    s_add_u32 s31, s31, s20
    v_mfma_f32_16x16x32_bf16 a[40:43], a[220:223], a[148:151], a[40:43]
    s_lshl_b32 s54, s31, 12
    v_mfma_f32_16x16x32_bf16 a[44:47], a[220:223], a[156:159], a[44:47]
    s_waitcnt lgkmcnt(6)
    s_add_u32 s31, s30, s82
    v_mfma_f32_16x16x32_bf16 v[112:115], a[224:227], a[132:135], v[112:115]
    ds_read_b64_tr_b16 a[200:201], v26 offset:9376
    ds_read_b64_tr_b16 a[202:203], v26 offset:11680
    v_mfma_f32_16x16x32_bf16 v[116:119], a[224:227], a[140:143], v[116:119]
    ds_read_b64_tr_b16 a[204:205], v26 offset:27808
    v_mfma_f32_16x16x32_bf16 v[120:123], a[224:227], a[148:151], v[120:123]
    ds_read_b64_tr_b16 a[206:207], v26 offset:30112
    v_mfma_f32_16x16x32_bf16 v[124:127], a[224:227], a[156:159], v[124:127]
    s_waitcnt lgkmcnt(8)
    s_lshl_b32 s31, s31, 2
    v_mfma_f32_16x16x32_bf16 a[48:51], a[228:231], a[132:135], a[48:51]
    ds_read_b64_tr_b16 a[208:209], v26 offset:9408
    ds_read_b64_tr_b16 a[210:211], v26 offset:11712
    v_mfma_f32_16x16x32_bf16 a[52:55], a[228:231], a[140:143], a[52:55]
    ds_read_b64_tr_b16 a[212:213], v26 offset:27840
    v_mfma_f32_16x16x32_bf16 a[56:59], a[228:231], a[148:151], a[56:59]
    ds_read_b64_tr_b16 a[214:215], v26 offset:30144
    v_mfma_f32_16x16x32_bf16 a[60:63], a[228:231], a[156:159], a[60:63]
    s_waitcnt lgkmcnt(10)
    s_add_u32 s31, s31, s29
    v_mfma_f32_16x16x32_bf16 v[128:131], a[192:195], a[132:135], v[128:131]
    ds_read_b64_tr_b16 a[216:217], v26 offset:9440
    ds_read_b64_tr_b16 a[218:219], v26 offset:11744
    v_mfma_f32_16x16x32_bf16 v[132:135], a[192:195], a[140:143], v[132:135]
    ds_read_b64_tr_b16 a[220:221], v26 offset:27872
    v_mfma_f32_16x16x32_bf16 v[136:139], a[192:195], a[148:151], v[136:139]
    ds_read_b64_tr_b16 a[222:223], v26 offset:30176
    v_mfma_f32_16x16x32_bf16 v[140:143], a[192:195], a[156:159], v[140:143]
    s_waitcnt lgkmcnt(12)
    s_lshl_b32 s31, s31, 2
    v_mfma_f32_16x16x32_bf16 a[64:67], a[196:199], a[132:135], a[64:67]
    ds_read_b64_tr_b16 a[224:225], v26 offset:9472
    ds_read_b64_tr_b16 a[226:227], v26 offset:11776
    v_mfma_f32_16x16x32_bf16 a[68:71], a[196:199], a[140:143], a[68:71]
    ds_read_b64_tr_b16 a[228:229], v26 offset:27904
    v_mfma_f32_16x16x32_bf16 a[72:75], a[196:199], a[148:151], a[72:75]
    ds_read_b64_tr_b16 a[230:231], v26 offset:30208
    v_mfma_f32_16x16x32_bf16 a[76:79], a[196:199], a[156:159], a[76:79]
    s_waitcnt lgkmcnt(14)
    s_add_u32 s31, s31, s20
    v_mfma_f32_16x16x32_bf16 v[144:147], a[200:203], a[132:135], v[144:147]
    s_lshl_b32 s38, s31, 12
    v_mfma_f32_16x16x32_bf16 v[148:151], a[200:203], a[140:143], v[148:151]
    s_xor_b32 s29, s82, 1
    v_mfma_f32_16x16x32_bf16 v[152:155], a[200:203], a[148:151], v[152:155]
    s_lshl_b32 s30, s72, 2
    v_mfma_f32_16x16x32_bf16 v[156:159], a[200:203], a[156:159], v[156:159]
    s_waitcnt lgkmcnt(12)
    s_add_u32 s31, s30, s29
    v_mfma_f32_16x16x32_bf16 a[80:83], a[204:207], a[132:135], a[80:83]
    s_lshl_b32 s31, s31, 2
    v_mfma_f32_16x16x32_bf16 a[84:87], a[204:207], a[140:143], a[84:87]
    s_add_u32 s31, s31, s82
    v_mfma_f32_16x16x32_bf16 a[88:91], a[204:207], a[148:151], a[88:91]
    s_lshl_b32 s31, s31, 2
    v_mfma_f32_16x16x32_bf16 a[92:95], a[204:207], a[156:159], a[92:95]
    s_waitcnt lgkmcnt(10)
    s_add_u32 s31, s31, s20
    v_mfma_f32_16x16x32_bf16 v[160:163], a[208:211], a[132:135], v[160:163]
    s_lshl_b32 s55, s31, 12
    v_mfma_f32_16x16x32_bf16 v[164:167], a[208:211], a[140:143], v[164:167]
    s_add_u32 s31, s30, s82
    v_mfma_f32_16x16x32_bf16 v[168:171], a[208:211], a[148:151], v[168:171]
    s_lshl_b32 s31, s31, 2
    v_mfma_f32_16x16x32_bf16 v[172:175], a[208:211], a[156:159], v[172:175]
    s_waitcnt lgkmcnt(8)
    s_add_u32 s31, s31, s29
    v_mfma_f32_16x16x32_bf16 v[176:179], a[212:215], a[132:135], v[176:179]
    s_lshl_b32 s31, s31, 2
    v_mfma_f32_16x16x32_bf16 v[180:183], a[212:215], a[140:143], v[180:183]
    s_add_u32 s31, s31, s20
    v_mfma_f32_16x16x32_bf16 v[184:187], a[212:215], a[148:151], v[184:187]
    s_lshl_b32 s39, s31, 12
    v_mfma_f32_16x16x32_bf16 v[188:191], a[212:215], a[156:159], v[188:191]
    s_waitcnt lgkmcnt(6)
    s_lshl_b32 s30, s72, 2
    s_waitcnt vmcnt(21) lgkmcnt(0)
    s_barrier
    v_mfma_f32_16x16x32_bf16 v[192:195], a[216:219], a[132:135], v[192:195]
    ds_read_b64_tr_b16 a[192:193], v27 offset:0
    ds_read_b64_tr_b16 a[194:195], v27 offset:2304
    v_mfma_f32_16x16x32_bf16 v[196:199], a[216:219], a[140:143], v[196:199]
    s_add_u32 s31, s30, s20
    v_mfma_f32_16x16x32_bf16 v[200:203], a[216:219], a[148:151], v[200:203]
    s_lshl_b32 s31, s31, 2
    v_mfma_f32_16x16x32_bf16 v[204:207], a[216:219], a[156:159], v[204:207]
    s_add_u32 s31, s31, s82
    v_mfma_f32_16x16x32_bf16 v[208:211], a[220:223], a[132:135], v[208:211]
    ds_read_b64_tr_b16 a[196:197], v27 offset:18432
    ds_read_b64_tr_b16 a[198:199], v27 offset:20736
    v_mfma_f32_16x16x32_bf16 v[212:215], a[220:223], a[140:143], v[212:215]
    buffer_load_dwordx4 v8, s[12:15], s25 offen offset:0 lds
    v_mfma_f32_16x16x32_bf16 v[216:219], a[220:223], a[148:151], v[216:219]
    s_lshl_b32 s31, s31, 2
    v_mfma_f32_16x16x32_bf16 v[220:223], a[220:223], a[156:159], v[220:223]
    s_add_u32 s31, s31, s20
    v_mfma_f32_16x16x32_bf16 v[224:227], a[224:227], a[132:135], v[224:227]
    ds_read_b64_tr_b16 a[200:201], v27 offset:32
    ds_read_b64_tr_b16 a[202:203], v27 offset:2336
    v_mfma_f32_16x16x32_bf16 v[228:231], a[224:227], a[140:143], v[228:231]
    buffer_load_dwordx4 v9, s[12:15], s25 offen offset:1024 lds
    v_mfma_f32_16x16x32_bf16 v[232:235], a[224:227], a[148:151], v[232:235]
    s_lshl_b32 s96, s31, 12
pad_3:
    s_cbranch_execz pad_7
    v_mfma_f32_16x16x32_bf16 v[236:239], a[224:227], a[156:159], v[236:239]
    s_cmp_eq_u32 s20, s82
    s_cselect_b32 s96, 0x7f000000, s96
    s_cselect_b32 s97, 0, 0x7f000000
    v_mfma_f32_16x16x32_bf16 v[240:243], a[228:231], a[132:135], v[240:243]
    ds_read_b64_tr_b16 a[204:205], v27 offset:18464
    ds_read_b64_tr_b16 a[206:207], v27 offset:20768
    v_mfma_f32_16x16x32_bf16 v[244:247], a[228:231], a[140:143], v[244:247]
    buffer_load_dwordx4 v10, s[12:15], s25 offen offset:2048 lds
    v_mfma_f32_16x16x32_bf16 v[248:251], a[228:231], a[148:151], v[248:251]
    s_lshr_b32 s31, s22, 2
    v_mfma_f32_16x16x32_bf16 v[252:255], a[228:231], a[156:159], v[252:255]
    s_waitcnt lgkmcnt(6)
    s_lshl_b32 s31, s31, 7
    v_mfma_f32_16x16x32_bf16 v[64:67], a[192:195], a[160:163], v[64:67]
    ds_read_b64_tr_b16 a[208:209], v27 offset:64
    ds_read_b64_tr_b16 a[210:211], v27 offset:2368
    v_mfma_f32_16x16x32_bf16 v[68:71], a[192:195], a[168:171], v[68:71]
    buffer_load_dwordx4 v11, s[12:15], s25 offen offset:3072 lds
    v_mfma_f32_16x16x32_bf16 v[72:75], a[192:195], a[176:179], v[72:75]
    s_add_u32 m0, s23, 40960
    v_mfma_f32_16x16x32_bf16 v[76:79], a[192:195], a[184:187], v[76:79]
    s_waitcnt lgkmcnt(6)
    s_add_u32 s31, s31, 0x670000
    v_mfma_f32_16x16x32_bf16 a[0:3], a[196:199], a[160:163], a[0:3]
    ds_read_b64_tr_b16 a[212:213], v27 offset:18496
    ds_read_b64_tr_b16 a[214:215], v27 offset:20800
    v_mfma_f32_16x16x32_bf16 a[4:7], a[196:199], a[168:171], a[4:7]
    ds_read_b128 a[96:99], v28 offset:0
    v_mfma_f32_16x16x32_bf16 a[8:11], a[196:199], a[176:179], a[8:11]
    ds_read_b128 a[100:103], v29 offset:0
    v_mfma_f32_16x16x32_bf16 a[12:15], a[196:199], a[184:187], a[12:15]
    s_waitcnt lgkmcnt(8)
    s_lshl_b32 s29, s83, 15
    v_mfma_f32_16x16x32_bf16 v[80:83], a[200:203], a[160:163], v[80:83]
    ds_read_b64_tr_b16 a[216:217], v27 offset:96
    ds_read_b64_tr_b16 a[218:219], v27 offset:2400
    v_mfma_f32_16x16x32_bf16 v[84:87], a[200:203], a[168:171], v[84:87]
    ds_read_b128 a[104:107], v28 offset:2048
    v_mfma_f32_16x16x32_bf16 v[88:91], a[200:203], a[176:179], v[88:91]
    ds_read_b128 a[108:111], v29 offset:2048
    v_mfma_f32_16x16x32_bf16 v[92:95], a[200:203], a[184:187], v[92:95]
    s_waitcnt lgkmcnt(10)
    buffer_load_dwordx4 v12, s[12:15], s25 offen offset:0 lds
    v_mfma_f32_16x16x32_bf16 a[16:19], a[204:207], a[160:163], a[16:19]
    ds_read_b64_tr_b16 a[220:221], v27 offset:18528
    ds_read_b64_tr_b16 a[222:223], v27 offset:20832
    v_mfma_f32_16x16x32_bf16 a[20:23], a[204:207], a[168:171], a[20:23]
    s_waitcnt vmcnt(13)
    ds_read_b128 a[112:115], v28 offset:4096
    v_mfma_f32_16x16x32_bf16 a[24:27], a[204:207], a[176:179], a[24:27]
    ds_read_b128 a[116:119], v29 offset:4096
    v_mfma_f32_16x16x32_bf16 a[28:31], a[204:207], a[184:187], a[28:31]
    s_waitcnt lgkmcnt(12)
    buffer_load_dwordx4 v13, s[12:15], s25 offen offset:1024 lds
    v_mfma_f32_16x16x32_bf16 v[96:99], a[208:211], a[160:163], v[96:99]
    ds_read_b64_tr_b16 a[224:225], v27 offset:128
    ds_read_b64_tr_b16 a[226:227], v27 offset:2432
    v_mfma_f32_16x16x32_bf16 v[100:103], a[208:211], a[168:171], v[100:103]
    ds_read_b128 a[120:123], v28 offset:6144
    v_mfma_f32_16x16x32_bf16 v[104:107], a[208:211], a[176:179], v[104:107]
    ds_read_b128 a[124:127], v29 offset:6144
    v_mfma_f32_16x16x32_bf16 v[108:111], a[208:211], a[184:187], v[108:111]
    s_waitcnt lgkmcnt(14)
    buffer_load_dwordx4 v14, s[12:15], s25 offen offset:2048 lds
    v_mfma_f32_16x16x32_bf16 a[32:35], a[212:215], a[160:163], a[32:35]
    s_add_u32 m0, s24, 0
    ds_read_b64_tr_b16 a[228:229], v27 offset:18560
    ds_read_b64_tr_b16 a[230:231], v27 offset:20864
    v_mfma_f32_16x16x32_bf16 a[36:39], a[212:215], a[168:171], a[36:39]
    s_waitcnt lgkmcnt(10)
    buffer_load_dwordx4 v21, s[8:11], s4 offen offset:0 lds
    v_mfma_f32_16x16x32_bf16 a[40:43], a[212:215], a[176:179], a[40:43]
    s_lshl_b32 s30, s82, 13
    v_mfma_f32_16x16x32_bf16 a[44:47], a[212:215], a[184:187], a[44:47]
    s_add_u32 s29, s29, s30
    v_mfma_f32_16x16x32_bf16 v[112:115], a[216:219], a[160:163], v[112:115]
    ds_read_b64_tr_b16 a[192:193], v27 offset:160
    ds_read_b64_tr_b16 a[194:195], v27 offset:2464
    v_mfma_f32_16x16x32_bf16 v[116:119], a[216:219], a[168:171], v[116:119]
    s_add_u32 s29, s29, s31
    v_mfma_f32_16x16x32_bf16 v[120:123], a[216:219], a[176:179], v[120:123]
    s_lshl_b32 s30, s20, 11
    v_mfma_f32_16x16x32_bf16 v[124:127], a[216:219], a[184:187], v[124:127]
    s_waitcnt lgkmcnt(10)
    s_add_u32 s29, s29, s30
    v_lshl_add_u32 v3, v0, 8, s29
    v_mfma_f32_16x16x32_bf16 a[48:51], a[220:223], a[160:163], a[48:51]
    ds_read_b64_tr_b16 a[196:197], v27 offset:18592
    ds_read_b64_tr_b16 a[198:199], v27 offset:20896
    v_mfma_f32_16x16x32_bf16 a[52:55], a[220:223], a[168:171], a[52:55]
    buffer_load_dwordx4 v22, s[8:11], s4 offen offset:1024 lds
    v_mfma_f32_16x16x32_bf16 a[56:59], a[220:223], a[176:179], a[56:59]
    s_lshl_b32 s29, s30, 1
    v_mfma_f32_16x16x32_bf16 a[60:63], a[220:223], a[184:187], a[60:63]
    s_waitcnt lgkmcnt(8)
    s_lshl_b32 s30, s83, 14
    v_mfma_f32_16x16x32_bf16 v[128:131], a[224:227], a[160:163], v[128:131]
    ds_read_b64_tr_b16 a[200:201], v27 offset:192
    ds_read_b64_tr_b16 a[202:203], v27 offset:2496
    v_mfma_f32_16x16x32_bf16 v[132:135], a[224:227], a[168:171], v[132:135]
    buffer_load_dwordx4 v23, s[8:11], s4 offen offset:2048 lds
    v_mfma_f32_16x16x32_bf16 v[136:139], a[224:227], a[176:179], v[136:139]
    s_lshl_b32 s31, s22, 7
    v_mfma_f32_16x16x32_bf16 v[140:143], a[224:227], a[184:187], v[140:143]
    s_waitcnt lgkmcnt(6)
    s_add_u32 s30, s30, s31
    v_mfma_f32_16x16x32_bf16 a[64:67], a[228:231], a[160:163], a[64:67]
    ds_read_b64_tr_b16 a[204:205], v27 offset:18624
    ds_read_b64_tr_b16 a[206:207], v27 offset:20928
    v_mfma_f32_16x16x32_bf16 a[68:71], a[228:231], a[168:171], a[68:71]
    buffer_load_dwordx4 v24, s[8:11], s4 offen offset:3072 lds
    v_mfma_f32_16x16x32_bf16 a[72:75], a[228:231], a[176:179], a[72:75]
    s_add_u32 m0, s24, 4096
    v_mfma_f32_16x16x32_bf16 a[76:79], a[228:231], a[184:187], a[76:79]
    s_waitcnt lgkmcnt(6)
    s_add_u32 s4, s4, 128
    v_mfma_f32_16x16x32_bf16 v[144:147], a[192:195], a[160:163], v[144:147]
    s_cmp_eq_u32 s4, 1152
    s_cselect_b32 s4, 0, s4
    ds_read_b64_tr_b16 a[208:209], v27 offset:224
    ds_read_b64_tr_b16 a[210:211], v27 offset:2528
    v_mfma_f32_16x16x32_bf16 v[148:151], a[192:195], a[168:171], v[148:151]
    buffer_load_dwordx4 v17, s[8:11], s4 offen offset:0 lds
    v_mfma_f32_16x16x32_bf16 v[152:155], a[192:195], a[176:179], v[152:155]
    s_add_u32 s30, s30, s29
    v_mfma_f32_16x16x32_bf16 v[156:159], a[192:195], a[184:187], v[156:159]
    s_waitcnt lgkmcnt(6)
    s_add_u32 s30, s30, 0x6ae000
    v_cmp_gt_u32 vcc, 8, v0
    v_mfma_f32_16x16x32_bf16 a[80:83], a[196:199], a[160:163], a[80:83]
    ds_read_b64_tr_b16 a[212:213], v27 offset:18656
    ds_read_b64_tr_b16 a[214:215], v27 offset:20960
    v_mfma_f32_16x16x32_bf16 a[84:87], a[196:199], a[168:171], a[84:87]
    v_min_u32 v4, 11, v0
    v_mfma_f32_16x16x32_bf16 a[88:91], a[196:199], a[176:179], a[88:91]
    v_lshl_add_u32 v4, v4, 10, s30
    v_mfma_f32_16x16x32_bf16 a[92:95], a[196:199], a[184:187], a[92:95]
    s_waitcnt lgkmcnt(6)
    v_cndmask_b32 v2, v4, v3, vcc
    v_mfma_f32_16x16x32_bf16 v[160:163], a[200:203], a[160:163], v[160:163]
    ds_read_b64_tr_b16 a[216:217], v27 offset:256
    ds_read_b64_tr_b16 a[218:219], v27 offset:2560
    v_mfma_f32_16x16x32_bf16 v[164:167], a[200:203], a[168:171], v[164:167]
    buffer_load_dwordx4 v18, s[8:11], s4 offen offset:1024 lds
    v_mfma_f32_16x16x32_bf16 v[168:171], a[200:203], a[176:179], v[168:171]
    v_accvgpr_write_b32 a248, v2
    v_mfma_f32_16x16x32_bf16 v[172:175], a[200:203], a[184:187], v[172:175]
    s_waitcnt lgkmcnt(6)
    v_min_u32 v3, 2, v0
    v_mfma_f32_16x16x32_bf16 v[176:179], a[204:207], a[160:163], v[176:179]
    ds_read_b64_tr_b16 a[220:221], v27 offset:18688
    ds_read_b64_tr_b16 a[222:223], v27 offset:20992
    v_mfma_f32_16x16x32_bf16 v[180:183], a[204:207], a[168:171], v[180:183]
    buffer_load_dwordx4 v19, s[8:11], s4 offen offset:2048 lds
    v_mfma_f32_16x16x32_bf16 v[184:187], a[204:207], a[176:179], v[184:187]
    v_add_u32 v3, s82, v3
    v_mfma_f32_16x16x32_bf16 v[188:191], a[204:207], a[184:187], v[188:191]
    s_waitcnt lgkmcnt(6)
    v_add_u32 v3, 1, v3
    v_mfma_f32_16x16x32_bf16 v[192:195], a[208:211], a[160:163], v[192:195]
    ds_read_b64_tr_b16 a[224:225], v27 offset:9216
    ds_read_b64_tr_b16 a[226:227], v27 offset:11520
    v_mfma_f32_16x16x32_bf16 v[196:199], a[208:211], a[168:171], v[196:199]
    buffer_load_dwordx4 v20, s[8:11], s4 offen offset:3072 lds
    v_mfma_f32_16x16x32_bf16 v[200:203], a[208:211], a[176:179], v[200:203]
    s_add_u32 m0, s23, 40960
    v_and_b32 v3, 3, v3
    v_mfma_f32_16x16x32_bf16 v[204:207], a[208:211], a[184:187], v[204:207]
    s_waitcnt lgkmcnt(6)
    v_lshlrev_b32 v2, 9, v3
    v_mfma_f32_16x16x32_bf16 v[208:211], a[212:215], a[160:163], v[208:211]
    ds_read_b64_tr_b16 a[228:229], v27 offset:27648
    ds_read_b64_tr_b16 a[230:231], v27 offset:29952
    v_mfma_f32_16x16x32_bf16 v[212:215], a[212:215], a[168:171], v[212:215]
    buffer_load_dwordx4 v15, s[12:15], s25 offen offset:3072 lds
    v_mfma_f32_16x16x32_bf16 v[216:219], a[212:215], a[176:179], v[216:219]
    s_add_u32 m0, s23, 45056
    v_accvgpr_write_b32 a249, v2
    v_mfma_f32_16x16x32_bf16 v[220:223], a[212:215], a[184:187], v[220:223]
    s_waitcnt lgkmcnt(6)
    s_lshl_b32 s29, s72, 11
    v_mfma_f32_16x16x32_bf16 v[224:227], a[216:219], a[160:163], v[224:227]
    ds_read_b64_tr_b16 a[192:193], v27 offset:9248
    ds_read_b64_tr_b16 a[194:195], v27 offset:11552
    v_mfma_f32_16x16x32_bf16 v[228:231], a[216:219], a[168:171], v[228:231]
    s_lshl_b32 s30, s20, 7
    v_mfma_f32_16x16x32_bf16 v[232:235], a[216:219], a[176:179], v[232:235]
    s_add_u32 s29, s29, s30
    v_mfma_f32_16x16x32_bf16 v[236:239], a[216:219], a[184:187], v[236:239]
    s_waitcnt lgkmcnt(6)
    s_add_u32 s49, s29, 0x650000
    v_mfma_f32_16x16x32_bf16 v[240:243], a[220:223], a[160:163], v[240:243]
    ds_read_b64_tr_b16 a[196:197], v27 offset:27680
    ds_read_b64_tr_b16 a[198:199], v27 offset:29984
    v_mfma_f32_16x16x32_bf16 v[244:247], a[220:223], a[168:171], v[244:247]
    buffer_load_dwordx4 v16, s[12:15], s25 offen offset:0 lds
    v_mfma_f32_16x16x32_bf16 v[248:251], a[220:223], a[176:179], v[248:251]
    s_add_u32 m0, s23, 73728
    v_mfma_f32_16x16x32_bf16 v[252:255], a[220:223], a[184:187], v[252:255]
    s_waitcnt lgkmcnt(6)
    s_add_u32 s25, s25, 589824
    v_mfma_f32_16x16x32_bf16 v[64:67], a[224:227], a[164:167], v[64:67]
    s_cmp_eq_u32 s25, 5308416
    s_cselect_b32 s25, 0, s25
    ds_read_b64_tr_b16 a[200:201], v27 offset:9280
    ds_read_b64_tr_b16 a[202:203], v27 offset:11584
    v_mfma_f32_16x16x32_bf16 v[68:71], a[224:227], a[172:175], v[68:71]
    s_waitcnt vmcnt(18)
    v_cmp_ne_u64 vcc, v[62:63], v[54:55]
    s_nop 0
    s_cbranch_vccnz wxs_8
wxr_9:
    v_mfma_f32_16x16x32_bf16 v[72:75], a[224:227], a[180:183], v[72:75]
    buffer_load_dword v57, v40, s[16:19], s87 offen
    v_mfma_f32_16x16x32_bf16 v[76:79], a[224:227], a[188:191], v[76:79]
    s_waitcnt lgkmcnt(6)
    s_lshl_b32 s30, s82, 9
    v_mfma_f32_16x16x32_bf16 a[0:3], a[228:231], a[164:167], a[0:3]
    ds_read_b64_tr_b16 a[204:205], v27 offset:27712
    ds_read_b64_tr_b16 a[206:207], v27 offset:30016
    v_mfma_f32_16x16x32_bf16 a[4:7], a[228:231], a[172:175], a[4:7]
    buffer_load_dwordx2 v[54:55], v53, s[32:35], 0 offen sc1
    v_mfma_f32_16x16x32_bf16 a[8:11], a[228:231], a[180:183], a[8:11]
    s_add_u32 s73, s49, s30
    v_lshrrev_b32 v3, 2, v0
    v_mfma_f32_16x16x32_bf16 a[12:15], a[228:231], a[188:191], a[12:15]
    s_waitcnt lgkmcnt(6)
    v_and_b32 v4, 3, v0
    v_mfma_f32_16x16x32_bf16 v[80:83], a[192:195], a[164:167], v[80:83]
    ds_read_b64_tr_b16 a[208:209], v27 offset:9312
    ds_read_b64_tr_b16 a[210:211], v27 offset:11616
    v_mfma_f32_16x16x32_bf16 v[84:87], a[192:195], a[172:175], v[84:87]
    s_add_u32 s60, s61, 221184
    buffer_load_dword v57, v56, s[40:43], s60 offen
    v_mfma_f32_16x16x32_bf16 v[88:91], a[192:195], a[180:183], v[88:91]
    v_lshlrev_b32 v4, 4, v4
    v_mfma_f32_16x16x32_bf16 v[92:95], a[192:195], a[188:191], v[92:95]
    s_waitcnt lgkmcnt(6)
    v_lshl_add_u32 v2, v3, 12, v4
    v_mfma_f32_16x16x32_bf16 a[16:19], a[196:199], a[164:167], a[16:19]
    ds_read_b64_tr_b16 a[212:213], v27 offset:27744
    ds_read_b64_tr_b16 a[214:215], v27 offset:30048
    v_mfma_f32_16x16x32_bf16 a[20:23], a[196:199], a[172:175], a[20:23]
    v_accvgpr_write_b32 a250, v2
    v_mfma_f32_16x16x32_bf16 a[24:27], a[196:199], a[180:183], a[24:27]
    v_mul_u32_u24 v3, 80, v3
    v_mfma_f32_16x16x32_bf16 a[28:31], a[196:199], a[188:191], a[28:31]
    s_waitcnt lgkmcnt(6)
    v_add_u32 v3, v3, v4
    v_mfma_f32_16x16x32_bf16 v[96:99], a[200:203], a[164:167], v[96:99]
    ds_read_b64_tr_b16 a[216:217], v27 offset:9344
    ds_read_b64_tr_b16 a[218:219], v27 offset:11648
    v_mfma_f32_16x16x32_bf16 v[100:103], a[200:203], a[172:175], v[100:103]
    v_add_u32 v2, s92, v3
    v_mfma_f32_16x16x32_bf16 v[104:107], a[200:203], a[180:183], v[104:107]
    v_accvgpr_write_b32 a252, v2
    v_mfma_f32_16x16x32_bf16 v[108:111], a[200:203], a[188:191], v[108:111]
    s_waitcnt lgkmcnt(6)
    s_lshl_b32 s29, s84, 2
    v_mfma_f32_16x16x32_bf16 a[32:35], a[204:207], a[164:167], a[32:35]
    ds_read_b64_tr_b16 a[220:221], v27 offset:27776
    ds_read_b64_tr_b16 a[222:223], v27 offset:30080
    v_mfma_f32_16x16x32_bf16 a[36:39], a[204:207], a[172:175], a[36:39]
    s_add_u32 s29, s29, s20
    v_mfma_f32_16x16x32_bf16 a[40:43], a[204:207], a[180:183], a[40:43]
    s_lshl_b32 s30, s29, 6
    v_mfma_f32_16x16x32_bf16 a[44:47], a[204:207], a[188:191], a[44:47]
    s_waitcnt lgkmcnt(6)
    s_add_u32 s30, s30, 0x300000
    v_mfma_f32_16x16x32_bf16 v[112:115], a[208:211], a[164:167], v[112:115]
    ds_read_b64_tr_b16 a[224:225], v27 offset:9376
    ds_read_b64_tr_b16 a[226:227], v27 offset:11680
    v_mfma_f32_16x16x32_bf16 v[116:119], a[208:211], a[172:175], v[116:119]
    ds_read_b64_tr_b16 a[228:229], v27 offset:27808
    v_mfma_f32_16x16x32_bf16 v[120:123], a[208:211], a[180:183], v[120:123]
    ds_read_b64_tr_b16 a[230:231], v27 offset:30112
    v_mfma_f32_16x16x32_bf16 v[124:127], a[208:211], a[188:191], v[124:127]
    s_waitcnt lgkmcnt(8)
    s_lshl_b32 s88, s83, 19
    v_mfma_f32_16x16x32_bf16 a[48:51], a[212:215], a[164:167], a[48:51]
    ds_read_b64_tr_b16 a[192:193], v27 offset:9408
    ds_read_b64_tr_b16 a[194:195], v27 offset:11712
    v_mfma_f32_16x16x32_bf16 a[52:55], a[212:215], a[172:175], a[52:55]
    ds_read_b64_tr_b16 a[196:197], v27 offset:27840
    v_mfma_f32_16x16x32_bf16 a[56:59], a[212:215], a[180:183], a[56:59]
    ds_read_b64_tr_b16 a[198:199], v27 offset:30144
    v_mfma_f32_16x16x32_bf16 a[60:63], a[212:215], a[188:191], a[60:63]
    s_waitcnt lgkmcnt(10)
    s_lshl_b32 s31, s82, 17
    v_mfma_f32_16x16x32_bf16 v[128:131], a[216:219], a[164:167], v[128:131]
    ds_read_b64_tr_b16 a[200:201], v27 offset:9440
    ds_read_b64_tr_b16 a[202:203], v27 offset:11744
    v_mfma_f32_16x16x32_bf16 v[132:135], a[216:219], a[172:175], v[132:135]
    ds_read_b64_tr_b16 a[204:205], v27 offset:27872
    v_mfma_f32_16x16x32_bf16 v[136:139], a[216:219], a[180:183], v[136:139]
    ds_read_b64_tr_b16 a[206:207], v27 offset:30176
    v_mfma_f32_16x16x32_bf16 v[140:143], a[216:219], a[188:191], v[140:143]
    s_waitcnt lgkmcnt(12)
    s_add_u32 s88, s88, s31
    v_mfma_f32_16x16x32_bf16 a[64:67], a[220:223], a[164:167], a[64:67]
    ds_read_b64_tr_b16 a[208:209], v27 offset:9472
    ds_read_b64_tr_b16 a[210:211], v27 offset:11776
    v_mfma_f32_16x16x32_bf16 a[68:71], a[220:223], a[172:175], a[68:71]
    ds_read_b64_tr_b16 a[212:213], v27 offset:27904
    v_mfma_f32_16x16x32_bf16 a[72:75], a[220:223], a[180:183], a[72:75]
    ds_read_b64_tr_b16 a[214:215], v27 offset:30208
    v_mfma_f32_16x16x32_bf16 a[76:79], a[220:223], a[188:191], a[76:79]
    s_waitcnt lgkmcnt(14)
    s_add_u32 s88, s88, s30
    v_mfma_f32_16x16x32_bf16 v[144:147], a[224:227], a[164:167], v[144:147]
    s_add_u32 s89, s88, 65536
    v_mfma_f32_16x16x32_bf16 v[148:151], a[224:227], a[172:175], v[148:151]
    s_lshl_b32 s90, s83, 16
    v_mfma_f32_16x16x32_bf16 v[152:155], a[224:227], a[180:183], v[152:155]
    s_add_u32 s90, s90, 2097152
    v_mfma_f32_16x16x32_bf16 v[156:159], a[224:227], a[188:191], v[156:159]
    s_waitcnt lgkmcnt(12)
    s_add_u32 s90, s90, s30
    v_mfma_f32_16x16x32_bf16 a[80:83], a[228:231], a[164:167], a[80:83]
    s_lshl_b32 s91, s29, 7
    v_mfma_f32_16x16x32_bf16 a[84:87], a[228:231], a[172:175], a[84:87]
    s_add_u32 s91, s91, 0x600000
    v_and_b32 v3, 15, v0
    v_mfma_f32_16x16x32_bf16 a[88:91], a[228:231], a[180:183], a[88:91]
    v_lshlrev_b32 v2, 2, v3
    v_mfma_f32_16x16x32_bf16 a[92:95], a[228:231], a[188:191], a[92:95]
    s_waitcnt lgkmcnt(10)
    v_accvgpr_write_b32 a251, v2
    v_mfma_f32_16x16x32_bf16 v[160:163], a[192:195], a[164:167], v[160:163]
    v_lshrrev_b32 v4, 2, v0
    v_mfma_f32_16x16x32_bf16 v[164:167], a[192:195], a[172:175], v[164:167]
    v_mul_u32_u24 v4, 80, v4
    v_mfma_f32_16x16x32_bf16 v[168:171], a[192:195], a[180:183], v[168:171]
    v_and_b32 v5, 3, v0
    v_mfma_f32_16x16x32_bf16 v[172:175], a[192:195], a[188:191], v[172:175]
    s_waitcnt lgkmcnt(8)
    v_lshl_add_u32 v4, v5, 3, v4
    v_mfma_f32_16x16x32_bf16 v[176:179], a[196:199], a[164:167], v[176:179]
    v_add_u32 v2, s92, v4
    v_mfma_f32_16x16x32_bf16 v[180:183], a[196:199], a[172:175], v[180:183]
    v_accvgpr_write_b32 a253, v2
    v_mfma_f32_16x16x32_bf16 v[184:187], a[196:199], a[180:183], v[184:187]
    s_mul_i32 s29, s29, 36864
    v_mfma_f32_16x16x32_bf16 v[188:191], a[196:199], a[188:191], v[188:191]
    s_waitcnt lgkmcnt(6)
    s_movk_i32 s30, 1152
    v_mul_u32_u24 v3, s30, v3
    s_waitcnt lgkmcnt(0)
    s_barrier
    v_mfma_f32_16x16x32_bf16 v[192:195], a[200:203], a[164:167], v[192:195]
    ds_read_b64_tr_b16 a[216:217], v25 offset:0
    ds_read_b64_tr_b16 a[218:219], v25 offset:2304
    v_mfma_f32_16x16x32_bf16 v[196:199], a[200:203], a[172:175], v[196:199]
    v_lshrrev_b32 v4, 4, v0
    v_mfma_f32_16x16x32_bf16 v[200:203], a[200:203], a[180:183], v[200:203]
    v_lshl_add_u32 v3, v4, 3, v3
    v_mfma_f32_16x16x32_bf16 v[204:207], a[200:203], a[188:191], v[204:207]
    s_lshl_b32 s30, s83, 8
    v_mfma_f32_16x16x32_bf16 v[208:211], a[204:207], a[164:167], v[208:211]
    ds_read_b64_tr_b16 a[220:221], v25 offset:18432
    ds_read_b64_tr_b16 a[222:223], v25 offset:20736
    v_mfma_f32_16x16x32_bf16 v[212:215], a[204:207], a[172:175], v[212:215]
    buffer_load_dwordx4 v8, s[12:15], s25 offen offset:0 lds
    v_mfma_f32_16x16x32_bf16 v[216:219], a[204:207], a[180:183], v[216:219]
    s_lshl_b32 s31, s82, 6
    v_mfma_f32_16x16x32_bf16 v[220:223], a[204:207], a[188:191], v[220:223]
    s_add_u32 s30, s30, s31
    v_mfma_f32_16x16x32_bf16 v[224:227], a[208:211], a[164:167], v[224:227]
    ds_read_b64_tr_b16 a[224:225], v25 offset:32
    ds_read_b64_tr_b16 a[226:227], v25 offset:2336
    v_mfma_f32_16x16x32_bf16 v[228:231], a[208:211], a[172:175], v[228:231]
    buffer_load_dwordx4 v9, s[12:15], s25 offen offset:1024 lds
    v_mfma_f32_16x16x32_bf16 v[232:235], a[208:211], a[180:183], v[232:235]
    s_add_u32 s30, s30, s29
    v_add_u32 v2, s30, v3
    v_mfma_f32_16x16x32_bf16 v[236:239], a[208:211], a[188:191], v[236:239]
    v_accvgpr_write_b32 a254, v2
    v_mfma_f32_16x16x32_bf16 v[240:243], a[212:215], a[164:167], v[240:243]
    ds_read_b64_tr_b16 a[228:229], v25 offset:18464
    ds_read_b64_tr_b16 a[230:231], v25 offset:20768
    v_mfma_f32_16x16x32_bf16 v[244:247], a[212:215], a[172:175], v[244:247]
    buffer_load_dwordx4 v10, s[12:15], s25 offen offset:2048 lds
    v_mfma_f32_16x16x32_bf16 v[248:251], a[212:215], a[180:183], v[248:251]
    s_lshl_b32 s30, s83, 5
    v_mfma_f32_16x16x32_bf16 v[252:255], a[212:215], a[188:191], v[252:255]
    s_waitcnt lgkmcnt(6)
    s_add_u32 s30, s30, s29
    v_mfma_f32_16x16x32_bf16 v[64:67], a[216:219], a[96:99], v[64:67]
    ds_read_b64_tr_b16 a[192:193], v25 offset:64
    ds_read_b64_tr_b16 a[194:195], v25 offset:2368
    v_mfma_f32_16x16x32_bf16 v[68:71], a[216:219], a[104:107], v[68:71]
    buffer_load_dwordx4 v11, s[12:15], s25 offen offset:3072 lds
    v_mfma_f32_16x16x32_bf16 v[72:75], a[216:219], a[112:115], v[72:75]
    s_add_u32 m0, s23, 77824
    v_mfma_f32_16x16x32_bf16 v[76:79], a[216:219], a[120:123], v[76:79]
    s_waitcnt lgkmcnt(6)
    s_add_u32 s30, s30, s97
    v_mfma_f32_16x16x32_bf16 a[0:3], a[220:223], a[96:99], a[0:3]
    ds_read_b64_tr_b16 a[196:197], v25 offset:18496
    ds_read_b64_tr_b16 a[198:199], v25 offset:20800
    v_mfma_f32_16x16x32_bf16 a[4:7], a[220:223], a[104:107], a[4:7]
    ds_read_b128 a[128:131], v28 offset:8192
    v_mfma_f32_16x16x32_bf16 a[8:11], a[220:223], a[112:115], a[8:11]
    ds_read_b128 a[132:135], v29 offset:8192
    v_mfma_f32_16x16x32_bf16 a[12:15], a[220:223], a[120:123], a[12:15]
    s_waitcnt lgkmcnt(8)
    s_add_u32 s30, s30, 1024
    v_add_u32 v2, s30, v3
    v_mfma_f32_16x16x32_bf16 v[80:83], a[224:227], a[96:99], v[80:83]
    ds_read_b64_tr_b16 a[200:201], v25 offset:96
    ds_read_b64_tr_b16 a[202:203], v25 offset:2400
    v_mfma_f32_16x16x32_bf16 v[84:87], a[224:227], a[104:107], v[84:87]
    ds_read_b128 a[136:139], v28 offset:10240
    v_mfma_f32_16x16x32_bf16 v[88:91], a[224:227], a[112:115], v[88:91]
    ds_read_b128 a[140:143], v29 offset:10240
    v_mfma_f32_16x16x32_bf16 v[92:95], a[224:227], a[120:123], v[92:95]
    s_waitcnt lgkmcnt(10)
    buffer_load_dwordx4 v12, s[12:15], s25 offen offset:0 lds
    v_mfma_f32_16x16x32_bf16 a[16:19], a[228:231], a[96:99], a[16:19]
    ds_read_b64_tr_b16 a[204:205], v25 offset:18528
    ds_read_b64_tr_b16 a[206:207], v25 offset:20832
    v_mfma_f32_16x16x32_bf16 a[20:23], a[228:231], a[104:107], a[20:23]
    s_waitcnt vmcnt(14)
    ds_read_b128 a[144:147], v28 offset:0
    v_mfma_f32_16x16x32_bf16 a[24:27], a[228:231], a[112:115], a[24:27]
    ds_read_b128 a[148:151], v29 offset:0
    v_mfma_f32_16x16x32_bf16 a[28:31], a[228:231], a[120:123], a[28:31]
    s_waitcnt lgkmcnt(12)
    buffer_load_dwordx4 v13, s[12:15], s25 offen offset:1024 lds
    v_mfma_f32_16x16x32_bf16 v[96:99], a[192:195], a[96:99], v[96:99]
    ds_read_b64_tr_b16 a[208:209], v25 offset:128
    ds_read_b64_tr_b16 a[210:211], v25 offset:2432
    v_mfma_f32_16x16x32_bf16 v[100:103], a[192:195], a[104:107], v[100:103]
    ds_read_b128 a[152:155], v28 offset:2048
    v_mfma_f32_16x16x32_bf16 v[104:107], a[192:195], a[112:115], v[104:107]
    ds_read_b128 a[156:159], v29 offset:2048
    v_mfma_f32_16x16x32_bf16 v[108:111], a[192:195], a[120:123], v[108:111]
    s_waitcnt lgkmcnt(14)
    buffer_load_dwordx4 v14, s[12:15], s25 offen offset:2048 lds
    v_mfma_f32_16x16x32_bf16 a[32:35], a[196:199], a[96:99], a[32:35]
    s_add_u32 m0, s24, 8192
    ds_read_b64_tr_b16 a[212:213], v25 offset:18560
    ds_read_b64_tr_b16 a[214:215], v25 offset:20864
    v_mfma_f32_16x16x32_bf16 a[36:39], a[196:199], a[104:107], a[36:39]
    s_waitcnt lgkmcnt(10)
    buffer_load_dwordx4 v21, s[8:11], s4 offen offset:0 lds
    v_mfma_f32_16x16x32_bf16 a[40:43], a[196:199], a[112:115], a[40:43]
    v_accvgpr_write_b32 a255, v2
    v_mfma_f32_16x16x32_bf16 a[44:47], a[196:199], a[120:123], a[44:47]
    s_add_u32 s68, s6, 0x2400000
    s_addc_u32 s69, s7, 0
    v_mfma_f32_16x16x32_bf16 v[112:115], a[200:203], a[96:99], v[112:115]
    ds_read_b64_tr_b16 a[216:217], v25 offset:160
    ds_read_b64_tr_b16 a[218:219], v25 offset:2464
    v_mfma_f32_16x16x32_bf16 v[116:119], a[200:203], a[104:107], v[116:119]
    s_mov_b32 s70, 0x1000000
    v_mfma_f32_16x16x32_bf16 v[120:123], a[200:203], a[112:115], v[120:123]
    s_mov_b32 s71, 0x20000
    v_mfma_f32_16x16x32_bf16 v[124:127], a[200:203], a[120:123], v[124:127]
    s_waitcnt lgkmcnt(10)
    s_lshl_b32 s93, s28, 12
    v_mfma_f32_16x16x32_bf16 a[48:51], a[204:207], a[96:99], a[48:51]
    ds_read_b64_tr_b16 a[220:221], v25 offset:18592
    ds_read_b64_tr_b16 a[222:223], v25 offset:20896
    v_mfma_f32_16x16x32_bf16 a[52:55], a[204:207], a[104:107], a[52:55]
    buffer_load_dwordx4 v22, s[8:11], s4 offen offset:1024 lds
    v_mfma_f32_16x16x32_bf16 a[56:59], a[204:207], a[112:115], a[56:59]
    s_lshl_b32 s29, s62, 11
    v_mfma_f32_16x16x32_bf16 a[60:63], a[204:207], a[120:123], a[60:63]
    s_waitcnt lgkmcnt(8)
    s_add_u32 s93, s93, s29
    v_mfma_f32_16x16x32_bf16 v[128:131], a[208:211], a[96:99], v[128:131]
    ds_read_b64_tr_b16 a[224:225], v25 offset:192
    ds_read_b64_tr_b16 a[226:227], v25 offset:2496
    v_mfma_f32_16x16x32_bf16 v[132:135], a[208:211], a[104:107], v[132:135]
    buffer_load_dwordx4 v23, s[8:11], s4 offen offset:2048 lds
    v_mfma_f32_16x16x32_bf16 v[136:139], a[208:211], a[112:115], v[136:139]
    s_add_u32 s93, s93, 0x300000
    v_mfma_f32_16x16x32_bf16 v[140:143], a[208:211], a[120:123], v[140:143]
    s_waitcnt lgkmcnt(6)
    s_lshl_b32 s94, s28, 1
    v_mfma_f32_16x16x32_bf16 a[64:67], a[212:215], a[96:99], a[64:67]
    ds_read_b64_tr_b16 a[228:229], v25 offset:18624
    ds_read_b64_tr_b16 a[230:231], v25 offset:20928
    v_mfma_f32_16x16x32_bf16 a[68:71], a[212:215], a[104:107], a[68:71]
    buffer_load_dwordx4 v24, s[8:11], s4 offen offset:3072 lds
    v_mfma_f32_16x16x32_bf16 a[72:75], a[212:215], a[112:115], a[72:75]
    s_add_u32 m0, s23, 77824
    v_mfma_f32_16x16x32_bf16 a[76:79], a[212:215], a[120:123], a[76:79]
    s_waitcnt lgkmcnt(6)
    s_add_u32 s94, s94, s62
    v_mfma_f32_16x16x32_bf16 v[144:147], a[216:219], a[96:99], v[144:147]
    ds_read_b64_tr_b16 a[192:193], v25 offset:224
    ds_read_b64_tr_b16 a[194:195], v25 offset:2528
    v_mfma_f32_16x16x32_bf16 v[148:151], a[216:219], a[104:107], v[148:151]
    buffer_load_dwordx4 v15, s[12:15], s25 offen offset:3072 lds
    v_mfma_f32_16x16x32_bf16 v[152:155], a[216:219], a[112:115], v[152:155]
    s_add_u32 m0, s23, 81920
    v_mfma_f32_16x16x32_bf16 v[156:159], a[216:219], a[120:123], v[156:159]
    s_waitcnt lgkmcnt(6)
    s_lshl_b32 s94, s94, 7
    v_mfma_f32_16x16x32_bf16 a[80:83], a[220:223], a[96:99], a[80:83]
    ds_read_b64_tr_b16 a[196:197], v25 offset:18656
    ds_read_b64_tr_b16 a[198:199], v25 offset:20960
    v_mfma_f32_16x16x32_bf16 a[84:87], a[220:223], a[104:107], a[84:87]
    s_add_u32 s94, s94, 0x670000
    v_mfma_f32_16x16x32_bf16 a[88:91], a[220:223], a[112:115], a[88:91]
    s_sub_u32 s29, 7, s5
    v_mfma_f32_16x16x32_bf16 a[92:95], a[220:223], a[120:123], a[92:95]
    s_waitcnt lgkmcnt(6)
    s_cmp_eq_u32 s62, 1
    s_cselect_b32 s29, s5, s29
    v_mfma_f32_16x16x32_bf16 v[160:163], a[224:227], a[96:99], v[160:163]
    ds_read_b64_tr_b16 a[200:201], v25 offset:256
    ds_read_b64_tr_b16 a[202:203], v25 offset:2560
    v_mfma_f32_16x16x32_bf16 v[164:167], a[224:227], a[104:107], v[164:167]
    buffer_load_dwordx4 v16, s[12:15], s25 offen offset:0 lds
    v_mfma_f32_16x16x32_bf16 v[168:171], a[224:227], a[112:115], v[168:171]
    s_mov_b32 m0, s74
    v_mfma_f32_16x16x32_bf16 v[172:175], a[224:227], a[120:123], v[172:175]
    s_waitcnt lgkmcnt(6)
    s_sub_u32 s30, s63, 512
    v_mfma_f32_16x16x32_bf16 v[176:179], a[228:231], a[96:99], v[176:179]
    ds_read_b64_tr_b16 a[204:205], v25 offset:18688
    ds_read_b64_tr_b16 a[206:207], v25 offset:20992
    v_mfma_f32_16x16x32_bf16 v[180:183], a[228:231], a[104:107], v[180:183]
    s_lshl_b32 s30, s30, 3
    v_mfma_f32_16x16x32_bf16 v[184:187], a[228:231], a[112:115], v[184:187]
    s_add_u32 s30, s30, s29
    v_mfma_f32_16x16x32_bf16 v[188:191], a[228:231], a[120:123], v[188:191]
    s_waitcnt lgkmcnt(6)
    s_lshl_b32 s30, s30, 7
    v_mfma_f32_16x16x32_bf16 v[192:195], a[192:195], a[96:99], v[192:195]
    ds_read_b64_tr_b16 a[208:209], v25 offset:9216
    ds_read_b64_tr_b16 a[210:211], v25 offset:11520
    v_mfma_f32_16x16x32_bf16 v[196:199], a[192:195], a[104:107], v[196:199]
    s_add_u32 s95, s30, 0x6b0000
    v_mfma_f32_16x16x32_bf16 v[200:203], a[192:195], a[112:115], v[200:203]
    s_lshl_b32 s29, s29, 9
    v_mfma_f32_16x16x32_bf16 v[204:207], a[192:195], a[120:123], v[204:207]
    s_waitcnt lgkmcnt(6)
    s_lshl_b32 s30, s63, 12
    v_mfma_f32_16x16x32_bf16 v[208:211], a[196:199], a[96:99], v[208:211]
    ds_read_b64_tr_b16 a[212:213], v25 offset:27648
    ds_read_b64_tr_b16 a[214:215], v25 offset:29952
    v_mfma_f32_16x16x32_bf16 v[212:215], a[196:199], a[104:107], v[212:215]
    s_add_u32 s29, s29, s30
    v_mfma_f32_16x16x32_bf16 v[216:219], a[196:199], a[112:115], v[216:219]
    s_add_u32 s56, s29, 0x300000
    v_mfma_f32_16x16x32_bf16 v[220:223], a[196:199], a[120:123], v[220:223]
    s_waitcnt lgkmcnt(6)
    s_cmp_ge_u32 s20, 2
    s_cselect_b32 s56, 0x7f000000, s56
    s_cselect_b32 s95, 0x7f000000, s95
    v_mfma_f32_16x16x32_bf16 v[224:227], a[200:203], a[96:99], v[224:227]
    ds_read_b64_tr_b16 a[216:217], v25 offset:9248
    ds_read_b64_tr_b16 a[218:219], v25 offset:11552
    v_mfma_f32_16x16x32_bf16 v[228:231], a[200:203], a[104:107], v[228:231]
    v_lshrrev_b32 v2, 4, v0
    v_mfma_f32_16x16x32_bf16 v[232:235], a[200:203], a[112:115], v[232:235]
    v_lshlrev_b32 v2, 4, v2
    v_mfma_f32_16x16x32_bf16 v[236:239], a[200:203], a[120:123], v[236:239]
    s_waitcnt lgkmcnt(6)
    v_sub_u32 v3, v51, v2
    v_mfma_f32_16x16x32_bf16 v[240:243], a[204:207], a[96:99], v[240:243]
    ds_read_b64_tr_b16 a[220:221], v25 offset:27680
    ds_read_b64_tr_b16 a[222:223], v25 offset:29984
    v_mfma_f32_16x16x32_bf16 v[244:247], a[204:207], a[104:107], v[244:247]
    s_lshl_b32 s29, s62, 8
    v_mfma_f32_16x16x32_bf16 v[248:251], a[204:207], a[112:115], v[248:251]
    s_add_u32 s30, s29, 56
    v_add_u32 v21, s30, v3
    v_mfma_f32_16x16x32_bf16 v[252:255], a[204:207], a[120:123], v[252:255]
    s_waitcnt lgkmcnt(6)
    s_lshl_b32 s30, s20, 7
    v_mfma_f32_16x16x32_bf16 v[64:67], a[208:211], a[100:103], v[64:67]
    ds_read_b64_tr_b16 a[224:225], v25 offset:9280
    ds_read_b64_tr_b16 a[226:227], v25 offset:11584
    v_mfma_f32_16x16x32_bf16 v[68:71], a[208:211], a[108:111], v[68:71]
    s_add_u32 s60, s61, 294912
    buffer_load_dword v57, v56, s[40:43], s60 offen
    v_mfma_f32_16x16x32_bf16 v[72:75], a[208:211], a[116:119], v[72:75]
    s_add_u32 s31, s30, 73784
    v_mfma_f32_16x16x32_bf16 v[76:79], a[208:211], a[124:127], v[76:79]
    s_waitcnt lgkmcnt(6)
    s_sub_u32 s31, s31, s51
pad_4:
    s_cbranch_execz pad_8
    v_add_u32 v23, s31, v3
    v_mfma_f32_16x16x32_bf16 a[0:3], a[212:215], a[100:103], a[0:3]
    ds_read_b64_tr_b16 a[228:229], v25 offset:27712
    ds_read_b64_tr_b16 a[230:231], v25 offset:30016
    v_mfma_f32_16x16x32_bf16 a[4:7], a[212:215], a[108:111], a[4:7]
    v_and_b32 v4, 15, v0
    v_mfma_f32_16x16x32_bf16 a[8:11], a[212:215], a[116:119], a[8:11]
    v_lshl_add_u32 v2, v4, 5, v2
    v_mfma_f32_16x16x32_bf16 a[12:15], a[212:215], a[124:127], a[12:15]
    s_waitcnt lgkmcnt(6)
    s_sub_u32 s29, s52, s29
    v_mfma_f32_16x16x32_bf16 v[80:83], a[216:219], a[100:103], v[80:83]
    ds_read_b64_tr_b16 a[192:193], v25 offset:9312
    ds_read_b64_tr_b16 a[194:195], v25 offset:11616
    v_mfma_f32_16x16x32_bf16 v[84:87], a[216:219], a[108:111], v[84:87]
    s_add_u32 s29, s29, 32
    v_add_u32 v22, s29, v2
    v_mfma_f32_16x16x32_bf16 v[88:91], a[216:219], a[116:119], v[88:91]
    s_sub_u32 s30, 90400, s30
    v_add_u32 v24, s30, v2
    v_mfma_f32_16x16x32_bf16 v[92:95], a[216:219], a[124:127], v[92:95]
    s_waitcnt lgkmcnt(6)
    v_and_b32 v61, 3, v0
    v_mfma_f32_16x16x32_bf16 a[16:19], a[220:223], a[100:103], a[16:19]
    ds_read_b64_tr_b16 a[196:197], v25 offset:27744
    ds_read_b64_tr_b16 a[198:199], v25 offset:30048
    v_mfma_f32_16x16x32_bf16 a[20:23], a[220:223], a[108:111], a[20:23]
    v_lshlrev_b32 v61, 9, v61
    v_mfma_f32_16x16x32_bf16 a[24:27], a[220:223], a[116:119], a[24:27]
    v_mfma_f32_16x16x32_bf16 a[28:31], a[220:223], a[124:127], a[28:31]
    s_waitcnt lgkmcnt(6)
    v_mfma_f32_16x16x32_bf16 v[96:99], a[224:227], a[100:103], v[96:99]
    ds_read_b64_tr_b16 a[200:201], v25 offset:9344
    ds_read_b64_tr_b16 a[202:203], v25 offset:11648
    v_mfma_f32_16x16x32_bf16 v[100:103], a[224:227], a[108:111], v[100:103]
    v_mfma_f32_16x16x32_bf16 v[104:107], a[224:227], a[116:119], v[104:107]
    v_mfma_f32_16x16x32_bf16 v[108:111], a[224:227], a[124:127], v[108:111]
    s_waitcnt lgkmcnt(6)
    v_mfma_f32_16x16x32_bf16 a[32:35], a[228:231], a[100:103], a[32:35]
    ds_read_b64_tr_b16 a[204:205], v25 offset:27776
    ds_read_b64_tr_b16 a[206:207], v25 offset:30080
    v_mfma_f32_16x16x32_bf16 a[36:39], a[228:231], a[108:111], a[36:39]
    v_mfma_f32_16x16x32_bf16 a[40:43], a[228:231], a[116:119], a[40:43]
    v_mfma_f32_16x16x32_bf16 a[44:47], a[228:231], a[124:127], a[44:47]
    s_waitcnt lgkmcnt(6)
    v_mfma_f32_16x16x32_bf16 v[112:115], a[192:195], a[100:103], v[112:115]
    ds_read_b64_tr_b16 a[208:209], v25 offset:9376
    ds_read_b64_tr_b16 a[210:211], v25 offset:11680
    v_mfma_f32_16x16x32_bf16 v[116:119], a[192:195], a[108:111], v[116:119]
    ds_read_b64_tr_b16 a[212:213], v25 offset:27808
    s_waitcnt vmcnt(15)
    v_cmp_ne_u64 vcc, v[62:63], v[54:55]
    s_nop 0
    s_cbranch_vccnz ups_10
upr_11:
    v_mfma_f32_16x16x32_bf16 v[120:123], a[192:195], a[116:119], v[120:123]
    ds_read_b64_tr_b16 a[214:215], v25 offset:30112
    s_add_u32 s29, s53, 646
    v_mfma_f32_16x16x32_bf16 v[124:127], a[192:195], a[124:127], v[124:127]
    s_waitcnt lgkmcnt(8)
    v_mov_b32 v53, s29
    v_lshlrev_b32 v6, 3, v0
    v_mfma_f32_16x16x32_bf16 a[48:51], a[196:199], a[100:103], a[48:51]
    ds_read_b64_tr_b16 a[216:217], v25 offset:9408
    ds_read_b64_tr_b16 a[218:219], v25 offset:11712
    v_mfma_f32_16x16x32_bf16 a[52:55], a[196:199], a[108:111], a[52:55]
    ds_read_b64_tr_b16 a[220:221], v25 offset:27840
    v_add_u32 v6, s52, v6
    v_mfma_f32_16x16x32_bf16 a[56:59], a[196:199], a[116:119], a[56:59]
    ds_read_b64_tr_b16 a[222:223], v25 offset:30144
    ds_read_b64 v[14:15], v47
    v_mfma_f32_16x16x32_bf16 a[60:63], a[196:199], a[124:127], a[60:63]
    s_waitcnt lgkmcnt(11)
    ds_read_b64 v[16:17], v47 offset:8
    ds_read_u16 v8, v45 offset:840
    v_mfma_f32_16x16x32_bf16 v[128:131], a[200:203], a[100:103], v[128:131]
    ds_read_b64_tr_b16 a[224:225], v25 offset:9440
    ds_read_b64_tr_b16 a[226:227], v25 offset:11744
    v_mfma_f32_16x16x32_bf16 v[132:135], a[200:203], a[108:111], v[132:135]
    ds_read_b64_tr_b16 a[228:229], v25 offset:27872
    ds_read_u16 v9, v45 offset:712
    v_mfma_f32_16x16x32_bf16 v[136:139], a[200:203], a[116:119], v[136:139]
    ds_read_b64_tr_b16 a[230:231], v25 offset:30176
    ds_read_u16 v10, v46 offset:646
    v_mfma_f32_16x16x32_bf16 v[140:143], a[200:203], a[124:127], v[140:143]
    s_waitcnt lgkmcnt(15)
    ds_read_u16 v11, v46 offset:774
    ds_read_u16 v12, v46 offset:776
    v_mfma_f32_16x16x32_bf16 a[64:67], a[204:207], a[100:103], a[64:67]
    ds_read_b64_tr_b16 a[192:193], v25 offset:9472
    ds_read_b64_tr_b16 a[194:195], v25 offset:11776
    v_mfma_f32_16x16x32_bf16 a[68:71], a[204:207], a[108:111], a[68:71]
    ds_read_b64_tr_b16 a[196:197], v25 offset:27904
    ds_read_u16 v18, v42 offset:1032
    v_mfma_f32_16x16x32_bf16 a[72:75], a[204:207], a[116:119], a[72:75]
    ds_read_b64_tr_b16 a[198:199], v25 offset:30208
    ds_read_u16 v19, v42 offset:1034
    v_mfma_f32_16x16x32_bf16 a[76:79], a[204:207], a[124:127], a[76:79]
    ds_read_u16 v20, v53
    v_mfma_f32_16x16x32_bf16 v[144:147], a[208:211], a[100:103], v[144:147]
    ds_read_b128 a[160:163], v28 offset:4096
    ds_read_b128 a[164:167], v29 offset:4096
    v_mfma_f32_16x16x32_bf16 v[148:151], a[208:211], a[108:111], v[148:151]
    v_mfma_f32_16x16x32_bf16 v[152:155], a[208:211], a[116:119], v[152:155]
    v_mfma_f32_16x16x32_bf16 v[156:159], a[208:211], a[124:127], v[156:159]
    s_waitcnt lgkmcnt(15)
    v_mfma_f32_16x16x32_bf16 a[80:83], a[212:215], a[100:103], a[80:83]
    ds_read_b128 a[168:171], v28 offset:6144
    ds_read_b128 a[172:175], v29 offset:6144
    v_mfma_f32_16x16x32_bf16 a[84:87], a[212:215], a[108:111], a[84:87]
    v_mfma_f32_16x16x32_bf16 a[88:91], a[212:215], a[116:119], a[88:91]
    v_mfma_f32_16x16x32_bf16 a[92:95], a[212:215], a[124:127], a[92:95]
    v_mfma_f32_16x16x32_bf16 v[160:163], a[216:219], a[100:103], v[160:163]
    v_mfma_f32_16x16x32_bf16 v[164:167], a[216:219], a[108:111], v[164:167]
    v_mfma_f32_16x16x32_bf16 v[168:171], a[216:219], a[116:119], v[168:171]
    v_mfma_f32_16x16x32_bf16 v[172:175], a[216:219], a[124:127], v[172:175]
    v_mfma_f32_16x16x32_bf16 v[176:179], a[220:223], a[100:103], v[176:179]
    v_mfma_f32_16x16x32_bf16 v[180:183], a[220:223], a[108:111], v[180:183]
    v_mfma_f32_16x16x32_bf16 v[184:187], a[220:223], a[116:119], v[184:187]
    v_mfma_f32_16x16x32_bf16 v[188:191], a[220:223], a[124:127], v[188:191]
    s_waitcnt lgkmcnt(0)
    s_barrier
    v_mfma_f32_16x16x32_bf16 v[192:195], a[224:227], a[100:103], v[192:195]
    ds_read_b64_tr_b16 a[200:201], v26 offset:0
    ds_read_b64_tr_b16 a[202:203], v26 offset:2304
    v_mfma_f32_16x16x32_bf16 v[196:199], a[224:227], a[108:111], v[196:199]
    v_mfma_f32_16x16x32_bf16 v[200:203], a[224:227], a[116:119], v[200:203]
    v_mfma_f32_16x16x32_bf16 v[204:207], a[224:227], a[124:127], v[204:207]
    v_mfma_f32_16x16x32_bf16 v[208:211], a[228:231], a[100:103], v[208:211]
    ds_read_b64_tr_b16 a[204:205], v26 offset:18432
    ds_read_b64_tr_b16 a[206:207], v26 offset:20736
    v_mfma_f32_16x16x32_bf16 v[212:215], a[228:231], a[108:111], v[212:215]
    s_waitcnt vmcnt(3)
    ds_read_b128 a[176:179], v28 offset:8192
    v_mov_b32 v54, 0
    v_mfma_f32_16x16x32_bf16 v[216:219], a[228:231], a[116:119], v[216:219]
    ds_read_b128 a[180:183], v29 offset:8192
    v_mov_b32 v55, 0
    v_mfma_f32_16x16x32_bf16 v[220:223], a[228:231], a[124:127], v[220:223]
    ds_write_b64 v51, v[54:55]
    ds_write_b64 v50, v[16:17] offset:32
    v_mfma_f32_16x16x32_bf16 v[224:227], a[192:195], a[100:103], v[224:227]
    ds_read_b64_tr_b16 a[208:209], v26 offset:9216
    ds_read_b64_tr_b16 a[210:211], v26 offset:11520
    v_mfma_f32_16x16x32_bf16 v[228:231], a[192:195], a[108:111], v[228:231]
    ds_read_b128 a[184:187], v28 offset:10240
    v_alignbit_b32 v2, v16, v15, 16
    v_mfma_f32_16x16x32_bf16 v[232:235], a[192:195], a[116:119], v[232:235]
    ds_read_b128 a[188:191], v29 offset:10240
    v_alignbit_b32 v3, v17, v16, 16
    v_mfma_f32_16x16x32_bf16 v[236:239], a[192:195], a[124:127], v[236:239]
    ds_write_b64 v50, v[2:3] offset:4192
    v_mov_b32 v4, v15
    v_mfma_f32_16x16x32_bf16 v[240:243], a[196:199], a[100:103], v[240:243]
    ds_read_b64_tr_b16 a[212:213], v26 offset:27648
    ds_read_b64_tr_b16 a[214:215], v26 offset:29952
    v_mfma_f32_16x16x32_bf16 v[244:247], a[196:199], a[108:111], v[244:247]
    v_mov_b32 v5, v16
    v_mfma_f32_16x16x32_bf16 v[248:251], a[196:199], a[116:119], v[248:251]
    ds_write_b64 v50, v[4:5] offset:8352
    v_alignbit_b32 v54, v15, v14, 16
    v_mfma_f32_16x16x32_bf16 v[252:255], a[196:199], a[124:127], v[252:255]
    s_waitcnt lgkmcnt(14)
    v_mov_b32 v55, v2
    s_waitcnt vmcnt(1) lgkmcnt(4)
    s_barrier
    v_mfma_f32_16x16x32_bf16 v[64:67], a[200:203], a[128:131], v[64:67]
    ds_read_b64_tr_b16 a[216:217], v27 offset:0
    ds_read_b64_tr_b16 a[218:219], v27 offset:2304
    v_mfma_f32_16x16x32_bf16 v[68:71], a[200:203], a[136:139], v[68:71]
    buffer_load_dwordx4 v1, s[32:35], s75 offen offset:0 sc1 lds
    ds_write_b64 v50, v[54:55] offset:12512
    v_mfma_f32_16x16x32_bf16 v[72:75], a[200:203], a[144:147], v[72:75]
    v_lshl_or_b32 v4, v8, 16, v8
    v_lshl_or_b32 v5, v12, 16, v9
    v_mfma_f32_16x16x32_bf16 v[76:79], a[200:203], a[152:155], v[76:79]
    ds_write_b64 v50, v[4:5] offset:544
    v_lshl_or_b32 v5, v9, 16, v8
    v_mfma_f32_16x16x32_bf16 a[0:3], a[204:207], a[128:131], a[0:3]
    ds_read_b64_tr_b16 a[220:221], v27 offset:18432
    ds_read_b64_tr_b16 a[222:223], v27 offset:20736
    v_mfma_f32_16x16x32_bf16 a[4:7], a[204:207], a[136:139], a[4:7]
    buffer_load_dwordx4 v1, s[32:35], s75 offen offset:1024 sc1 lds
    ds_write_b64 v50, v[4:5] offset:4704
    v_mfma_f32_16x16x32_bf16 a[8:11], a[204:207], a[144:147], a[8:11]
    s_add_u32 m0, s23, 110592
    buffer_load_dwordx4 a[232:235], v1, s[32:35], s77 offen sc1
    v_lshl_or_b32 v4, v8, 16, v10
    v_mfma_f32_16x16x32_bf16 a[12:15], a[204:207], a[152:155], a[12:15]
    v_lshl_or_b32 v5, v8, 16, v8
    v_mfma_f32_16x16x32_bf16 v[64:67], a[208:211], a[132:135], v[64:67]
    ds_read_b64_tr_b16 a[224:225], v27 offset:9216
    ds_read_b64_tr_b16 a[226:227], v27 offset:11520
    v_mfma_f32_16x16x32_bf16 v[68:71], a[208:211], a[140:143], v[68:71]
    s_add_u32 s60, s59, 0
    buffer_load_dwordx4 v32, s[40:43], s60 offen offset:0 lds
    ds_write_b64 v50, v[4:5] offset:8864
    v_mfma_f32_16x16x32_bf16 v[72:75], a[208:211], a[148:151], v[72:75]
    v_lshl_or_b32 v4, v10, 16, v11
    v_mfma_f32_16x16x32_bf16 v[76:79], a[208:211], a[156:159], v[76:79]
    s_waitcnt lgkmcnt(11)
    ds_write_b64 v50, v[4:5] offset:13024
    ds_write_b16_d16_hi v50, v17 offset:4200
    v_mfma_f32_16x16x32_bf16 a[0:3], a[212:215], a[132:135], a[0:3]
    ds_read_b64_tr_b16 a[228:229], v27 offset:27648
    ds_read_b64_tr_b16 a[230:231], v27 offset:29952
    v_mfma_f32_16x16x32_bf16 a[4:7], a[212:215], a[140:143], a[4:7]
    buffer_load_dwordx4 v33, s[40:43], s60 offen offset:1024 lds
    ds_write_b32 v50, v17 offset:8360
    v_mfma_f32_16x16x32_bf16 a[8:11], a[212:215], a[148:151], a[8:11]
    ds_write_b32 v50, v3 offset:12520
    ds_write_b16_d16_hi v50, v17 offset:12524
    v_mfma_f32_16x16x32_bf16 a[12:15], a[212:215], a[156:159], a[12:15]
    s_waitcnt lgkmcnt(15)
    ds_read_u16 v8, v43 offset:518
    ds_read_u16 v9, v41 offset:520
    v_mfma_f32_16x16x32_bf16 v[64:67], a[216:219], a[160:163], v[64:67]
    ds_read_b64_tr_b16 a[192:193], v26 offset:32
    ds_read_b64_tr_b16 a[194:195], v26 offset:2336
    v_mfma_f32_16x16x32_bf16 v[68:71], a[216:219], a[168:171], v[68:71]
    buffer_load_dwordx4 v34, s[40:43], s60 offen offset:2048 lds
    ds_read_u16 v10, v41 offset:904
    v_mfma_f32_16x16x32_bf16 v[72:75], a[216:219], a[176:179], v[72:75]
    ds_read_u16 v11, v41 offset:906
    ds_read_u16 v12, v44 offset:904
    v_mfma_f32_16x16x32_bf16 v[76:79], a[216:219], a[184:187], v[76:79]
    s_waitcnt lgkmcnt(15)
    v_perm_b32 v14, v19, v18, s80
    v_perm_b32 v15, v19, v18, s80
    v_mfma_f32_16x16x32_bf16 a[0:3], a[220:223], a[160:163], a[0:3]
    ds_read_b64_tr_b16 a[196:197], v26 offset:18464
    ds_read_b64_tr_b16 a[198:199], v26 offset:20768
    v_mfma_f32_16x16x32_bf16 a[4:7], a[220:223], a[168:171], a[4:7]
    v_perm_b32 v16, v19, v18, v30
    v_perm_b32 v17, v19, v18, s81
    v_mfma_f32_16x16x32_bf16 a[8:11], a[220:223], a[176:179], a[8:11]
    ds_write_b128 v48, v[14:17] offset:2080
    v_perm_b32 v16, v19, v18, v31
    v_mfma_f32_16x16x32_bf16 a[12:15], a[220:223], a[184:187], a[12:15]
    v_lshl_or_b32 v20, v18, 16, v20
    v_mfma_f32_16x16x32_bf16 v[64:67], a[224:227], a[164:167], v[64:67]
    ds_read_b64_tr_b16 a[200:201], v26 offset:9248
    ds_read_b64_tr_b16 a[202:203], v26 offset:11552
    v_mfma_f32_16x16x32_bf16 v[68:71], a[224:227], a[172:175], v[68:71]
    buffer_load_dwordx4 v35, s[40:43], s60 offen offset:3072 lds
    ds_write_b128 v48, v[14:17] offset:6240
    v_mfma_f32_16x16x32_bf16 v[72:75], a[224:227], a[180:183], v[72:75]
    s_add_u32 m0, s23, 114688
    v_mov_b32 v16, v14
    v_perm_b32 v17, v19, v18, v30
    v_mfma_f32_16x16x32_bf16 v[76:79], a[224:227], a[188:191], v[76:79]
    s_waitcnt lgkmcnt(15)
    ds_write_b128 v48, v[14:17] offset:10400
    v_perm_b32 v17, v19, v18, v31
    v_mfma_f32_16x16x32_bf16 a[0:3], a[228:231], a[164:167], a[0:3]
    ds_read_b64_tr_b16 a[204:205], v26 offset:27680
    ds_read_b64_tr_b16 a[206:207], v26 offset:29984
    v_mfma_f32_16x16x32_bf16 a[4:7], a[228:231], a[172:175], a[4:7]
    buffer_load_dwordx4 v36, s[40:43], s60 offen offset:0 lds
    v_cndmask_b32 v14, v14, v20, s[78:79]
    v_mfma_f32_16x16x32_bf16 a[8:11], a[228:231], a[180:183], a[8:11]
    ds_write_b128 v48, v[14:17] offset:14560
    s_waitcnt lgkmcnt(10)
    v_lshl_or_b32 v2, v10, 16, v10
    v_mfma_f32_16x16x32_bf16 a[12:15], a[228:231], a[188:191], a[12:15]
    v_lshl_or_b32 v3, v9, 16, v10
    v_lshl_or_b32 v4, v9, 16, v9
    v_mfma_f32_16x16x32_bf16 v[80:83], a[192:195], a[128:131], v[80:83]
    ds_read_b64_tr_b16 a[208:209], v27 offset:32
    ds_read_b64_tr_b16 a[210:211], v27 offset:2336
    v_mfma_f32_16x16x32_bf16 v[84:87], a[192:195], a[136:139], v[84:87]
    buffer_load_dwordx4 v37, s[40:43], s60 offen offset:1024 lds
    v_lshl_or_b32 v5, v11, 16, v11
    v_mfma_f32_16x16x32_bf16 v[88:91], a[192:195], a[144:147], v[88:91]
    ds_write_b128 v49, v[2:5] offset:1056
    v_lshl_or_b32 v3, v10, 16, v10
    v_mfma_f32_16x16x32_bf16 v[92:95], a[192:195], a[152:155], v[92:95]
    s_waitcnt lgkmcnt(11)
    v_lshl_or_b32 v5, v11, 16, v9
    v_mfma_f32_16x16x32_bf16 a[16:19], a[196:199], a[128:131], a[16:19]
    ds_read_b64_tr_b16 a[212:213], v27 offset:18464
    ds_read_b64_tr_b16 a[214:215], v27 offset:20768
    v_mfma_f32_16x16x32_bf16 a[20:23], a[196:199], a[136:139], a[20:23]
    ds_write_b128 v49, v[2:5] offset:5216
    v_lshl_or_b32 v2, v10, 16, v12
    v_mfma_f32_16x16x32_bf16 a[24:27], a[196:199], a[144:147], a[24:27]
    v_accvgpr_read_b32 v28, a0
    v_accvgpr_read_b32 v29, a1
    v_mfma_f32_16x16x32_bf16 a[28:31], a[196:199], a[152:155], a[28:31]
    s_waitcnt lgkmcnt(11)
    v_mul_f32 v64, v64, v28
    v_mul_f32 v65, v65, v29
    v_mfma_f32_16x16x32_bf16 v[80:83], a[200:203], a[132:135], v[80:83]
    ds_read_b64_tr_b16 a[216:217], v27 offset:9248
    ds_read_b64_tr_b16 a[218:219], v27 offset:11552
    v_mfma_f32_16x16x32_bf16 v[84:87], a[200:203], a[140:143], v[84:87]
    buffer_load_dwordx4 v38, s[40:43], s60 offen offset:2048 lds
    v_lshl_or_b32 v4, v9, 16, v10
    v_mfma_f32_16x16x32_bf16 v[88:91], a[200:203], a[148:151], v[88:91]
    v_accvgpr_read_b32 v28, a2
    v_accvgpr_read_b32 v29, a3
    v_mfma_f32_16x16x32_bf16 v[92:95], a[200:203], a[156:159], v[92:95]
    s_waitcnt lgkmcnt(9)
    v_mul_f32 v66, v66, v28
    v_mul_f32 v67, v67, v29
    v_mfma_f32_16x16x32_bf16 a[16:19], a[204:207], a[132:135], a[16:19]
    ds_read_b64_tr_b16 a[220:221], v27 offset:27680
    ds_read_b64_tr_b16 a[222:223], v27 offset:29984
    v_mfma_f32_16x16x32_bf16 a[20:23], a[204:207], a[140:143], a[20:23]
    buffer_load_dwordx4 v39, s[40:43], s60 offen offset:3072 lds
    v_lshl_or_b32 v5, v9, 16, v9
    v_mfma_f32_16x16x32_bf16 a[24:27], a[204:207], a[148:151], a[24:27]
    s_add_u32 m0, s23, 118784
    v_cvt_pk_bf16_f32 v64, v64, v65
    v_cvt_pk_bf16_f32 v65, v66, v67
    v_mfma_f32_16x16x32_bf16 a[28:31], a[204:207], a[156:159], a[28:31]
    s_waitcnt lgkmcnt(8)
    v_accvgpr_read_b32 v28, a4
    v_accvgpr_read_b32 v29, a5
    v_mfma_f32_16x16x32_bf16 v[80:83], a[208:211], a[160:163], v[80:83]
    ds_read_b64_tr_b16 a[224:225], v26 offset:64
    ds_read_b64_tr_b16 a[226:227], v26 offset:2368
    v_mfma_f32_16x16x32_bf16 v[84:87], a[208:211], a[168:171], v[84:87]
    s_add_u32 s60, s3, 0
    buffer_load_dwordx4 v1, s[16:19], s60 offen lds
    ds_write_b128 v49, v[2:5] offset:9376
    v_mfma_f32_16x16x32_bf16 v[88:91], a[208:211], a[176:179], v[88:91]
    v_mul_f32 v68, v68, v28
    v_mul_f32 v69, v69, v29
    v_mfma_f32_16x16x32_bf16 v[92:95], a[208:211], a[184:187], v[92:95]
    s_waitcnt lgkmcnt(8)
    v_accvgpr_read_b32 v28, a6
    v_accvgpr_read_b32 v29, a7
    v_mfma_f32_16x16x32_bf16 a[16:19], a[212:215], a[160:163], a[16:19]
    ds_read_b64_tr_b16 a[228:229], v26 offset:18496
    ds_read_b64_tr_b16 a[230:231], v26 offset:20800
    v_mfma_f32_16x16x32_bf16 a[20:23], a[212:215], a[168:171], a[20:23]
    v_lshl_or_b32 v2, v12, 16, v8
    v_lshl_or_b32 v4, v10, 16, v10
    v_mfma_f32_16x16x32_bf16 a[24:27], a[212:215], a[176:179], a[24:27]
    v_mul_f32 v70, v70, v28
    v_mul_f32 v71, v71, v29
    v_mfma_f32_16x16x32_bf16 a[28:31], a[212:215], a[184:187], a[28:31]
    s_waitcnt lgkmcnt(7)
    v_cvt_pk_bf16_f32 v68, v68, v69
    v_cvt_pk_bf16_f32 v69, v70, v71
    v_mfma_f32_16x16x32_bf16 v[80:83], a[216:219], a[164:167], v[80:83]
    ds_read_b64_tr_b16 a[192:193], v26 offset:9280
    ds_read_b64_tr_b16 a[194:195], v26 offset:11584
    v_mfma_f32_16x16x32_bf16 v[84:87], a[216:219], a[172:175], v[84:87]
    ds_write_b128 v49, v[2:5] offset:13536
    s_sub_u32 s29, 162384, s53
    v_mfma_f32_16x16x32_bf16 v[88:91], a[216:219], a[180:183], v[88:91]
    v_accvgpr_read_b32 v28, a8
    v_accvgpr_read_b32 v29, a9
    v_mfma_f32_16x16x32_bf16 v[92:95], a[216:219], a[188:191], v[92:95]
    s_waitcnt lgkmcnt(8)
    v_mul_f32 v72, v72, v28
    v_mul_f32 v73, v73, v29
    v_mfma_f32_16x16x32_bf16 a[16:19], a[220:223], a[164:167], a[16:19]
    ds_read_b64_tr_b16 a[196:197], v26 offset:27712
    ds_read_b64_tr_b16 a[198:199], v26 offset:30016
    v_mfma_f32_16x16x32_bf16 a[20:23], a[220:223], a[172:175], a[20:23]
    s_sub_u32 s30, 73728, s51
    v_add_u32 v41, s29, v41
    v_add_u32 v43, s29, v43
    v_mfma_f32_16x16x32_bf16 a[24:27], a[220:223], a[180:183], a[24:27]
    v_accvgpr_read_b32 v28, a10
    v_accvgpr_read_b32 v29, a11
    v_mfma_f32_16x16x32_bf16 a[28:31], a[220:223], a[188:191], a[28:31]
    s_waitcnt lgkmcnt(8)
    v_mul_f32 v74, v74, v28
    v_mul_f32 v75, v75, v29
    v_mfma_f32_16x16x32_bf16 v[96:99], a[224:227], a[128:131], v[96:99]
    ds_read_b64_tr_b16 a[200:201], v27 offset:64
    ds_read_b64_tr_b16 a[202:203], v27 offset:2368
    v_mfma_f32_16x16x32_bf16 v[100:103], a[224:227], a[136:139], v[100:103]
    v_add_u32 v44, s29, v44
    v_add_u32 v45, s29, v45
    v_mfma_f32_16x16x32_bf16 v[104:107], a[224:227], a[144:147], v[104:107]
    v_cvt_pk_bf16_f32 v72, v72, v73
    v_cvt_pk_bf16_f32 v73, v74, v75
    v_mfma_f32_16x16x32_bf16 v[108:111], a[224:227], a[152:155], v[108:111]
    s_waitcnt lgkmcnt(7)
    v_accvgpr_read_b32 v28, a12
    v_accvgpr_read_b32 v29, a13
    v_mfma_f32_16x16x32_bf16 a[32:35], a[228:231], a[128:131], a[32:35]
    ds_read_b64_tr_b16 a[204:205], v27 offset:18496
    ds_read_b64_tr_b16 a[206:207], v27 offset:20800
    v_mfma_f32_16x16x32_bf16 a[36:39], a[228:231], a[136:139], a[36:39]
    v_add_u32 v46, s29, v46
    v_add_u32 v47, s29, v47
    v_mfma_f32_16x16x32_bf16 a[40:43], a[228:231], a[144:147], a[40:43]
    v_mul_f32 v76, v76, v28
    v_mul_f32 v77, v77, v29
    v_mfma_f32_16x16x32_bf16 a[44:47], a[228:231], a[152:155], a[44:47]
    s_waitcnt lgkmcnt(7)
    v_accvgpr_read_b32 v28, a14
    v_accvgpr_read_b32 v29, a15
    v_mfma_f32_16x16x32_bf16 v[96:99], a[192:195], a[132:135], v[96:99]
    ds_read_b64_tr_b16 a[208:209], v27 offset:9280
    ds_read_b64_tr_b16 a[210:211], v27 offset:11584
    v_mfma_f32_16x16x32_bf16 v[100:103], a[192:195], a[140:143], v[100:103]
    v_add_u32 v49, s30, v49
    v_add_u32 v50, s30, v50
    v_mfma_f32_16x16x32_bf16 v[104:107], a[192:195], a[148:151], v[104:107]
    v_mul_f32 v78, v78, v28
    v_mul_f32 v79, v79, v29
    v_mfma_f32_16x16x32_bf16 v[108:111], a[192:195], a[156:159], v[108:111]
    s_waitcnt lgkmcnt(6)
    v_cvt_pk_bf16_f32 v76, v76, v77
    v_cvt_pk_bf16_f32 v77, v78, v79
    v_mfma_f32_16x16x32_bf16 a[32:35], a[196:199], a[132:135], a[32:35]
    ds_read_b64_tr_b16 a[212:213], v27 offset:27712
    ds_read_b64_tr_b16 a[214:215], v27 offset:30016
    v_mfma_f32_16x16x32_bf16 a[36:39], a[196:199], a[140:143], a[36:39]
    v_add_u32 v51, s30, v51
    s_lshr_b32 s31, s20, 1
    v_mfma_f32_16x16x32_bf16 a[40:43], a[196:199], a[148:151], a[40:43]
    v_accvgpr_read_b32 v28, a16
    v_accvgpr_read_b32 v29, a17
    v_mfma_f32_16x16x32_bf16 a[44:47], a[196:199], a[156:159], a[44:47]
    s_waitcnt lgkmcnt(6)
    v_mul_f32 v80, v80, v28
    v_mul_f32 v81, v81, v29
    v_mfma_f32_16x16x32_bf16 v[96:99], a[200:203], a[160:163], v[96:99]
    ds_read_b64_tr_b16 a[216:217], v26 offset:96
    ds_read_b64_tr_b16 a[218:219], v26 offset:2400
    v_mfma_f32_16x16x32_bf16 v[100:103], a[200:203], a[168:171], v[100:103]
    s_xor_b32 s78, s31, 1
    s_lshl_b32 s31, s31, 7
    v_add_u32 v42, s31, v41
    v_mfma_f32_16x16x32_bf16 v[104:107], a[200:203], a[176:179], v[104:107]
    v_accvgpr_read_b32 v28, a18
    v_accvgpr_read_b32 v29, a19
    v_mfma_f32_16x16x32_bf16 v[108:111], a[200:203], a[184:187], v[108:111]
    s_waitcnt lgkmcnt(6)
    v_mul_f32 v82, v82, v28
    v_mul_f32 v83, v83, v29
    v_mfma_f32_16x16x32_bf16 a[32:35], a[204:207], a[160:163], a[32:35]
    ds_read_b64_tr_b16 a[220:221], v26 offset:18528
    ds_read_b64_tr_b16 a[222:223], v26 offset:20832
    v_mfma_f32_16x16x32_bf16 a[36:39], a[204:207], a[168:171], a[36:39]
    s_lshl_b32 s31, s31, 3
    v_add_u32 v48, s31, v49
    v_mov_b32 v53, 163030
    v_mfma_f32_16x16x32_bf16 a[40:43], a[204:207], a[176:179], a[40:43]
    v_cvt_pk_bf16_f32 v66, v80, v81
    v_cvt_pk_bf16_f32 v67, v82, v83
    v_mfma_f32_16x16x32_bf16 a[44:47], a[204:207], a[184:187], a[44:47]
    s_waitcnt lgkmcnt(6)
    buffer_store_dwordx4 v[64:67], v1, s[16:19], s26 offen offset:0 sc1
    v_accvgpr_read_b32 v28, a20
    v_mfma_f32_16x16x32_bf16 v[96:99], a[208:211], a[164:167], v[96:99]
    ds_read_b64_tr_b16 a[224:225], v26 offset:9312
    ds_read_b64_tr_b16 a[226:227], v26 offset:11616
    v_mfma_f32_16x16x32_bf16 v[100:103], a[208:211], a[172:175], v[100:103]
    v_mov_b32 v54, 0
    v_mov_b32 v55, 0
    v_mfma_f32_16x16x32_bf16 v[104:107], a[208:211], a[180:183], v[104:107]
    v_accvgpr_read_b32 v29, a21
    v_mul_f32 v84, v84, v28
    v_mfma_f32_16x16x32_bf16 v[108:111], a[208:211], a[188:191], v[108:111]
    s_waitcnt lgkmcnt(6)
    v_mul_f32 v85, v85, v29
    v_accvgpr_read_b32 v28, a22
    v_mfma_f32_16x16x32_bf16 a[32:35], a[212:215], a[164:167], a[32:35]
    ds_read_b64_tr_b16 a[228:229], v26 offset:27744
    ds_read_b64_tr_b16 a[230:231], v26 offset:30048
    v_mfma_f32_16x16x32_bf16 a[36:39], a[212:215], a[172:175], a[36:39]
    ds_write_b64 v6, v[54:55]
    v_lshlrev_b32 v6, 3, v0
    v_mfma_f32_16x16x32_bf16 a[40:43], a[212:215], a[180:183], a[40:43]
    v_accvgpr_read_b32 v29, a23
    v_mul_f32 v86, v86, v28
    v_mfma_f32_16x16x32_bf16 a[44:47], a[212:215], a[188:191], a[44:47]
    s_waitcnt lgkmcnt(7)
    v_mul_f32 v87, v87, v29
    v_cvt_pk_bf16_f32 v70, v84, v85
    v_mfma_f32_16x16x32_bf16 v[112:115], a[216:219], a[128:131], v[112:115]
    ds_read_b64_tr_b16 a[192:193], v27 offset:96
    ds_read_b64_tr_b16 a[194:195], v27 offset:2400
    v_mfma_f32_16x16x32_bf16 v[116:119], a[216:219], a[136:139], v[116:119]
    v_add_u32 v6, 90368, v6
    v_add_u32 v13, s76, v1
    v_mfma_f32_16x16x32_bf16 v[120:123], a[216:219], a[144:147], v[120:123]
    v_cvt_pk_bf16_f32 v71, v86, v87
    v_accvgpr_read_b32 v28, a24
    v_mfma_f32_16x16x32_bf16 v[124:127], a[216:219], a[152:155], v[124:127]
    s_waitcnt lgkmcnt(7)
    buffer_store_dwordx4 v[68:71], v1, s[16:19], s26 offen offset:1024 sc1
    v_accvgpr_read_b32 v29, a25
    v_mfma_f32_16x16x32_bf16 a[48:51], a[220:223], a[128:131], a[48:51]
    ds_read_b64_tr_b16 a[196:197], v27 offset:18528
    ds_read_b64_tr_b16 a[198:199], v27 offset:20832
    v_mfma_f32_16x16x32_bf16 a[52:55], a[220:223], a[136:139], a[52:55]
    v_mul_f32 v88, v88, v28
    v_mul_f32 v89, v89, v29
    v_mfma_f32_16x16x32_bf16 a[56:59], a[220:223], a[144:147], a[56:59]
    v_accvgpr_read_b32 v28, a26
    v_accvgpr_read_b32 v29, a27
    v_mfma_f32_16x16x32_bf16 a[60:63], a[220:223], a[152:155], a[60:63]
    s_waitcnt lgkmcnt(7)
    v_mul_f32 v90, v90, v28
    v_mul_f32 v91, v91, v29
    v_mfma_f32_16x16x32_bf16 v[112:115], a[224:227], a[132:135], v[112:115]
    ds_read_b64_tr_b16 a[200:201], v27 offset:9312
    ds_read_b64_tr_b16 a[202:203], v27 offset:11616
    v_mfma_f32_16x16x32_bf16 v[116:119], a[224:227], a[140:143], v[116:119]
    v_cvt_pk_bf16_f32 v74, v88, v89
    v_cvt_pk_bf16_f32 v75, v90, v91
    v_mfma_f32_16x16x32_bf16 v[120:123], a[224:227], a[148:151], v[120:123]
    v_accvgpr_read_b32 v28, a28
    v_accvgpr_read_b32 v29, a29
    v_mfma_f32_16x16x32_bf16 v[124:127], a[224:227], a[156:159], v[124:127]
    s_waitcnt lgkmcnt(7)
    v_mul_f32 v92, v92, v28
    v_mul_f32 v93, v93, v29
    v_mfma_f32_16x16x32_bf16 a[48:51], a[228:231], a[132:135], a[48:51]
    ds_read_b64_tr_b16 a[204:205], v27 offset:27744
    ds_read_b64_tr_b16 a[206:207], v27 offset:30048
    v_mfma_f32_16x16x32_bf16 a[52:55], a[228:231], a[140:143], a[52:55]
    v_accvgpr_read_b32 v28, a30
    v_accvgpr_read_b32 v29, a31
    v_mfma_f32_16x16x32_bf16 a[56:59], a[228:231], a[148:151], a[56:59]
    v_mul_f32 v94, v94, v28
    v_mul_f32 v95, v95, v29
    v_mfma_f32_16x16x32_bf16 a[60:63], a[228:231], a[156:159], a[60:63]
    s_waitcnt lgkmcnt(6)
    v_cvt_pk_bf16_f32 v78, v92, v93
    v_cvt_pk_bf16_f32 v79, v94, v95
    v_mfma_f32_16x16x32_bf16 v[112:115], a[192:195], a[160:163], v[112:115]
    ds_read_b64_tr_b16 a[208:209], v26 offset:128
    ds_read_b64_tr_b16 a[210:211], v26 offset:2432
    v_mfma_f32_16x16x32_bf16 v[116:119], a[192:195], a[168:171], v[116:119]
    buffer_store_dwordx4 v[72:75], v1, s[16:19], s26 offen offset:2048 sc1
    v_accvgpr_read_b32 v28, a32
    v_mfma_f32_16x16x32_bf16 v[120:123], a[192:195], a[176:179], v[120:123]
    v_accvgpr_read_b32 v29, a33
    v_mul_f32 v96, v96, v28
    v_mfma_f32_16x16x32_bf16 v[124:127], a[192:195], a[184:187], v[124:127]
    s_waitcnt lgkmcnt(6)
    v_mul_f32 v97, v97, v29
    v_accvgpr_read_b32 v28, a34
    v_mfma_f32_16x16x32_bf16 a[48:51], a[196:199], a[160:163], a[48:51]
    ds_read_b64_tr_b16 a[212:213], v26 offset:18560
    ds_read_b64_tr_b16 a[214:215], v26 offset:20864
    v_mfma_f32_16x16x32_bf16 a[52:55], a[196:199], a[168:171], a[52:55]
    v_accvgpr_read_b32 v29, a35
    v_mul_f32 v98, v98, v28
    v_mfma_f32_16x16x32_bf16 a[56:59], a[196:199], a[176:179], a[56:59]
    v_mul_f32 v99, v99, v29
    v_cvt_pk_bf16_f32 v96, v96, v97
    v_mfma_f32_16x16x32_bf16 a[60:63], a[196:199], a[184:187], a[60:63]
    s_waitcnt lgkmcnt(6)
    v_cvt_pk_bf16_f32 v97, v98, v99
    v_accvgpr_read_b32 v28, a36
    v_mfma_f32_16x16x32_bf16 v[112:115], a[200:203], a[164:167], v[112:115]
    ds_read_b64_tr_b16 a[216:217], v26 offset:9344
    ds_read_b64_tr_b16 a[218:219], v26 offset:11648
    v_mfma_f32_16x16x32_bf16 v[116:119], a[200:203], a[172:175], v[116:119]
    v_accvgpr_read_b32 v29, a37
    v_mul_f32 v100, v100, v28
    v_mfma_f32_16x16x32_bf16 v[120:123], a[200:203], a[180:183], v[120:123]
    v_mul_f32 v101, v101, v29
    v_accvgpr_read_b32 v28, a38
    v_mfma_f32_16x16x32_bf16 v[124:127], a[200:203], a[188:191], v[124:127]
    s_waitcnt lgkmcnt(6)
    v_accvgpr_read_b32 v29, a39
    v_mul_f32 v102, v102, v28
    v_mfma_f32_16x16x32_bf16 a[48:51], a[204:207], a[164:167], a[48:51]
    ds_read_b64_tr_b16 a[220:221], v26 offset:27776
    ds_read_b64_tr_b16 a[222:223], v26 offset:30080
    v_mfma_f32_16x16x32_bf16 a[52:55], a[204:207], a[172:175], a[52:55]
    v_mul_f32 v103, v103, v29
pad_5:
    s_cbranch_execz pad_9
    v_cvt_pk_bf16_f32 v100, v100, v101
    v_mfma_f32_16x16x32_bf16 a[56:59], a[204:207], a[180:183], a[56:59]
    v_cvt_pk_bf16_f32 v101, v102, v103
    v_accvgpr_read_b32 v28, a40
    v_mfma_f32_16x16x32_bf16 a[60:63], a[204:207], a[188:191], a[60:63]
    s_waitcnt lgkmcnt(6)
    v_accvgpr_read_b32 v29, a41
    v_mul_f32 v104, v104, v28
    v_mfma_f32_16x16x32_bf16 v[128:131], a[208:211], a[128:131], v[128:131]
    ds_read_b64_tr_b16 a[224:225], v27 offset:128
    ds_read_b64_tr_b16 a[226:227], v27 offset:2432
    v_mfma_f32_16x16x32_bf16 v[132:135], a[208:211], a[136:139], v[132:135]
    buffer_store_dwordx4 v[76:79], v1, s[16:19], s26 offen offset:3072 sc1
    v_mul_f32 v105, v105, v29
    v_mfma_f32_16x16x32_bf16 v[136:139], a[208:211], a[144:147], v[136:139]
    v_accvgpr_read_b32 v28, a42
    v_accvgpr_read_b32 v29, a43
    v_mfma_f32_16x16x32_bf16 v[140:143], a[208:211], a[152:155], v[140:143]
    s_waitcnt lgkmcnt(6)
    v_mul_f32 v106, v106, v28
    v_mul_f32 v107, v107, v29
    v_mfma_f32_16x16x32_bf16 a[64:67], a[212:215], a[128:131], a[64:67]
    ds_read_b64_tr_b16 a[228:229], v27 offset:18560
    ds_read_b64_tr_b16 a[230:231], v27 offset:20864
    v_mfma_f32_16x16x32_bf16 a[68:71], a[212:215], a[136:139], a[68:71]
    v_cvt_pk_bf16_f32 v104, v104, v105
    v_cvt_pk_bf16_f32 v105, v106, v107
    v_mfma_f32_16x16x32_bf16 a[72:75], a[212:215], a[144:147], a[72:75]
    v_accvgpr_read_b32 v28, a44
    v_accvgpr_read_b32 v29, a45
    v_mfma_f32_16x16x32_bf16 a[76:79], a[212:215], a[152:155], a[76:79]
    s_waitcnt lgkmcnt(6)
    v_mul_f32 v108, v108, v28
    v_mul_f32 v109, v109, v29
    v_mfma_f32_16x16x32_bf16 v[128:131], a[216:219], a[132:135], v[128:131]
    ds_read_b64_tr_b16 a[192:193], v27 offset:9344
    ds_read_b64_tr_b16 a[194:195], v27 offset:11648
    v_mfma_f32_16x16x32_bf16 v[132:135], a[216:219], a[140:143], v[132:135]
    v_accvgpr_read_b32 v28, a46
    v_accvgpr_read_b32 v29, a47
    v_mfma_f32_16x16x32_bf16 v[136:139], a[216:219], a[148:151], v[136:139]
    v_mul_f32 v110, v110, v28
    v_mul_f32 v111, v111, v29
    v_mfma_f32_16x16x32_bf16 v[140:143], a[216:219], a[156:159], v[140:143]
    s_waitcnt lgkmcnt(6)
    v_cvt_pk_bf16_f32 v108, v108, v109
    v_cvt_pk_bf16_f32 v109, v110, v111
    v_mfma_f32_16x16x32_bf16 a[64:67], a[220:223], a[132:135], a[64:67]
    ds_read_b64_tr_b16 a[196:197], v27 offset:27776
    ds_read_b64_tr_b16 a[198:199], v27 offset:30080
    v_mfma_f32_16x16x32_bf16 a[68:71], a[220:223], a[140:143], a[68:71]
    v_accvgpr_read_b32 v28, a48
    v_accvgpr_read_b32 v29, a49
    v_mfma_f32_16x16x32_bf16 a[72:75], a[220:223], a[148:151], a[72:75]
    v_mul_f32 v112, v112, v28
    v_mul_f32 v113, v113, v29
    v_mfma_f32_16x16x32_bf16 a[76:79], a[220:223], a[156:159], a[76:79]
    s_waitcnt lgkmcnt(6)
    v_accvgpr_read_b32 v28, a50
    v_accvgpr_read_b32 v29, a51
    v_mfma_f32_16x16x32_bf16 v[128:131], a[224:227], a[160:163], v[128:131]
    ds_read_b64_tr_b16 a[200:201], v26 offset:160
    ds_read_b64_tr_b16 a[202:203], v26 offset:2464
    v_mfma_f32_16x16x32_bf16 v[132:135], a[224:227], a[168:171], v[132:135]
    v_mul_f32 v114, v114, v28
    v_mul_f32 v115, v115, v29
    v_mfma_f32_16x16x32_bf16 v[136:139], a[224:227], a[176:179], v[136:139]
    v_cvt_pk_bf16_f32 v98, v112, v113
    v_cvt_pk_bf16_f32 v99, v114, v115
    v_mfma_f32_16x16x32_bf16 v[140:143], a[224:227], a[184:187], v[140:143]
    s_waitcnt lgkmcnt(6)
    v_accvgpr_read_b32 v28, a52
    v_accvgpr_read_b32 v29, a53
    v_mfma_f32_16x16x32_bf16 a[64:67], a[228:231], a[160:163], a[64:67]
    ds_read_b64_tr_b16 a[204:205], v26 offset:18592
    ds_read_b64_tr_b16 a[206:207], v26 offset:20896
    v_mfma_f32_16x16x32_bf16 a[68:71], a[228:231], a[168:171], a[68:71]
    s_add_u32 s26, s26, 4096
    buffer_store_dwordx4 v[96:99], v1, s[16:19], s26 offen offset:0 sc1
    v_mul_f32 v116, v116, v28
    v_mfma_f32_16x16x32_bf16 a[72:75], a[228:231], a[176:179], a[72:75]
    v_mul_f32 v117, v117, v29
    v_accvgpr_read_b32 v28, a54
    v_mfma_f32_16x16x32_bf16 a[76:79], a[228:231], a[184:187], a[76:79]
    s_waitcnt lgkmcnt(6)
    v_accvgpr_read_b32 v29, a55
    v_mul_f32 v118, v118, v28
    v_mfma_f32_16x16x32_bf16 v[128:131], a[192:195], a[164:167], v[128:131]
    ds_read_b64_tr_b16 a[208:209], v26 offset:9376
    ds_read_b64_tr_b16 a[210:211], v26 offset:11680
    v_mfma_f32_16x16x32_bf16 v[132:135], a[192:195], a[172:175], v[132:135]
    v_mul_f32 v119, v119, v29
    v_cvt_pk_bf16_f32 v102, v116, v117
    v_mfma_f32_16x16x32_bf16 v[136:139], a[192:195], a[180:183], v[136:139]
    v_cvt_pk_bf16_f32 v103, v118, v119
    v_accvgpr_read_b32 v28, a56
    v_mfma_f32_16x16x32_bf16 v[140:143], a[192:195], a[188:191], v[140:143]
    s_waitcnt lgkmcnt(6)
    v_accvgpr_read_b32 v29, a57
    v_mul_f32 v120, v120, v28
    v_mfma_f32_16x16x32_bf16 a[64:67], a[196:199], a[164:167], a[64:67]
    ds_read_b64_tr_b16 a[212:213], v26 offset:27808
    ds_read_b64_tr_b16 a[214:215], v26 offset:30112
    v_mfma_f32_16x16x32_bf16 a[68:71], a[196:199], a[172:175], a[68:71]
    v_mul_f32 v121, v121, v29
    v_accvgpr_read_b32 v28, a58
    v_mfma_f32_16x16x32_bf16 a[72:75], a[196:199], a[180:183], a[72:75]
    v_accvgpr_read_b32 v29, a59
    v_mul_f32 v122, v122, v28
    v_mfma_f32_16x16x32_bf16 a[76:79], a[196:199], a[188:191], a[76:79]
    s_waitcnt lgkmcnt(6)
    v_mul_f32 v123, v123, v29
    v_cvt_pk_bf16_f32 v106, v120, v121
    v_mfma_f32_16x16x32_bf16 v[144:147], a[200:203], a[128:131], v[144:147]
    ds_read_b64_tr_b16 a[216:217], v27 offset:160
    ds_read_b64_tr_b16 a[218:219], v27 offset:2464
    v_mfma_f32_16x16x32_bf16 v[148:151], a[200:203], a[136:139], v[148:151]
    v_cvt_pk_bf16_f32 v107, v122, v123
    v_accvgpr_read_b32 v28, a60
    v_mfma_f32_16x16x32_bf16 v[152:155], a[200:203], a[144:147], v[152:155]
    v_accvgpr_read_b32 v29, a61
    v_mul_f32 v124, v124, v28
    v_mfma_f32_16x16x32_bf16 v[156:159], a[200:203], a[152:155], v[156:159]
    s_waitcnt lgkmcnt(6)
    v_mul_f32 v125, v125, v29
    v_accvgpr_read_b32 v28, a62
    v_mfma_f32_16x16x32_bf16 a[80:83], a[204:207], a[128:131], a[80:83]
    ds_read_b64_tr_b16 a[220:221], v27 offset:18592
    ds_read_b64_tr_b16 a[222:223], v27 offset:20896
    v_mfma_f32_16x16x32_bf16 a[84:87], a[204:207], a[136:139], a[84:87]
    buffer_store_dwordx4 v[100:103], v1, s[16:19], s26 offen offset:1024 sc1
    v_accvgpr_read_b32 v29, a63
    v_mfma_f32_16x16x32_bf16 a[88:91], a[204:207], a[144:147], a[88:91]
    v_mul_f32 v126, v126, v28
    v_mul_f32 v127, v127, v29
    v_mfma_f32_16x16x32_bf16 a[92:95], a[204:207], a[152:155], a[92:95]
    s_waitcnt lgkmcnt(6)
    v_cvt_pk_bf16_f32 v110, v124, v125
    v_cvt_pk_bf16_f32 v111, v126, v127
    v_mfma_f32_16x16x32_bf16 v[144:147], a[208:211], a[132:135], v[144:147]
    ds_read_b64_tr_b16 a[224:225], v27 offset:9376
    ds_read_b64_tr_b16 a[226:227], v27 offset:11680
    v_mfma_f32_16x16x32_bf16 v[148:151], a[208:211], a[140:143], v[148:151]
    v_accvgpr_read_b32 v28, a64
    v_accvgpr_read_b32 v29, a65
    v_mfma_f32_16x16x32_bf16 v[152:155], a[208:211], a[148:151], v[152:155]
    v_mul_f32 v128, v128, v28
    v_mul_f32 v129, v129, v29
    v_mfma_f32_16x16x32_bf16 v[156:159], a[208:211], a[156:159], v[156:159]
    s_waitcnt lgkmcnt(6)
    v_accvgpr_read_b32 v28, a66
    v_accvgpr_read_b32 v29, a67
    v_mfma_f32_16x16x32_bf16 a[80:83], a[212:215], a[132:135], a[80:83]
    ds_read_b64_tr_b16 a[228:229], v27 offset:27808
    ds_read_b64_tr_b16 a[230:231], v27 offset:30112
    v_mfma_f32_16x16x32_bf16 a[84:87], a[212:215], a[140:143], a[84:87]
    v_mul_f32 v130, v130, v28
    v_mul_f32 v131, v131, v29
    v_mfma_f32_16x16x32_bf16 a[88:91], a[212:215], a[148:151], a[88:91]
    v_cvt_pk_bf16_f32 v128, v128, v129
    v_cvt_pk_bf16_f32 v129, v130, v131
    v_mfma_f32_16x16x32_bf16 a[92:95], a[212:215], a[156:159], a[92:95]
    s_waitcnt lgkmcnt(6)
    v_accvgpr_read_b32 v28, a68
    v_accvgpr_read_b32 v29, a69
    v_mfma_f32_16x16x32_bf16 v[144:147], a[216:219], a[160:163], v[144:147]
    ds_read_b64_tr_b16 a[192:193], v26 offset:192
    ds_read_b64_tr_b16 a[194:195], v26 offset:2496
    v_mfma_f32_16x16x32_bf16 v[148:151], a[216:219], a[168:171], v[148:151]
    v_mul_f32 v132, v132, v28
    v_mul_f32 v133, v133, v29
    v_mfma_f32_16x16x32_bf16 v[152:155], a[216:219], a[176:179], v[152:155]
    v_accvgpr_read_b32 v28, a70
    v_accvgpr_read_b32 v29, a71
    v_mfma_f32_16x16x32_bf16 v[156:159], a[216:219], a[184:187], v[156:159]
    s_waitcnt lgkmcnt(6)
    v_mul_f32 v134, v134, v28
    v_mul_f32 v135, v135, v29
    v_mfma_f32_16x16x32_bf16 a[80:83], a[220:223], a[160:163], a[80:83]
    ds_read_b64_tr_b16 a[196:197], v26 offset:18624
    ds_read_b64_tr_b16 a[198:199], v26 offset:20928
    v_mfma_f32_16x16x32_bf16 a[84:87], a[220:223], a[168:171], a[84:87]
    v_cvt_pk_bf16_f32 v132, v132, v133
    v_cvt_pk_bf16_f32 v133, v134, v135
    v_mfma_f32_16x16x32_bf16 a[88:91], a[220:223], a[176:179], a[88:91]
    v_accvgpr_read_b32 v28, a72
    v_accvgpr_read_b32 v29, a73
    v_mfma_f32_16x16x32_bf16 a[92:95], a[220:223], a[184:187], a[92:95]
    s_waitcnt lgkmcnt(6)
    v_mul_f32 v136, v136, v28
    v_mul_f32 v137, v137, v29
    v_mfma_f32_16x16x32_bf16 v[144:147], a[224:227], a[164:167], v[144:147]
    ds_read_b64_tr_b16 a[200:201], v26 offset:9408
    ds_read_b64_tr_b16 a[202:203], v26 offset:11712
    v_mfma_f32_16x16x32_bf16 v[148:151], a[224:227], a[172:175], v[148:151]
    buffer_store_dwordx4 v[104:107], v1, s[16:19], s26 offen offset:2048 sc1
    v_accvgpr_read_b32 v28, a74
    v_mfma_f32_16x16x32_bf16 v[152:155], a[224:227], a[180:183], v[152:155]
    v_accvgpr_read_b32 v29, a75
    v_mul_f32 v138, v138, v28
    v_mfma_f32_16x16x32_bf16 v[156:159], a[224:227], a[188:191], v[156:159]
    s_waitcnt lgkmcnt(6)
    v_mul_f32 v139, v139, v29
    v_cvt_pk_bf16_f32 v136, v136, v137
    v_mfma_f32_16x16x32_bf16 a[80:83], a[228:231], a[164:167], a[80:83]
    ds_read_b64_tr_b16 a[204:205], v26 offset:27840
    ds_read_b64_tr_b16 a[206:207], v26 offset:30144
    v_mfma_f32_16x16x32_bf16 a[84:87], a[228:231], a[172:175], a[84:87]
    v_cvt_pk_bf16_f32 v137, v138, v139
    v_accvgpr_read_b32 v28, a76
    v_mfma_f32_16x16x32_bf16 a[88:91], a[228:231], a[180:183], a[88:91]
    v_accvgpr_read_b32 v29, a77
    v_mul_f32 v140, v140, v28
    v_mfma_f32_16x16x32_bf16 a[92:95], a[228:231], a[188:191], a[92:95]
    s_waitcnt lgkmcnt(6)
    v_mul_f32 v141, v141, v29
    v_accvgpr_read_b32 v28, a78
    v_mfma_f32_16x16x32_bf16 v[160:163], a[192:195], a[128:131], v[160:163]
    ds_read_b64_tr_b16 a[208:209], v27 offset:192
    ds_read_b64_tr_b16 a[210:211], v27 offset:2496
    v_mfma_f32_16x16x32_bf16 v[164:167], a[192:195], a[136:139], v[164:167]
    v_accvgpr_read_b32 v29, a79
    v_mul_f32 v142, v142, v28
    v_mfma_f32_16x16x32_bf16 v[168:171], a[192:195], a[144:147], v[168:171]
    v_mul_f32 v143, v143, v29
    v_cvt_pk_bf16_f32 v140, v140, v141
    v_mfma_f32_16x16x32_bf16 v[172:175], a[192:195], a[152:155], v[172:175]
    s_waitcnt lgkmcnt(6)
    v_cvt_pk_bf16_f32 v141, v142, v143
    v_mfma_f32_16x16x32_bf16 v[176:179], a[196:199], a[128:131], v[176:179]
    ds_read_b64_tr_b16 a[212:213], v27 offset:18624
    ds_read_b64_tr_b16 a[214:215], v27 offset:20928
    v_mfma_f32_16x16x32_bf16 v[180:183], a[196:199], a[136:139], v[180:183]
    v_accvgpr_read_b32 v28, a80
    v_accvgpr_read_b32 v29, a81
    v_mfma_f32_16x16x32_bf16 v[184:187], a[196:199], a[144:147], v[184:187]
    v_mul_f32 v144, v144, v28
    v_mul_f32 v145, v145, v29
    v_mfma_f32_16x16x32_bf16 v[188:191], a[196:199], a[152:155], v[188:191]
    s_waitcnt lgkmcnt(6)
    v_accvgpr_read_b32 v28, a82
    v_accvgpr_read_b32 v29, a83
    v_mfma_f32_16x16x32_bf16 v[160:163], a[200:203], a[132:135], v[160:163]
    ds_read_b64_tr_b16 a[216:217], v27 offset:9408
    ds_read_b64_tr_b16 a[218:219], v27 offset:11712
    v_mfma_f32_16x16x32_bf16 v[164:167], a[200:203], a[140:143], v[164:167]
    buffer_store_dwordx4 v[108:111], v1, s[16:19], s26 offen offset:3072 sc1
    v_mul_f32 v146, v146, v28
    v_mfma_f32_16x16x32_bf16 v[168:171], a[200:203], a[148:151], v[168:171]
    v_mul_f32 v147, v147, v29
    v_cvt_pk_bf16_f32 v130, v144, v145
    v_mfma_f32_16x16x32_bf16 v[172:175], a[200:203], a[156:159], v[172:175]
    s_waitcnt lgkmcnt(6)
    v_cvt_pk_bf16_f32 v131, v146, v147
    v_accvgpr_read_b32 v28, a84
    v_mfma_f32_16x16x32_bf16 v[176:179], a[204:207], a[132:135], v[176:179]
    ds_read_b64_tr_b16 a[220:221], v27 offset:27840
    ds_read_b64_tr_b16 a[222:223], v27 offset:30144
    v_mfma_f32_16x16x32_bf16 v[180:183], a[204:207], a[140:143], v[180:183]
    v_accvgpr_read_b32 v29, a85
    v_mul_f32 v148, v148, v28
    v_mfma_f32_16x16x32_bf16 v[184:187], a[204:207], a[148:151], v[184:187]
    v_mul_f32 v149, v149, v29
    v_accvgpr_read_b32 v28, a86
    v_mfma_f32_16x16x32_bf16 v[188:191], a[204:207], a[156:159], v[188:191]
    s_waitcnt lgkmcnt(6)
    v_accvgpr_read_b32 v29, a87
    v_mul_f32 v150, v150, v28
    v_mfma_f32_16x16x32_bf16 v[160:163], a[208:211], a[160:163], v[160:163]
    ds_read_b64_tr_b16 a[224:225], v26 offset:224
    ds_read_b64_tr_b16 a[226:227], v26 offset:2528
    v_mfma_f32_16x16x32_bf16 v[164:167], a[208:211], a[168:171], v[164:167]
    v_mul_f32 v151, v151, v29
    v_cvt_pk_bf16_f32 v134, v148, v149
    v_mfma_f32_16x16x32_bf16 v[168:171], a[208:211], a[176:179], v[168:171]
    v_cvt_pk_bf16_f32 v135, v150, v151
    v_accvgpr_read_b32 v28, a88
    v_mfma_f32_16x16x32_bf16 v[172:175], a[208:211], a[184:187], v[172:175]
    s_waitcnt lgkmcnt(6)
    v_accvgpr_read_b32 v29, a89
    v_mul_f32 v152, v152, v28
    v_mfma_f32_16x16x32_bf16 v[176:179], a[212:215], a[160:163], v[176:179]
    ds_read_b64_tr_b16 a[228:229], v26 offset:18656
    ds_read_b64_tr_b16 a[230:231], v26 offset:20960
    v_mfma_f32_16x16x32_bf16 v[180:183], a[212:215], a[168:171], v[180:183]
    v_mul_f32 v153, v153, v29
    v_accvgpr_read_b32 v28, a90
    v_mfma_f32_16x16x32_bf16 v[184:187], a[212:215], a[176:179], v[184:187]
    v_accvgpr_read_b32 v29, a91
    v_mul_f32 v154, v154, v28
    v_mfma_f32_16x16x32_bf16 v[188:191], a[212:215], a[184:187], v[188:191]
    s_waitcnt lgkmcnt(6)
    v_mul_f32 v155, v155, v29
    v_cvt_pk_bf16_f32 v138, v152, v153
    v_mfma_f32_16x16x32_bf16 v[160:163], a[216:219], a[164:167], v[160:163]
    ds_read_b64_tr_b16 a[192:193], v26 offset:9440
    ds_read_b64_tr_b16 a[194:195], v26 offset:11744
    v_mfma_f32_16x16x32_bf16 v[164:167], a[216:219], a[172:175], v[164:167]
    v_cvt_pk_bf16_f32 v139, v154, v155
    v_accvgpr_read_b32 v28, a92
    v_mfma_f32_16x16x32_bf16 v[168:171], a[216:219], a[180:183], v[168:171]
    v_accvgpr_read_b32 v29, a93
    v_mul_f32 v156, v156, v28
    v_mfma_f32_16x16x32_bf16 v[172:175], a[216:219], a[188:191], v[172:175]
    s_waitcnt lgkmcnt(6)
    v_mul_f32 v157, v157, v29
    v_accvgpr_read_b32 v28, a94
    v_mfma_f32_16x16x32_bf16 v[176:179], a[220:223], a[164:167], v[176:179]
    ds_read_b64_tr_b16 a[196:197], v26 offset:27872
    ds_read_b64_tr_b16 a[198:199], v26 offset:30176
    v_mfma_f32_16x16x32_bf16 v[180:183], a[220:223], a[172:175], v[180:183]
    s_add_u32 s26, s26, 4096
    buffer_store_dwordx4 v[128:131], v1, s[16:19], s26 offen offset:0 sc1
    v_accvgpr_read_b32 v29, a95
    v_mfma_f32_16x16x32_bf16 v[184:187], a[220:223], a[180:183], v[184:187]
    v_mul_f32 v158, v158, v28
    v_mul_f32 v159, v159, v29
    v_mfma_f32_16x16x32_bf16 v[188:191], a[220:223], a[188:191], v[188:191]
    s_waitcnt lgkmcnt(6)
    v_cvt_pk_bf16_f32 v142, v156, v157
    v_cvt_pk_bf16_f32 v143, v158, v159
    v_mfma_f32_16x16x32_bf16 v[192:195], a[224:227], a[128:131], v[192:195]
    ds_read_b64_tr_b16 a[200:201], v27 offset:224
    ds_read_b64_tr_b16 a[202:203], v27 offset:2528
    v_mfma_f32_16x16x32_bf16 v[196:199], a[224:227], a[136:139], v[196:199]
    v_mfma_f32_16x16x32_bf16 v[200:203], a[224:227], a[144:147], v[200:203]
    v_mfma_f32_16x16x32_bf16 v[204:207], a[224:227], a[152:155], v[204:207]
    s_waitcnt lgkmcnt(6)
    v_mfma_f32_16x16x32_bf16 v[208:211], a[228:231], a[128:131], v[208:211]
    ds_read_b64_tr_b16 a[204:205], v27 offset:18656
    ds_read_b64_tr_b16 a[206:207], v27 offset:20960
    v_mfma_f32_16x16x32_bf16 v[212:215], a[228:231], a[136:139], v[212:215]
    v_mul_f32 v160, v160, v176
    v_mul_f32 v161, v161, v177
    v_mfma_f32_16x16x32_bf16 v[216:219], a[228:231], a[144:147], v[216:219]
    v_mul_f32 v162, v162, v178
    v_mul_f32 v163, v163, v179
    v_mfma_f32_16x16x32_bf16 v[220:223], a[228:231], a[152:155], v[220:223]
    s_waitcnt lgkmcnt(6)
    v_cvt_pk_bf16_f32 v160, v160, v161
    v_cvt_pk_bf16_f32 v161, v162, v163
    s_waitcnt vmcnt(9)
    s_barrier
    v_mfma_f32_16x16x32_bf16 v[192:195], a[192:195], a[132:135], v[192:195]
    ds_read_b64_tr_b16 a[208:209], v27 offset:9440
    ds_read_b64_tr_b16 a[210:211], v27 offset:11744
    s_waitcnt vmcnt(1)
    v_mfma_f32_16x16x32_bf16 v[196:199], a[192:195], a[140:143], v[196:199]
    buffer_store_dwordx2 v[62:63], v52, s[32:35], s57 offen sc1
    v_mul_f32 v164, v164, v180
    v_mfma_f32_16x16x32_bf16 v[200:203], a[192:195], a[148:151], v[200:203]
    v_mul_f32 v165, v165, v181
    v_mul_f32 v166, v166, v182
    v_mfma_f32_16x16x32_bf16 v[204:207], a[192:195], a[156:159], v[204:207]
    s_waitcnt lgkmcnt(6)
    v_mul_f32 v167, v167, v183
    v_cvt_pk_bf16_f32 v164, v164, v165
    v_mfma_f32_16x16x32_bf16 v[208:211], a[196:199], a[132:135], v[208:211]
    ds_read_b64_tr_b16 a[212:213], v27 offset:27872
    ds_read_b64_tr_b16 a[214:215], v27 offset:30176
    v_mfma_f32_16x16x32_bf16 v[212:215], a[196:199], a[140:143], v[212:215]
    buffer_store_dwordx4 v[132:135], v1, s[16:19], s26 offen offset:1024 sc1
    v_cvt_pk_bf16_f32 v165, v166, v167
    v_mfma_f32_16x16x32_bf16 v[216:219], a[196:199], a[148:151], v[216:219]
    v_mul_f32 v168, v168, v184
    v_mul_f32 v169, v169, v185
    v_mfma_f32_16x16x32_bf16 v[220:223], a[196:199], a[156:159], v[220:223]
    s_waitcnt lgkmcnt(6)
    v_mul_f32 v170, v170, v186
    v_mul_f32 v171, v171, v187
    v_mfma_f32_16x16x32_bf16 v[192:195], a[200:203], a[160:163], v[192:195]
    ds_read_b64_tr_b16 a[216:217], v26 offset:256
    ds_read_b64_tr_b16 a[218:219], v26 offset:2560
    v_mfma_f32_16x16x32_bf16 v[196:199], a[200:203], a[168:171], v[196:199]
    ds_read_b128 a[96:99], v22 offset:448
    v_cvt_pk_bf16_f32 v168, v168, v169
    v_mfma_f32_16x16x32_bf16 v[200:203], a[200:203], a[176:179], v[200:203]
    ds_read_b128 a[100:103], v22 offset:960
    v_cvt_pk_bf16_f32 v169, v170, v171
    v_mfma_f32_16x16x32_bf16 v[204:207], a[200:203], a[184:187], v[204:207]
    s_waitcnt lgkmcnt(8)
    v_mul_f32 v172, v172, v188
    v_mul_f32 v173, v173, v189
    v_mfma_f32_16x16x32_bf16 v[208:211], a[204:207], a[160:163], v[208:211]
    ds_read_b64_tr_b16 a[220:221], v26 offset:18688
    ds_read_b64_tr_b16 a[222:223], v26 offset:20992
    v_mfma_f32_16x16x32_bf16 v[212:215], a[204:207], a[168:171], v[212:215]
    ds_read_b128 a[104:107], v22 offset:1472
    v_mul_f32 v174, v174, v190
    v_mfma_f32_16x16x32_bf16 v[216:219], a[204:207], a[176:179], v[216:219]
    ds_read_b128 a[108:111], v22 offset:1984
    v_mul_f32 v175, v175, v191
    v_mfma_f32_16x16x32_bf16 v[220:223], a[204:207], a[184:187], v[220:223]
    s_waitcnt lgkmcnt(10)
    v_cvt_pk_bf16_f32 v172, v172, v173
    v_cvt_pk_bf16_f32 v173, v174, v175
    v_mfma_f32_16x16x32_bf16 v[192:195], a[208:211], a[164:167], v[192:195]
    ds_read_b64_tr_b16 a[224:225], v26 offset:9472
    ds_read_b64_tr_b16 a[226:227], v26 offset:11776
    v_mfma_f32_16x16x32_bf16 v[196:199], a[208:211], a[172:175], v[196:199]
    ds_read_b128 a[112:115], v22 offset:2496
    v_mfma_f32_16x16x32_bf16 v[200:203], a[208:211], a[180:183], v[200:203]
    ds_read_b128 a[116:119], v22 offset:3008
    v_mfma_f32_16x16x32_bf16 v[204:207], a[208:211], a[188:191], v[204:207]
    s_waitcnt lgkmcnt(12)
    v_mfma_f32_16x16x32_bf16 v[208:211], a[212:215], a[164:167], v[208:211]
    ds_read_b64_tr_b16 a[228:229], v26 offset:27904
    ds_read_b64_tr_b16 a[230:231], v26 offset:30208
    v_mfma_f32_16x16x32_bf16 v[212:215], a[212:215], a[172:175], v[212:215]
    ds_read_b128 a[120:123], v22 offset:3520
    v_mfma_f32_16x16x32_bf16 v[216:219], a[212:215], a[180:183], v[216:219]
    ds_read_b128 a[124:127], v22 offset:4032
    v_mfma_f32_16x16x32_bf16 v[220:223], a[212:215], a[188:191], v[220:223]
    s_waitcnt lgkmcnt(14)
    v_mfma_f32_16x16x32_bf16 v[224:227], a[216:219], a[128:131], v[224:227]
    ds_read_b64_tr_b16 a[192:193], v27 offset:256
    ds_read_b64_tr_b16 a[194:195], v27 offset:2560
    buffer_store_dwordx4 v[136:139], v1, s[16:19], s26 offen offset:2048 sc1
    v_mfma_f32_16x16x32_bf16 v[228:231], a[216:219], a[136:139], v[228:231]
    ds_read_b64_tr_b16 v[104:105], v21 offset:8
    v_mfma_f32_16x16x32_bf16 v[232:235], a[216:219], a[144:147], v[232:235]
    ds_read_b64_tr_b16 v[106:107], v21 offset:0
    v_mfma_f32_16x16x32_bf16 v[236:239], a[216:219], a[152:155], v[236:239]
    s_waitcnt lgkmcnt(14)
    v_mfma_f32_16x16x32_bf16 v[240:243], a[220:223], a[128:131], v[240:243]
    ds_read_b64_tr_b16 a[196:197], v27 offset:18688
    ds_read_b64_tr_b16 a[198:199], v27 offset:20992
    v_mfma_f32_16x16x32_bf16 v[244:247], a[220:223], a[136:139], v[244:247]
    ds_read_b64_tr_b16 v[108:109], v21 offset:520
    v_mul_f32 v192, v192, v208
    v_mul_f32 v193, v193, v209
    v_mfma_f32_16x16x32_bf16 v[248:251], a[220:223], a[144:147], v[248:251]
    ds_read_b64_tr_b16 v[110:111], v21 offset:512
    v_mul_f32 v194, v194, v210
    v_mul_f32 v195, v195, v211
    v_mfma_f32_16x16x32_bf16 v[252:255], a[220:223], a[152:155], v[252:255]
    s_waitcnt lgkmcnt(14)
    v_cvt_pk_bf16_f32 v162, v192, v193
    v_cvt_pk_bf16_f32 v163, v194, v195
    v_mul_f32 v196, v196, v212
    v_mfma_f32_16x16x32_bf16 v[224:227], a[224:227], a[132:135], v[224:227]
    ds_read_b64_tr_b16 a[200:201], v27 offset:9472
    ds_read_b64_tr_b16 a[202:203], v27 offset:11776
    v_mul_f32 v197, v197, v213
    v_mfma_f32_16x16x32_bf16 v[228:231], a[224:227], a[140:143], v[228:231]
    ds_read_b64_tr_b16 v[112:113], v21 offset:1032
    v_mul_f32 v198, v198, v214
    v_mul_f32 v199, v199, v215
    v_mfma_f32_16x16x32_bf16 v[232:235], a[224:227], a[148:151], v[232:235]
    ds_read_b64_tr_b16 v[114:115], v21 offset:1024
    v_cvt_pk_bf16_f32 v166, v196, v197
    v_cvt_pk_bf16_f32 v167, v198, v199
    v_mfma_f32_16x16x32_bf16 v[236:239], a[224:227], a[156:159], v[236:239]
    s_waitcnt lgkmcnt(14)
    v_mul_f32 v200, v200, v216
    v_mul_f32 v201, v201, v217
    v_mul_f32 v202, v202, v218
    v_mfma_f32_16x16x32_bf16 v[240:243], a[228:231], a[132:135], v[240:243]
    ds_read_b64_tr_b16 a[204:205], v27 offset:27904
    ds_read_b64_tr_b16 a[206:207], v27 offset:30208
    v_mul_f32 v203, v203, v219
    v_mfma_f32_16x16x32_bf16 v[244:247], a[228:231], a[140:143], v[244:247]
    ds_read_b64_tr_b16 v[116:117], v21 offset:1544
    v_cvt_pk_bf16_f32 v170, v200, v201
    v_cvt_pk_bf16_f32 v171, v202, v203
    v_mfma_f32_16x16x32_bf16 v[248:251], a[228:231], a[148:151], v[248:251]
    ds_read_b64_tr_b16 v[118:119], v21 offset:1536
    v_mul_f32 v204, v204, v220
    v_mul_f32 v205, v205, v221
    v_mfma_f32_16x16x32_bf16 v[252:255], a[228:231], a[156:159], v[252:255]
    s_waitcnt lgkmcnt(14)
    v_mul_f32 v206, v206, v222
    v_mul_f32 v207, v207, v223
    v_cvt_pk_bf16_f32 v174, v204, v205
    v_mfma_f32_16x16x32_bf16 v[224:227], a[192:195], a[160:163], v[224:227]
    ds_read_b64_tr_b16 v[120:121], v21 offset:2056
    ds_read_b64_tr_b16 v[122:123], v21 offset:2048
    buffer_store_dwordx4 v[140:143], v1, s[16:19], s26 offen offset:3072 sc1
    v_mfma_f32_16x16x32_bf16 v[228:231], a[192:195], a[168:171], v[228:231]
    v_cvt_pk_bf16_f32 v175, v206, v207
    v_mfma_f32_16x16x32_bf16 v[232:235], a[192:195], a[176:179], v[232:235]
    v_mfma_f32_16x16x32_bf16 v[236:239], a[192:195], a[184:187], v[236:239]
    s_waitcnt lgkmcnt(12)
    v_mfma_f32_16x16x32_bf16 v[240:243], a[196:199], a[160:163], v[240:243]
    v_mfma_f32_16x16x32_bf16 v[244:247], a[196:199], a[168:171], v[244:247]
    v_mfma_f32_16x16x32_bf16 v[248:251], a[196:199], a[176:179], v[248:251]
    v_mfma_f32_16x16x32_bf16 v[252:255], a[196:199], a[184:187], v[252:255]
    s_waitcnt lgkmcnt(8)
    v_mfma_f32_16x16x32_bf16 v[224:227], a[200:203], a[164:167], v[224:227]
    v_mfma_f32_16x16x32_bf16 v[228:231], a[200:203], a[172:175], v[228:231]
    v_mfma_f32_16x16x32_bf16 v[232:235], a[200:203], a[180:183], v[232:235]
    v_mfma_f32_16x16x32_bf16 v[236:239], a[200:203], a[188:191], v[236:239]
    s_waitcnt lgkmcnt(4)
    v_mfma_f32_16x16x32_bf16 v[240:243], a[204:207], a[164:167], v[240:243]
    v_mfma_f32_16x16x32_bf16 v[244:247], a[204:207], a[172:175], v[244:247]
    v_mfma_f32_16x16x32_bf16 v[248:251], a[204:207], a[180:183], v[248:251]
    v_mfma_f32_16x16x32_bf16 v[252:255], a[204:207], a[188:191], v[252:255]
    s_cmp_eq_u32 s62, 1
    s_cbranch_scc1 ver_13
ver_12:
pad_6:
    s_cbranch_execz pad_10
    v_mfma_f32_16x16x32_bf16 v[208:211], a[240:243], a[96:99], 0
    v_mfma_f32_16x16x32_bf16 v[212:215], a[240:243], a[100:103], 0
    v_mfma_f32_16x16x32_bf16 v[216:219], a[240:243], a[104:107], 0
    v_mul_f32 v224, v224, v240
    v_mul_f32 v225, v225, v241
    v_mul_f32 v226, v226, v242
    v_mfma_f32_16x16x32_bf16 v[220:223], a[240:243], a[108:111], 0
    v_mul_f32 v227, v227, v243
    v_cvt_pk_bf16_f32 v224, v224, v225
    v_cvt_pk_bf16_f32 v225, v226, v227
    v_mfma_f32_16x16x32_bf16 v[192:195], a[240:243], a[112:115], 0
    s_add_u32 s26, s26, 4096
    buffer_store_dwordx4 v[160:163], v1, s[16:19], s26 offen offset:0 sc1
    v_mul_f32 v228, v228, v244
    v_mul_f32 v229, v229, v245
    v_mfma_f32_16x16x32_bf16 v[196:199], a[240:243], a[116:119], 0
    v_mul_f32 v230, v230, v246
    v_mul_f32 v231, v231, v247
    v_cvt_pk_bf16_f32 v228, v228, v229
    v_mfma_f32_16x16x32_bf16 v[200:203], a[240:243], a[120:123], 0
    v_cvt_pk_bf16_f32 v229, v230, v231
    v_mul_f32 v232, v232, v248
    v_mul_f32 v233, v233, v249
    v_mfma_f32_16x16x32_bf16 v[204:207], a[240:243], a[124:127], 0
    ds_read_b64_tr_b16 v[124:125], v21 offset:2568
    ds_read_b64_tr_b16 v[126:127], v21 offset:2560
    v_mul_f32 v234, v234, v250
    s_barrier
    v_mfma_f32_16x16x32_bf16 v[208:211], v[104:107], a[96:99], v[208:211]
    ds_read_b128 a[160:163], v22 offset:384
    v_mul_f32 v235, v235, v251
    v_cvt_pk_bf16_f32 v232, v232, v233
    v_mfma_f32_16x16x32_bf16 v[212:215], v[104:107], a[100:103], v[212:215]
    ds_read_b128 a[164:167], v22 offset:896
    s_add_u32 s60, s59, 184320
    s_add_u32 m0, s23, 36864
    s_nop 0
    buffer_load_dwordx4 v32, s[40:43], s60 offen offset:0 lds
    v_cvt_pk_bf16_f32 v233, v234, v235
    v_mfma_f32_16x16x32_bf16 v[216:219], v[104:107], a[104:107], v[216:219]
    v_mul_f32 v236, v236, v252
    v_mul_f32 v237, v237, v253
    v_mul_f32 v238, v238, v254
    v_mfma_f32_16x16x32_bf16 v[220:223], v[104:107], a[108:111], v[220:223]
    v_mul_f32 v239, v239, v255
    v_cvt_pk_bf16_f32 v236, v236, v237
    v_cvt_pk_bf16_f32 v237, v238, v239
    v_mfma_f32_16x16x32_bf16 v[192:195], v[104:107], a[112:115], v[192:195]
    buffer_load_dwordx4 v33, s[40:43], s60 offen offset:1024 lds
    v_mfma_f32_16x16x32_bf16 v[196:199], v[104:107], a[116:119], v[196:199]
    v_mfma_f32_16x16x32_bf16 v[200:203], v[104:107], a[120:123], v[200:203]
    v_mfma_f32_16x16x32_bf16 v[204:207], v[104:107], a[124:127], v[204:207]
    ds_read_b64_tr_b16 v[104:105], v21 offset:3080
    ds_read_b64_tr_b16 v[106:107], v21 offset:3072
    v_mfma_f32_16x16x32_bf16 v[212:215], v[108:111], a[96:99], v[212:215]
    ds_read_b128 a[168:171], v22 offset:1408
    buffer_load_dwordx4 v34, s[40:43], s60 offen offset:2048 lds
    v_mfma_f32_16x16x32_bf16 v[216:219], v[108:111], a[100:103], v[216:219]
    ds_read_b128 a[172:175], v22 offset:1920
    v_mfma_f32_16x16x32_bf16 v[220:223], v[108:111], a[104:107], v[220:223]
    ds_write_b128 v13, a[232:235]
    ds_read_u16 v240, v42 offset:1032
    ds_read_u16 v241, v42 offset:1034
    v_mfma_f32_16x16x32_bf16 v[192:195], v[108:111], a[108:111], v[192:195]
    buffer_load_dwordx4 v35, s[40:43], s60 offen offset:3072 lds
    ds_read_u16 v242, v53
    v_mfma_f32_16x16x32_bf16 v[196:199], v[108:111], a[112:115], v[196:199]
    s_add_u32 m0, s23, 40960
    v_mfma_f32_16x16x32_bf16 v[200:203], v[108:111], a[116:119], v[200:203]
    v_mfma_f32_16x16x32_bf16 v[204:207], v[108:111], a[120:123], v[204:207]
    ds_read_b64_tr_b16 v[108:109], v21 offset:3592
    ds_read_b64_tr_b16 v[110:111], v21 offset:3584
    v_mfma_f32_16x16x32_bf16 v[216:219], v[112:115], a[96:99], v[216:219]
    ds_read_b128 a[176:179], v22 offset:2432
    buffer_load_dwordx4 v36, s[40:43], s60 offen offset:0 lds
    v_mfma_f32_16x16x32_bf16 v[220:223], v[112:115], a[100:103], v[220:223]
    ds_read_b128 a[180:183], v22 offset:2944
    buffer_store_dwordx4 v[164:167], v1, s[16:19], s26 offen offset:1024 sc1
    v_mfma_f32_16x16x32_bf16 v[192:195], v[112:115], a[104:107], v[192:195]
    v_mfma_f32_16x16x32_bf16 v[196:199], v[112:115], a[108:111], v[196:199]
    v_mfma_f32_16x16x32_bf16 v[200:203], v[112:115], a[112:115], v[200:203]
    buffer_load_dwordx4 v37, s[40:43], s60 offen offset:1024 lds
    s_waitcnt lgkmcnt(4)
    v_perm_b32 v244, v241, v240, s80
    v_mfma_f32_16x16x32_bf16 v[204:207], v[112:115], a[116:119], v[204:207]
    ds_read_b64_tr_b16 v[112:113], v21 offset:72
    ds_read_b64_tr_b16 v[114:115], v21 offset:64
    v_mfma_f32_16x16x32_bf16 v[220:223], v[116:119], a[96:99], v[220:223]
pad_7:
    s_cbranch_execz pad_11
    ds_read_b128 a[184:187], v22 offset:3456
    v_perm_b32 v245, v241, v240, s80
    v_mfma_f32_16x16x32_bf16 v[192:195], v[116:119], a[100:103], v[192:195]
    ds_read_b128 a[188:191], v22 offset:3968
    buffer_load_dwordx4 v38, s[40:43], s60 offen offset:2048 lds
    v_mfma_f32_16x16x32_bf16 v[196:199], v[116:119], a[104:107], v[196:199]
    v_perm_b32 v246, v241, v240, v30
    v_mfma_f32_16x16x32_bf16 v[200:203], v[116:119], a[108:111], v[200:203]
    v_perm_b32 v247, v241, v240, s81
    v_mfma_f32_16x16x32_bf16 v[204:207], v[116:119], a[112:115], v[204:207]
    ds_read_b64_tr_b16 v[116:117], v21 offset:584
    ds_read_b64_tr_b16 v[118:119], v21 offset:576
    v_mfma_f32_16x16x32_bf16 v[192:195], v[120:123], a[96:99], v[192:195]
    buffer_load_dwordx4 v39, s[40:43], s60 offen offset:3072 lds
    ds_write_b128 v48, v[244:247] offset:2080
    v_mfma_f32_16x16x32_bf16 v[196:199], v[120:123], a[100:103], v[196:199]
    s_add_u32 m0, s23, 45056
    v_perm_b32 v246, v241, v240, v31
    v_mfma_f32_16x16x32_bf16 v[200:203], v[120:123], a[104:107], v[200:203]
    v_lshl_or_b32 v242, v240, 16, v242
    v_mfma_f32_16x16x32_bf16 v[204:207], v[120:123], a[108:111], v[204:207]
    ds_read_b64_tr_b16 v[120:121], v21 offset:1096
    ds_read_b64_tr_b16 v[122:123], v21 offset:1088
    v_mfma_f32_16x16x32_bf16 v[196:199], v[124:127], a[96:99], v[196:199]
    s_add_u32 s60, s3, 5120
    buffer_load_dwordx4 v1, s[16:19], s60 offen lds
    ds_write_b128 v48, v[244:247] offset:6240
    v_mfma_f32_16x16x32_bf16 v[200:203], v[124:127], a[100:103], v[200:203]
    v_mov_b32 v246, v244
    v_mfma_f32_16x16x32_bf16 v[204:207], v[124:127], a[104:107], v[204:207]
    ds_read_b64_tr_b16 v[124:125], v21 offset:1608
    ds_read_b64_tr_b16 v[126:127], v21 offset:1600
    v_mfma_f32_16x16x32_bf16 v[200:203], v[104:107], a[96:99], v[200:203]
    s_add_u32 s60, s59, 36864
    buffer_load_dwordx4 v[144:147], v32, s[40:43], s60 offen offset:0
    v_perm_b32 v247, v241, v240, v30
    v_mfma_f32_16x16x32_bf16 v[204:207], v[104:107], a[100:103], v[204:207]
    s_waitcnt lgkmcnt(14)
    ds_read_b64_tr_b16 v[104:105], v21 offset:2120
    ds_read_b64_tr_b16 v[106:107], v21 offset:2112
    v_mfma_f32_16x16x32_bf16 v[204:207], v[108:111], a[96:99], v[204:207]
    s_waitcnt lgkmcnt(12)
    ds_read_b64_tr_b16 v[108:109], v21 offset:2632
    ds_read_b64_tr_b16 v[110:111], v21 offset:2624
    v_mfma_f32_16x16x32_bf16 v[208:211], v[112:115], a[160:163], v[208:211]
    ds_read_b128 a[96:99], v22 offset:320
    buffer_load_dwordx2 v[54:55], v61, s[32:35], s86 offen sc1
    v_mfma_f32_16x16x32_bf16 v[212:215], v[112:115], a[164:167], v[212:215]
    ds_read_b128 a[100:103], v22 offset:832
    buffer_store_dwordx4 v[168:171], v1, s[16:19], s26 offen offset:2048 sc1
    v_mfma_f32_16x16x32_bf16 v[216:219], v[112:115], a[168:171], v[216:219]
    buffer_load_dwordx4 v[148:151], v33, s[40:43], s60 offen offset:1024
    ds_write_b128 v48, v[244:247] offset:10400
    v_mfma_f32_16x16x32_bf16 v[220:223], v[112:115], a[172:175], v[220:223]
    v_perm_b32 v247, v241, v240, v31
    v_mfma_f32_16x16x32_bf16 v[192:195], v[112:115], a[176:179], v[192:195]
    buffer_load_dwordx4 v[152:155], v34, s[40:43], s60 offen offset:2048
    v_cndmask_b32 v244, v244, v242, s[78:79]
    v_mfma_f32_16x16x32_bf16 v[196:199], v[112:115], a[180:183], v[196:199]
    s_waitcnt lgkmcnt(15)
    ds_write_b128 v48, v[244:247] offset:14560
    v_lshrrev_b32 v3, 2, v0
    v_mfma_f32_16x16x32_bf16 v[200:203], v[112:115], a[184:187], v[200:203]
    v_and_b32 v4, 7, v3
    v_mfma_f32_16x16x32_bf16 v[204:207], v[112:115], a[188:191], v[204:207]
    s_waitcnt lgkmcnt(14)
    ds_read_b64_tr_b16 v[112:113], v21 offset:3144
    ds_read_b64_tr_b16 v[114:115], v21 offset:3136
    v_mfma_f32_16x16x32_bf16 v[212:215], v[116:119], a[160:163], v[212:215]
    ds_read_b128 a[104:107], v22 offset:1344
    buffer_load_dwordx4 v[156:159], v35, s[40:43], s60 offen offset:3072
    v_mfma_f32_16x16x32_bf16 v[216:219], v[116:119], a[164:167], v[216:219]
    ds_read_b128 a[108:111], v22 offset:1856
    v_lshlrev_b32 v3, 8, v3
    v_mfma_f32_16x16x32_bf16 v[220:223], v[116:119], a[168:171], v[220:223]
    v_lshl_add_u32 v3, v4, 5, v3
    v_mfma_f32_16x16x32_bf16 v[192:195], v[116:119], a[172:175], v[192:195]
    buffer_load_dwordx4 v[176:179], v36, s[40:43], s60 offen offset:0
    v_and_b32 v4, 3, v0
    v_mfma_f32_16x16x32_bf16 v[196:199], v[116:119], a[176:179], v[196:199]
    v_lshl_add_u32 v3, v4, 3, v3
    s_mul_i32 s48, s62, 18432
    v_mfma_f32_16x16x32_bf16 v[200:203], v[116:119], a[180:183], v[200:203]
    v_add_u32 v8, s48, v3
    v_mfma_f32_16x16x32_bf16 v[204:207], v[116:119], a[184:187], v[204:207]
    s_waitcnt lgkmcnt(15)
    ds_read_b64_tr_b16 v[116:117], v21 offset:3656
    ds_read_b64_tr_b16 v[118:119], v21 offset:3648
    v_mfma_f32_16x16x32_bf16 v[216:219], v[120:123], a[160:163], v[216:219]
    ds_read_b128 a[112:115], v22 offset:2368
    buffer_load_dwordx4 v[180:183], v37, s[40:43], s60 offen offset:1024
    v_mfma_f32_16x16x32_bf16 v[220:223], v[120:123], a[164:167], v[220:223]
    ds_read_b128 a[116:119], v22 offset:2880
    v_xor_b32 v9, 32, v8
    v_mfma_f32_16x16x32_bf16 v[192:195], v[120:123], a[168:171], v[192:195]
    v_xor_b32 v10, 64, v8
    v_mfma_f32_16x16x32_bf16 v[196:199], v[120:123], a[172:175], v[196:199]
    v_xor_b32 v11, 96, v8
    v_mfma_f32_16x16x32_bf16 v[200:203], v[120:123], a[176:179], v[200:203]
    buffer_load_dwordx4 v[184:187], v38, s[40:43], s60 offen offset:2048
    v_xor_b32 v25, 128, v8
    v_mfma_f32_16x16x32_bf16 v[204:207], v[120:123], a[180:183], v[204:207]
    s_waitcnt lgkmcnt(15)
    ds_read_b64_tr_b16 v[120:121], v21 offset:136
    ds_read_b64_tr_b16 v[122:123], v21 offset:128
    v_mfma_f32_16x16x32_bf16 v[220:223], v[124:127], a[160:163], v[220:223]
    ds_read_b128 a[120:123], v22 offset:3392
    buffer_store_dwordx4 v[172:175], v1, s[16:19], s26 offen offset:3072 sc1
    v_mfma_f32_16x16x32_bf16 v[192:195], v[124:127], a[164:167], v[192:195]
    ds_read_b128 a[124:127], v22 offset:3904
    buffer_load_dwordx4 v[188:191], v39, s[40:43], s60 offen offset:3072
    v_mfma_f32_16x16x32_bf16 v[196:199], v[124:127], a[168:171], v[196:199]
    v_xor_b32 v26, 160, v8
    v_mfma_f32_16x16x32_bf16 v[200:203], v[124:127], a[172:175], v[200:203]
    v_xor_b32 v27, 192, v8
    v_mfma_f32_16x16x32_bf16 v[204:207], v[124:127], a[176:179], v[204:207]
    s_waitcnt lgkmcnt(15)
    ds_read_b64_tr_b16 v[124:125], v21 offset:648
    ds_read_b64_tr_b16 v[126:127], v21 offset:640
    v_mfma_f32_16x16x32_bf16 v[192:195], v[104:107], a[160:163], v[192:195]
    s_add_u32 s60, s3, 1024
    buffer_load_dwordx4 a[236:239], v1, s[16:19], s60 offen
    v_xor_b32 v41, 224, v8
    v_mfma_f32_16x16x32_bf16 v[196:199], v[104:107], a[164:167], v[196:199]
    s_add_u32 s48, s48, 8192
    v_add_u32 v42, s48, v59
    v_mfma_f32_16x16x32_bf16 v[200:203], v[104:107], a[168:171], v[200:203]
    v_add_u32 v43, 73728, v8
    v_mfma_f32_16x16x32_bf16 v[204:207], v[104:107], a[172:175], v[204:207]
    ds_read_b64_tr_b16 v[104:105], v21 offset:1160
    ds_read_b64_tr_b16 v[106:107], v21 offset:1152
    v_mfma_f32_16x16x32_bf16 v[196:199], v[108:111], a[160:163], v[196:199]
    buffer_store_dwordx2 v[224:225], v59, s[16:19], s27 offen offset:0 sc1
    v_add_u32 v44, 73728, v9
    v_mfma_f32_16x16x32_bf16 v[200:203], v[108:111], a[164:167], v[200:203]
    v_add_u32 v45, 73728, v10
    v_mfma_f32_16x16x32_bf16 v[204:207], v[108:111], a[168:171], v[204:207]
    s_waitcnt lgkmcnt(14)
    ds_read_b64_tr_b16 v[108:109], v21 offset:1672
    ds_read_b64_tr_b16 v[110:111], v21 offset:1664
    v_mfma_f32_16x16x32_bf16 v[200:203], v[112:115], a[160:163], v[200:203]
    s_waitcnt vmcnt(11)
    v_cmp_ne_u64 vcc, v[62:63], v[54:55]
    s_nop 0
    s_cbranch_vccnz fas_15
far_16:
    v_mfma_f32_16x16x32_bf16 v[204:207], v[112:115], a[164:167], v[204:207]
    s_waitcnt lgkmcnt(12)
    ds_read_b64_tr_b16 v[112:113], v21 offset:2184
    ds_read_b64_tr_b16 v[114:115], v21 offset:2176
    v_mfma_f32_16x16x32_bf16 v[204:207], v[116:119], a[160:163], v[204:207]
    s_waitcnt lgkmcnt(10)
    ds_read_b64_tr_b16 v[116:117], v21 offset:2696
    ds_read_b64_tr_b16 v[118:119], v21 offset:2688
    v_mfma_f32_16x16x32_bf16 v[208:211], v[120:123], a[96:99], v[208:211]
    ds_read_b128 a[160:163], v22 offset:256
    s_add_u32 s87, s85, 0
    buffer_load_dwordx4 a[0:3], v1, s[16:19], s87 offen offset:0 sc1
    v_mfma_f32_16x16x32_bf16 v[212:215], v[120:123], a[100:103], v[212:215]
    ds_read_b128 a[164:167], v22 offset:768
    buffer_load_dwordx4 a[4:7], v1, s[16:19], s87 offen offset:1024 sc1
    v_mfma_f32_16x16x32_bf16 v[216:219], v[120:123], a[104:107], v[216:219]
    v_add_u32 v46, 73728, v11
    v_mfma_f32_16x16x32_bf16 v[220:223], v[120:123], a[108:111], v[220:223]
    v_add_u32 v47, 73728, v25
    v_mfma_f32_16x16x32_bf16 v[192:195], v[120:123], a[112:115], v[192:195]
    buffer_store_dwordx2 v[228:229], v59, s[16:19], s27 offen offset:512 sc1
    v_add_u32 v48, 73728, v26
    v_mfma_f32_16x16x32_bf16 v[196:199], v[120:123], a[116:119], v[196:199]
    s_waitcnt lgkmcnt(13)
    s_xor_b32 s61, s87, 2048
    buffer_load_dwordx4 a[8:11], v1, s[16:19], s61 offen offset:0 sc1
    v_add_u32 v49, 73728, v27
    v_mfma_f32_16x16x32_bf16 v[200:203], v[120:123], a[120:123], v[200:203]
    s_waitcnt lgkmcnt(12)
    v_add_u32 v50, 73728, v41
    v_mfma_f32_16x16x32_bf16 v[204:207], v[120:123], a[124:127], v[204:207]
    s_waitcnt lgkmcnt(10)
    ds_read_b64_tr_b16 v[120:121], v21 offset:3208
    ds_read_b64_tr_b16 v[122:123], v21 offset:3200
    v_mfma_f32_16x16x32_bf16 v[212:215], v[124:127], a[96:99], v[212:215]
    ds_read_b128 a[168:171], v22 offset:1280
    v_add_u32 v51, 73728, v42
    v_mfma_f32_16x16x32_bf16 v[216:219], v[124:127], a[100:103], v[216:219]
    ds_read_b128 a[172:175], v22 offset:1792
    v_mfma_f32_16x16x32_bf16 v[220:223], v[124:127], a[104:107], v[220:223]
    buffer_load_dwordx4 a[12:15], v1, s[16:19], s61 offen offset:1024 sc1
    v_mfma_f32_16x16x32_bf16 v[192:195], v[124:127], a[108:111], v[192:195]
    v_mfma_f32_16x16x32_bf16 v[196:199], v[124:127], a[112:115], v[196:199]
    v_mfma_f32_16x16x32_bf16 v[200:203], v[124:127], a[116:119], v[200:203]
    v_mfma_f32_16x16x32_bf16 v[204:207], v[124:127], a[120:123], v[204:207]
    s_waitcnt lgkmcnt(12)
    ds_read_b64_tr_b16 v[124:125], v21 offset:3720
    ds_read_b64_tr_b16 v[126:127], v21 offset:3712
    v_mfma_f32_16x16x32_bf16 v[216:219], v[104:107], a[96:99], v[216:219]
    ds_read_b128 a[176:179], v22 offset:2304
    buffer_store_dwordx2 v[232:233], v59, s[16:19], s27 offen offset:1024 sc1
    v_mfma_f32_16x16x32_bf16 v[220:223], v[104:107], a[100:103], v[220:223]
    ds_read_b128 a[180:183], v22 offset:2816
    buffer_load_dwordx4 a[16:19], v58, s[16:19], s87 offen offset:0 sc1
    v_mfma_f32_16x16x32_bf16 v[192:195], v[104:107], a[104:107], v[192:195]
    v_mfma_f32_16x16x32_bf16 v[196:199], v[104:107], a[108:111], v[196:199]
    v_mfma_f32_16x16x32_bf16 v[200:203], v[104:107], a[112:115], v[200:203]
    buffer_load_dwordx4 a[20:23], v58, s[16:19], s87 offen offset:1024 sc1
    s_barrier
    v_mfma_f32_16x16x32_bf16 v[204:207], v[104:107], a[116:119], v[204:207]
    s_waitcnt lgkmcnt(14)
    ds_read_b64_tr_b16 v[104:105], v21 offset:200
    ds_read_b64_tr_b16 v[106:107], v21 offset:192
    v_mfma_f32_16x16x32_bf16 v[220:223], v[108:111], a[96:99], v[220:223]
    ds_read_b128 a[184:187], v22 offset:3328
    v_mfma_f32_16x16x32_bf16 v[192:195], v[108:111], a[100:103], v[192:195]
    ds_read_b128 a[188:191], v22 offset:3840
    v_mfma_f32_16x16x32_bf16 v[196:199], v[108:111], a[104:107], v[196:199]
    buffer_load_dwordx4 a[24:27], v58, s[16:19], s61 offen offset:0 sc1
    v_mfma_f32_16x16x32_bf16 v[200:203], v[108:111], a[108:111], v[200:203]
    buffer_store_dwordx2 v[236:237], v59, s[16:19], s27 offen offset:1536 sc1
    v_mfma_f32_16x16x32_bf16 v[204:207], v[108:111], a[112:115], v[204:207]
    s_waitcnt lgkmcnt(15)
    ds_read_b64_tr_b16 v[108:109], v21 offset:712
    ds_read_b64_tr_b16 v[110:111], v21 offset:704
    v_mfma_f32_16x16x32_bf16 v[192:195], v[112:115], a[96:99], v[192:195]
    v_mfma_f32_16x16x32_bf16 v[196:199], v[112:115], a[100:103], v[196:199]
    buffer_load_dwordx4 a[28:31], v58, s[16:19], s61 offen offset:1024 sc1
    v_mfma_f32_16x16x32_bf16 v[200:203], v[112:115], a[104:107], v[200:203]
    v_mfma_f32_16x16x32_bf16 v[204:207], v[112:115], a[108:111], v[204:207]
    s_waitcnt lgkmcnt(15)
    ds_read_b64_tr_b16 v[112:113], v21 offset:1224
    ds_read_b64_tr_b16 v[114:115], v21 offset:1216
    v_mfma_f32_16x16x32_bf16 v[196:199], v[116:119], a[96:99], v[196:199]
    v_mfma_f32_16x16x32_bf16 v[200:203], v[116:119], a[100:103], v[200:203]
    v_mfma_f32_16x16x32_bf16 v[204:207], v[116:119], a[104:107], v[204:207]
    s_waitcnt lgkmcnt(14)
    ds_read_b64_tr_b16 v[116:117], v21 offset:1736
    ds_read_b64_tr_b16 v[118:119], v21 offset:1728
    v_mfma_f32_16x16x32_bf16 v[200:203], v[120:123], a[96:99], v[200:203]
    s_add_u32 s87, s85, 20480
    buffer_load_dwordx4 a[32:35], v1, s[16:19], s87 offen offset:0 sc1
    v_mfma_f32_16x16x32_bf16 v[204:207], v[120:123], a[100:103], v[204:207]
    s_waitcnt lgkmcnt(12)
    ds_read_b64_tr_b16 v[120:121], v21 offset:2248
    ds_read_b64_tr_b16 v[122:123], v21 offset:2240
    v_mfma_f32_16x16x32_bf16 v[204:207], v[124:127], a[96:99], v[204:207]
    s_waitcnt lgkmcnt(10)
    ds_read_b64_tr_b16 v[124:125], v21 offset:2760
    ds_read_b64_tr_b16 v[126:127], v21 offset:2752
    v_mfma_f32_16x16x32_bf16 v[208:211], v[104:107], a[160:163], v[208:211]
    ds_read_b128 v[64:67], v24 offset:448
    buffer_load_dwordx4 a[36:39], v1, s[16:19], s87 offen offset:1024 sc1
    v_mfma_f32_16x16x32_bf16 v[212:215], v[104:107], a[164:167], v[212:215]
    ds_read_b128 v[68:71], v24 offset:960
    v_mfma_f32_16x16x32_bf16 v[216:219], v[104:107], a[168:171], v[216:219]
    ds_read_b128 a[96:99], v24 offset:384
    v_mfma_f32_16x16x32_bf16 v[220:223], v[104:107], a[172:175], v[220:223]
    ds_read_b128 a[100:103], v24 offset:896
    v_mfma_f32_16x16x32_bf16 v[192:195], v[104:107], a[176:179], v[192:195]
    v_mfma_f32_16x16x32_bf16 v[196:199], v[104:107], a[180:183], v[196:199]
    s_waitcnt lgkmcnt(15)
    s_xor_b32 s61, s87, 2048
    buffer_load_dwordx4 a[40:43], v1, s[16:19], s61 offen offset:0 sc1
    v_mfma_f32_16x16x32_bf16 v[200:203], v[104:107], a[184:187], v[200:203]
    s_waitcnt lgkmcnt(14)
    v_mfma_f32_16x16x32_bf16 v[204:207], v[104:107], a[188:191], v[204:207]
    s_waitcnt lgkmcnt(12)
    ds_read_b64_tr_b16 v[104:105], v21 offset:3272
    ds_read_b64_tr_b16 v[106:107], v21 offset:3264
    v_mfma_f32_16x16x32_bf16 v[212:215], v[108:111], a[160:163], v[212:215]
    ds_read_b128 v[72:75], v24 offset:1472
    v_mfma_f32_16x16x32_bf16 v[216:219], v[108:111], a[164:167], v[216:219]
    ds_read_b128 v[76:79], v24 offset:1984
    buffer_load_dwordx4 a[44:47], v1, s[16:19], s61 offen offset:1024 sc1
    v_mfma_f32_16x16x32_bf16 v[220:223], v[108:111], a[168:171], v[220:223]
    ds_read_b128 a[104:107], v24 offset:1408
    v_mfma_f32_16x16x32_bf16 v[192:195], v[108:111], a[172:175], v[192:195]
    ds_read_b128 a[108:111], v24 offset:1920
    v_mfma_f32_16x16x32_bf16 v[196:199], v[108:111], a[176:179], v[196:199]
    v_mfma_f32_16x16x32_bf16 v[200:203], v[108:111], a[180:183], v[200:203]
    buffer_load_dwordx4 a[48:51], v58, s[16:19], s87 offen offset:0 sc1
    v_mfma_f32_16x16x32_bf16 v[204:207], v[108:111], a[184:187], v[204:207]
    s_waitcnt lgkmcnt(15)
    ds_read_b64_tr_b16 v[108:109], v21 offset:3784
    ds_read_b64_tr_b16 v[110:111], v21 offset:3776
    v_mfma_f32_16x16x32_bf16 v[216:219], v[112:115], a[160:163], v[216:219]
    ds_read_b128 v[80:83], v24 offset:2496
    v_mfma_f32_16x16x32_bf16 v[220:223], v[112:115], a[164:167], v[220:223]
    ds_read_b128 v[84:87], v24 offset:3008
    v_mfma_f32_16x16x32_bf16 v[192:195], v[112:115], a[168:171], v[192:195]
    ds_read_b128 a[112:115], v24 offset:2432
    v_mfma_f32_16x16x32_bf16 v[196:199], v[112:115], a[172:175], v[196:199]
    ds_read_b128 a[116:119], v24 offset:2944
    buffer_load_dwordx4 a[52:55], v58, s[16:19], s87 offen offset:1024 sc1
    v_mfma_f32_16x16x32_bf16 v[200:203], v[112:115], a[176:179], v[200:203]
    v_mfma_f32_16x16x32_bf16 v[204:207], v[112:115], a[180:183], v[204:207]
    s_waitcnt lgkmcnt(15)
    ds_read_b64_tr_b16 v[112:113], v23 offset:8
    ds_read_b64_tr_b16 v[114:115], v23 offset:0
    v_mfma_f32_16x16x32_bf16 v[220:223], v[116:119], a[160:163], v[220:223]
    ds_read_b128 v[88:91], v24 offset:3520
    v_mfma_f32_16x16x32_bf16 v[192:195], v[116:119], a[164:167], v[192:195]
    ds_read_b128 v[92:95], v24 offset:4032
    buffer_load_dwordx4 a[56:59], v58, s[16:19], s61 offen offset:0 sc1
    v_mfma_f32_16x16x32_bf16 v[196:199], v[116:119], a[168:171], v[196:199]
    ds_read_b128 a[120:123], v24 offset:3456
    v_mfma_f32_16x16x32_bf16 v[200:203], v[116:119], a[172:175], v[200:203]
    ds_read_b128 a[124:127], v24 offset:3968
    v_mfma_f32_16x16x32_bf16 v[204:207], v[116:119], a[176:179], v[204:207]
    ds_read_b64_tr_b16 v[116:117], v23 offset:520
    ds_read_b64_tr_b16 v[118:119], v23 offset:512
    v_mfma_f32_16x16x32_bf16 v[192:195], v[120:123], a[160:163], v[192:195]
    v_mfma_f32_16x16x32_bf16 v[196:199], v[120:123], a[164:167], v[196:199]
    buffer_load_dwordx4 a[60:63], v58, s[16:19], s61 offen offset:1024 sc1
    v_mfma_f32_16x16x32_bf16 v[200:203], v[120:123], a[168:171], v[200:203]
    v_mfma_f32_16x16x32_bf16 v[204:207], v[120:123], a[172:175], v[204:207]
    ds_read_b64_tr_b16 v[120:121], v23 offset:1032
    ds_read_b64_tr_b16 v[122:123], v23 offset:1024
    v_mfma_f32_16x16x32_bf16 v[196:199], v[124:127], a[160:163], v[196:199]
    v_mfma_f32_16x16x32_bf16 v[200:203], v[124:127], a[164:167], v[200:203]
    s_add_u32 s87, s85, 4096
    buffer_load_dwordx4 a[64:67], v1, s[16:19], s87 offen offset:0 sc1
    v_mfma_f32_16x16x32_bf16 v[204:207], v[124:127], a[168:171], v[204:207]
    s_waitcnt lgkmcnt(15)
    ds_read_b64_tr_b16 v[124:125], v23 offset:1544
    ds_read_b64_tr_b16 v[126:127], v23 offset:1536
    v_mfma_f32_16x16x32_bf16 v[200:203], v[104:107], a[160:163], v[200:203]
    v_mfma_f32_16x16x32_bf16 v[204:207], v[104:107], a[164:167], v[204:207]
    s_waitcnt lgkmcnt(15)
    ds_read_b64_tr_b16 v[104:105], v23 offset:2056
    ds_read_b64_tr_b16 v[106:107], v23 offset:2048
    v_mfma_f32_16x16x32_bf16 v[204:207], v[108:111], a[160:163], v[204:207]
    buffer_load_dwordx4 a[68:71], v1, s[16:19], s87 offen offset:1024 sc1
    s_branch verj_14
ver_13:
pad_8:
    s_cbranch_execz pad_12
    v_mfma_f32_16x16x32_bf16 v[192:195], a[240:243], a[96:99], 0
    v_mfma_f32_16x16x32_bf16 v[196:199], a[240:243], a[100:103], 0
    v_mfma_f32_16x16x32_bf16 v[200:203], a[240:243], a[104:107], 0
    v_mul_f32 v224, v224, v240
    v_mul_f32 v225, v225, v241
    v_mul_f32 v226, v226, v242
    v_mfma_f32_16x16x32_bf16 v[204:207], a[240:243], a[108:111], 0
    v_mul_f32 v227, v227, v243
    v_cvt_pk_bf16_f32 v224, v224, v225
    v_cvt_pk_bf16_f32 v225, v226, v227
    v_mfma_f32_16x16x32_bf16 v[208:211], a[240:243], a[112:115], 0
    s_add_u32 s26, s26, 4096
    buffer_store_dwordx4 v[160:163], v1, s[16:19], s26 offen offset:0 sc1
    v_mul_f32 v228, v228, v244
    v_mul_f32 v229, v229, v245
    v_mfma_f32_16x16x32_bf16 v[212:215], a[240:243], a[116:119], 0
    v_mul_f32 v230, v230, v246
    v_mul_f32 v231, v231, v247
    v_cvt_pk_bf16_f32 v228, v228, v229
    v_mfma_f32_16x16x32_bf16 v[216:219], a[240:243], a[120:123], 0
    v_cvt_pk_bf16_f32 v229, v230, v231
    v_mul_f32 v232, v232, v248
    v_mul_f32 v233, v233, v249
    v_mfma_f32_16x16x32_bf16 v[220:223], a[240:243], a[124:127], 0
    ds_read_b64_tr_b16 v[124:125], v21 offset:2568
    ds_read_b64_tr_b16 v[126:127], v21 offset:2560
    v_mul_f32 v234, v234, v250
    s_barrier
    v_mfma_f32_16x16x32_bf16 v[192:195], v[104:107], a[96:99], v[192:195]
    ds_read_b128 a[160:163], v22 offset:384
    v_mul_f32 v235, v235, v251
    v_cvt_pk_bf16_f32 v232, v232, v233
    v_mfma_f32_16x16x32_bf16 v[196:199], v[104:107], a[100:103], v[196:199]
    ds_read_b128 a[164:167], v22 offset:896
    s_add_u32 s60, s59, 184320
    s_add_u32 m0, s23, 36864
    s_nop 0
    buffer_load_dwordx4 v32, s[40:43], s60 offen offset:0 lds
    v_cvt_pk_bf16_f32 v233, v234, v235
    v_mfma_f32_16x16x32_bf16 v[200:203], v[104:107], a[104:107], v[200:203]
    v_mul_f32 v236, v236, v252
    v_mul_f32 v237, v237, v253
    v_mul_f32 v238, v238, v254
    v_mfma_f32_16x16x32_bf16 v[204:207], v[104:107], a[108:111], v[204:207]
    v_mul_f32 v239, v239, v255
    v_cvt_pk_bf16_f32 v236, v236, v237
    v_cvt_pk_bf16_f32 v237, v238, v239
    v_mfma_f32_16x16x32_bf16 v[208:211], v[104:107], a[112:115], v[208:211]
    buffer_load_dwordx4 v33, s[40:43], s60 offen offset:1024 lds
    v_mfma_f32_16x16x32_bf16 v[212:215], v[104:107], a[116:119], v[212:215]
    v_mfma_f32_16x16x32_bf16 v[216:219], v[104:107], a[120:123], v[216:219]
    v_mfma_f32_16x16x32_bf16 v[220:223], v[104:107], a[124:127], v[220:223]
    ds_read_b64_tr_b16 v[104:105], v21 offset:3080
    ds_read_b64_tr_b16 v[106:107], v21 offset:3072
    v_mfma_f32_16x16x32_bf16 v[196:199], v[108:111], a[96:99], v[196:199]
    ds_read_b128 a[168:171], v22 offset:1408
    buffer_load_dwordx4 v34, s[40:43], s60 offen offset:2048 lds
    v_mfma_f32_16x16x32_bf16 v[200:203], v[108:111], a[100:103], v[200:203]
    ds_read_b128 a[172:175], v22 offset:1920
    v_mfma_f32_16x16x32_bf16 v[204:207], v[108:111], a[104:107], v[204:207]
    ds_write_b128 v13, a[232:235]
    ds_read_b64 v[246:247], v47
    ds_read_b64 v[248:249], v47 offset:8
    v_mfma_f32_16x16x32_bf16 v[208:211], v[108:111], a[108:111], v[208:211]
    buffer_load_dwordx4 v35, s[40:43], s60 offen offset:3072 lds
    ds_read_u16 v240, v45 offset:840
    ds_read_u16 v241, v45 offset:712
    v_mfma_f32_16x16x32_bf16 v[212:215], v[108:111], a[112:115], v[212:215]
    s_add_u32 m0, s23, 40960
    ds_read_u16 v242, v46 offset:646
    ds_read_u16 v243, v46 offset:774
    v_mfma_f32_16x16x32_bf16 v[216:219], v[108:111], a[116:119], v[216:219]
    ds_read_u16 v244, v46 offset:776
    ds_read_u16 v250, v43 offset:518
    v_mfma_f32_16x16x32_bf16 v[220:223], v[108:111], a[120:123], v[220:223]
    ds_read_b64_tr_b16 v[108:109], v21 offset:3592
    ds_read_b64_tr_b16 v[110:111], v21 offset:3584
    v_mfma_f32_16x16x32_bf16 v[200:203], v[112:115], a[96:99], v[200:203]
    ds_read_b128 a[176:179], v22 offset:2432
    buffer_load_dwordx4 v36, s[40:43], s60 offen offset:0 lds
    v_mfma_f32_16x16x32_bf16 v[204:207], v[112:115], a[100:103], v[204:207]
    ds_read_b128 a[180:183], v22 offset:2944
    buffer_store_dwordx4 v[164:167], v1, s[16:19], s26 offen offset:1024 sc1
    v_mfma_f32_16x16x32_bf16 v[208:211], v[112:115], a[104:107], v[208:211]
    ds_read_u16 v251, v41 offset:520
    ds_read_u16 v252, v41 offset:904
    v_mfma_f32_16x16x32_bf16 v[212:215], v[112:115], a[108:111], v[212:215]
    ds_read_u16 v253, v41 offset:906
    ds_read_u16 v254, v44 offset:904
    v_mfma_f32_16x16x32_bf16 v[216:219], v[112:115], a[112:115], v[216:219]
    buffer_load_dwordx4 v37, s[40:43], s60 offen offset:1024 lds
    v_mov_b32 v28, 0
    v_mfma_f32_16x16x32_bf16 v[220:223], v[112:115], a[116:119], v[220:223]
    s_waitcnt lgkmcnt(15)
    ds_read_b64_tr_b16 v[112:113], v21 offset:72
    ds_read_b64_tr_b16 v[114:115], v21 offset:64
    v_mfma_f32_16x16x32_bf16 v[204:207], v[116:119], a[96:99], v[204:207]
    ds_read_b128 a[184:187], v22 offset:3456
    v_mov_b32 v29, 0
    v_mfma_f32_16x16x32_bf16 v[208:211], v[116:119], a[100:103], v[208:211]
    ds_read_b128 a[188:191], v22 offset:3968
    buffer_load_dwordx4 v38, s[40:43], s60 offen offset:2048 lds
    v_mfma_f32_16x16x32_bf16 v[212:215], v[116:119], a[104:107], v[212:215]
    ds_write_b64 v51, v[28:29]
    ds_write_b64 v6, v[28:29]
    s_waitcnt lgkmcnt(15)
    v_mfma_f32_16x16x32_bf16 v[216:219], v[116:119], a[108:111], v[216:219]
    ds_write_b64 v50, v[248:249] offset:32
    v_alignbit_b32 v2, v248, v247, 16
    v_mfma_f32_16x16x32_bf16 v[220:223], v[116:119], a[112:115], v[220:223]
    ds_read_b64_tr_b16 v[116:117], v21 offset:584
    ds_read_b64_tr_b16 v[118:119], v21 offset:576
    v_mfma_f32_16x16x32_bf16 v[208:211], v[120:123], a[96:99], v[208:211]
    buffer_load_dwordx4 v39, s[40:43], s60 offen offset:3072 lds
    v_alignbit_b32 v3, v249, v248, 16
    v_mfma_f32_16x16x32_bf16 v[212:215], v[120:123], a[100:103], v[212:215]
    s_add_u32 m0, s23, 45056
    ds_write_b64 v50, v[2:3] offset:4192
    v_mov_b32 v4, v247
    v_mfma_f32_16x16x32_bf16 v[216:219], v[120:123], a[104:107], v[216:219]
    v_mov_b32 v5, v248
    v_mfma_f32_16x16x32_bf16 v[220:223], v[120:123], a[108:111], v[220:223]
    ds_read_b64_tr_b16 v[120:121], v21 offset:1096
    ds_read_b64_tr_b16 v[122:123], v21 offset:1088
    v_mfma_f32_16x16x32_bf16 v[212:215], v[124:127], a[96:99], v[212:215]
    s_add_u32 s60, s3, 5120
    buffer_load_dwordx4 v1, s[16:19], s60 offen lds
    ds_write_b64 v50, v[4:5] offset:8352
    v_mfma_f32_16x16x32_bf16 v[216:219], v[124:127], a[100:103], v[216:219]
    v_alignbit_b32 v28, v247, v246, 16
    v_mfma_f32_16x16x32_bf16 v[220:223], v[124:127], a[104:107], v[220:223]
    ds_read_b64_tr_b16 v[124:125], v21 offset:1608
    ds_read_b64_tr_b16 v[126:127], v21 offset:1600
    v_mfma_f32_16x16x32_bf16 v[216:219], v[104:107], a[96:99], v[216:219]
    s_add_u32 s60, s59, 36864
    buffer_load_dwordx4 v[144:147], v32, s[40:43], s60 offen offset:0
    v_mov_b32 v29, v2
    v_mfma_f32_16x16x32_bf16 v[220:223], v[104:107], a[100:103], v[220:223]
    s_waitcnt lgkmcnt(15)
    ds_read_b64_tr_b16 v[104:105], v21 offset:2120
    ds_read_b64_tr_b16 v[106:107], v21 offset:2112
    v_mfma_f32_16x16x32_bf16 v[220:223], v[108:111], a[96:99], v[220:223]
    s_waitcnt lgkmcnt(15)
    ds_read_b64_tr_b16 v[108:109], v21 offset:2632
    ds_read_b64_tr_b16 v[110:111], v21 offset:2624
    v_mfma_f32_16x16x32_bf16 v[192:195], v[112:115], a[160:163], v[192:195]
    ds_read_b128 a[96:99], v22 offset:320
    buffer_load_dwordx2 v[54:55], v61, s[32:35], s86 offen sc1
    v_mfma_f32_16x16x32_bf16 v[196:199], v[112:115], a[164:167], v[196:199]
    ds_read_b128 a[100:103], v22 offset:832
    buffer_store_dwordx4 v[168:171], v1, s[16:19], s26 offen offset:2048 sc1
    v_mfma_f32_16x16x32_bf16 v[200:203], v[112:115], a[168:171], v[200:203]
    buffer_load_dwordx4 v[148:151], v33, s[40:43], s60 offen offset:1024
    ds_write_b64 v50, v[28:29] offset:12512
    v_mfma_f32_16x16x32_bf16 v[204:207], v[112:115], a[172:175], v[204:207]
    v_lshl_or_b32 v4, v240, 16, v240
    v_mfma_f32_16x16x32_bf16 v[208:211], v[112:115], a[176:179], v[208:211]
    buffer_load_dwordx4 v[152:155], v34, s[40:43], s60 offen offset:2048
    v_lshl_or_b32 v5, v244, 16, v241
    v_mfma_f32_16x16x32_bf16 v[212:215], v[112:115], a[180:183], v[212:215]
    s_waitcnt lgkmcnt(15)
    ds_write_b64 v50, v[4:5] offset:544
    v_lshl_or_b32 v5, v241, 16, v240
    v_mfma_f32_16x16x32_bf16 v[216:219], v[112:115], a[184:187], v[216:219]
    ds_write_b64 v50, v[4:5] offset:4704
    v_lshl_or_b32 v4, v240, 16, v242
    v_mfma_f32_16x16x32_bf16 v[220:223], v[112:115], a[188:191], v[220:223]
    s_waitcnt lgkmcnt(15)
    ds_read_b64_tr_b16 v[112:113], v21 offset:3144
    ds_read_b64_tr_b16 v[114:115], v21 offset:3136
    v_mfma_f32_16x16x32_bf16 v[196:199], v[116:119], a[160:163], v[196:199]
    ds_read_b128 a[104:107], v22 offset:1344
    buffer_load_dwordx4 v[156:159], v35, s[40:43], s60 offen offset:3072
    v_mfma_f32_16x16x32_bf16 v[200:203], v[116:119], a[164:167], v[200:203]
    ds_read_b128 a[108:111], v22 offset:1856
    v_lshl_or_b32 v5, v240, 16, v240
    v_mfma_f32_16x16x32_bf16 v[204:207], v[116:119], a[168:171], v[204:207]
    ds_write_b64 v50, v[4:5] offset:8864
    v_lshl_or_b32 v4, v242, 16, v243
    v_mfma_f32_16x16x32_bf16 v[208:211], v[116:119], a[172:175], v[208:211]
    buffer_load_dwordx4 v[176:179], v36, s[40:43], s60 offen offset:0
    ds_write_b64 v50, v[4:5] offset:13024
    v_mfma_f32_16x16x32_bf16 v[212:215], v[116:119], a[176:179], v[212:215]
    ds_write_b16_d16_hi v50, v249 offset:4200
    ds_write_b32 v50, v249 offset:8360
    v_mfma_f32_16x16x32_bf16 v[216:219], v[116:119], a[180:183], v[216:219]
    ds_write_b32 v50, v3 offset:12520
    ds_write_b16_d16_hi v50, v249 offset:12524
    v_mfma_f32_16x16x32_bf16 v[220:223], v[116:119], a[184:187], v[220:223]
    s_waitcnt lgkmcnt(15)
    ds_read_b64_tr_b16 v[116:117], v21 offset:3656
    ds_read_b64_tr_b16 v[118:119], v21 offset:3648
    v_mfma_f32_16x16x32_bf16 v[200:203], v[120:123], a[160:163], v[200:203]
    ds_read_b128 a[112:115], v22 offset:2368
    buffer_load_dwordx4 v[180:183], v37, s[40:43], s60 offen offset:1024
    v_mfma_f32_16x16x32_bf16 v[204:207], v[120:123], a[164:167], v[204:207]
    ds_read_b128 a[116:119], v22 offset:2880
    v_lshl_or_b32 v240, v252, 16, v252
    v_mfma_f32_16x16x32_bf16 v[208:211], v[120:123], a[168:171], v[208:211]
    v_lshl_or_b32 v241, v251, 16, v252
    v_mfma_f32_16x16x32_bf16 v[212:215], v[120:123], a[172:175], v[212:215]
    v_lshl_or_b32 v242, v251, 16, v251
    v_mfma_f32_16x16x32_bf16 v[216:219], v[120:123], a[176:179], v[216:219]
    buffer_load_dwordx4 v[184:187], v38, s[40:43], s60 offen offset:2048
    v_lshl_or_b32 v243, v253, 16, v253
    v_mfma_f32_16x16x32_bf16 v[220:223], v[120:123], a[180:183], v[220:223]
    ds_read_b64_tr_b16 v[120:121], v21 offset:136
    ds_read_b64_tr_b16 v[122:123], v21 offset:128
    v_mfma_f32_16x16x32_bf16 v[204:207], v[124:127], a[160:163], v[204:207]
    ds_read_b128 a[120:123], v22 offset:3392
    buffer_store_dwordx4 v[172:175], v1, s[16:19], s26 offen offset:3072 sc1
    v_mfma_f32_16x16x32_bf16 v[208:211], v[124:127], a[164:167], v[208:211]
    ds_read_b128 a[124:127], v22 offset:3904
    buffer_load_dwordx4 v[188:191], v39, s[40:43], s60 offen offset:3072
    v_mfma_f32_16x16x32_bf16 v[212:215], v[124:127], a[168:171], v[212:215]
    ds_write_b128 v49, v[240:243] offset:1056
    v_lshl_or_b32 v241, v252, 16, v252
    v_mfma_f32_16x16x32_bf16 v[216:219], v[124:127], a[172:175], v[216:219]
pad_9:
    s_cbranch_execz pad_13
    v_lshl_or_b32 v243, v253, 16, v251
    v_mfma_f32_16x16x32_bf16 v[220:223], v[124:127], a[176:179], v[220:223]
    ds_read_b64_tr_b16 v[124:125], v21 offset:648
    ds_read_b64_tr_b16 v[126:127], v21 offset:640
    v_mfma_f32_16x16x32_bf16 v[208:211], v[104:107], a[160:163], v[208:211]
    s_add_u32 s60, s3, 1024
    buffer_load_dwordx4 a[236:239], v1, s[16:19], s60 offen
    ds_write_b128 v49, v[240:243] offset:5216
    v_mfma_f32_16x16x32_bf16 v[212:215], v[104:107], a[164:167], v[212:215]
    v_lshl_or_b32 v240, v252, 16, v254
    v_mfma_f32_16x16x32_bf16 v[216:219], v[104:107], a[168:171], v[216:219]
    v_lshl_or_b32 v242, v251, 16, v252
    v_mfma_f32_16x16x32_bf16 v[220:223], v[104:107], a[172:175], v[220:223]
    ds_read_b64_tr_b16 v[104:105], v21 offset:1160
    ds_read_b64_tr_b16 v[106:107], v21 offset:1152
    v_mfma_f32_16x16x32_bf16 v[212:215], v[108:111], a[160:163], v[212:215]
    buffer_store_dwordx2 v[224:225], v59, s[16:19], s27 offen offset:0 sc1
    v_lshl_or_b32 v243, v251, 16, v251
    v_mfma_f32_16x16x32_bf16 v[216:219], v[108:111], a[164:167], v[216:219]
    ds_write_b128 v49, v[240:243] offset:9376
    v_lshl_or_b32 v240, v254, 16, v250
    v_mfma_f32_16x16x32_bf16 v[220:223], v[108:111], a[168:171], v[220:223]
    s_waitcnt lgkmcnt(15)
    ds_read_b64_tr_b16 v[108:109], v21 offset:1672
    ds_read_b64_tr_b16 v[110:111], v21 offset:1664
    v_mfma_f32_16x16x32_bf16 v[216:219], v[112:115], a[160:163], v[216:219]
    s_waitcnt vmcnt(11)
    v_cmp_ne_u64 vcc, v[62:63], v[54:55]
    s_nop 0
    s_cbranch_vccnz fas_17
far_18:
    v_mfma_f32_16x16x32_bf16 v[220:223], v[112:115], a[164:167], v[220:223]
    s_waitcnt lgkmcnt(15)
    ds_read_b64_tr_b16 v[112:113], v21 offset:2184
    ds_read_b64_tr_b16 v[114:115], v21 offset:2176
    v_mfma_f32_16x16x32_bf16 v[220:223], v[116:119], a[160:163], v[220:223]
    s_waitcnt lgkmcnt(13)
    ds_read_b64_tr_b16 v[116:117], v21 offset:2696
    ds_read_b64_tr_b16 v[118:119], v21 offset:2688
    v_mfma_f32_16x16x32_bf16 v[192:195], v[120:123], a[96:99], v[192:195]
    ds_read_b128 a[160:163], v22 offset:256
    s_add_u32 s87, s85, 0
    buffer_load_dwordx4 a[0:3], v1, s[16:19], s87 offen offset:0 sc1
    v_mfma_f32_16x16x32_bf16 v[196:199], v[120:123], a[100:103], v[196:199]
    ds_read_b128 a[164:167], v22 offset:768
    buffer_load_dwordx4 a[4:7], v1, s[16:19], s87 offen offset:1024 sc1
    v_mfma_f32_16x16x32_bf16 v[200:203], v[120:123], a[104:107], v[200:203]
    v_lshl_or_b32 v242, v252, 16, v252
    v_mfma_f32_16x16x32_bf16 v[204:207], v[120:123], a[108:111], v[204:207]
    ds_write_b128 v49, v[240:243] offset:13536
    v_lshrrev_b32 v3, 2, v0
    v_mfma_f32_16x16x32_bf16 v[208:211], v[120:123], a[112:115], v[208:211]
    buffer_store_dwordx2 v[228:229], v59, s[16:19], s27 offen offset:512 sc1
    v_and_b32 v4, 7, v3
    v_mfma_f32_16x16x32_bf16 v[212:215], v[120:123], a[116:119], v[212:215]
    s_waitcnt lgkmcnt(15)
    s_xor_b32 s61, s87, 2048
    buffer_load_dwordx4 a[8:11], v1, s[16:19], s61 offen offset:0 sc1
    v_lshlrev_b32 v3, 8, v3
    v_mfma_f32_16x16x32_bf16 v[216:219], v[120:123], a[120:123], v[216:219]
    v_lshl_add_u32 v3, v4, 5, v3
    v_mfma_f32_16x16x32_bf16 v[220:223], v[120:123], a[124:127], v[220:223]
    s_waitcnt lgkmcnt(13)
    ds_read_b64_tr_b16 v[120:121], v21 offset:3208
    ds_read_b64_tr_b16 v[122:123], v21 offset:3200
    v_mfma_f32_16x16x32_bf16 v[196:199], v[124:127], a[96:99], v[196:199]
    ds_read_b128 a[168:171], v22 offset:1280
    v_and_b32 v4, 3, v0
    v_mfma_f32_16x16x32_bf16 v[200:203], v[124:127], a[100:103], v[200:203]
    ds_read_b128 a[172:175], v22 offset:1792
    v_lshl_add_u32 v3, v4, 3, v3
    v_mfma_f32_16x16x32_bf16 v[204:207], v[124:127], a[104:107], v[204:207]
    buffer_load_dwordx4 a[12:15], v1, s[16:19], s61 offen offset:1024 sc1
    s_mul_i32 s48, s62, 18432
    v_mfma_f32_16x16x32_bf16 v[208:211], v[124:127], a[108:111], v[208:211]
    v_add_u32 v8, s48, v3
    v_mfma_f32_16x16x32_bf16 v[212:215], v[124:127], a[112:115], v[212:215]
    v_xor_b32 v9, 32, v8
    v_mfma_f32_16x16x32_bf16 v[216:219], v[124:127], a[116:119], v[216:219]
    v_xor_b32 v10, 64, v8
    v_mfma_f32_16x16x32_bf16 v[220:223], v[124:127], a[120:123], v[220:223]
    s_waitcnt lgkmcnt(14)
    ds_read_b64_tr_b16 v[124:125], v21 offset:3720
    ds_read_b64_tr_b16 v[126:127], v21 offset:3712
    v_mfma_f32_16x16x32_bf16 v[200:203], v[104:107], a[96:99], v[200:203]
    ds_read_b128 a[176:179], v22 offset:2304
    buffer_store_dwordx2 v[232:233], v59, s[16:19], s27 offen offset:1024 sc1
    v_mfma_f32_16x16x32_bf16 v[204:207], v[104:107], a[100:103], v[204:207]
    ds_read_b128 a[180:183], v22 offset:2816
    buffer_load_dwordx4 a[16:19], v58, s[16:19], s87 offen offset:0 sc1
    v_mfma_f32_16x16x32_bf16 v[208:211], v[104:107], a[104:107], v[208:211]
    v_xor_b32 v11, 96, v8
    v_mfma_f32_16x16x32_bf16 v[212:215], v[104:107], a[108:111], v[212:215]
    v_xor_b32 v25, 128, v8
    v_mfma_f32_16x16x32_bf16 v[216:219], v[104:107], a[112:115], v[216:219]
    buffer_load_dwordx4 a[20:23], v58, s[16:19], s87 offen offset:1024 sc1
    v_xor_b32 v26, 160, v8
    s_waitcnt lgkmcnt(8)
    s_barrier
    v_mfma_f32_16x16x32_bf16 v[220:223], v[104:107], a[116:119], v[220:223]
    ds_read_b64_tr_b16 v[104:105], v21 offset:200
    ds_read_b64_tr_b16 v[106:107], v21 offset:192
    v_mfma_f32_16x16x32_bf16 v[204:207], v[108:111], a[96:99], v[204:207]
    ds_read_b128 a[184:187], v22 offset:3328
    v_xor_b32 v27, 192, v8
    v_mfma_f32_16x16x32_bf16 v[208:211], v[108:111], a[100:103], v[208:211]
    ds_read_b128 a[188:191], v22 offset:3840
    v_xor_b32 v41, 224, v8
    v_mfma_f32_16x16x32_bf16 v[212:215], v[108:111], a[104:107], v[212:215]
    buffer_load_dwordx4 a[24:27], v58, s[16:19], s61 offen offset:0 sc1
    s_add_u32 s48, s48, 8192
    v_mfma_f32_16x16x32_bf16 v[216:219], v[108:111], a[108:111], v[216:219]
    buffer_store_dwordx2 v[236:237], v59, s[16:19], s27 offen offset:1536 sc1
    v_add_u32 v42, s48, v59
    v_mfma_f32_16x16x32_bf16 v[220:223], v[108:111], a[112:115], v[220:223]
    ds_read_b64_tr_b16 v[108:109], v21 offset:712
    ds_read_b64_tr_b16 v[110:111], v21 offset:704
    v_mfma_f32_16x16x32_bf16 v[208:211], v[112:115], a[96:99], v[208:211]
    v_add_u32 v43, 73728, v8
    v_mfma_f32_16x16x32_bf16 v[212:215], v[112:115], a[100:103], v[212:215]
    buffer_load_dwordx4 a[28:31], v58, s[16:19], s61 offen offset:1024 sc1
    v_add_u32 v44, 73728, v9
    v_mfma_f32_16x16x32_bf16 v[216:219], v[112:115], a[104:107], v[216:219]
    v_add_u32 v45, 73728, v10
    v_mfma_f32_16x16x32_bf16 v[220:223], v[112:115], a[108:111], v[220:223]
    ds_read_b64_tr_b16 v[112:113], v21 offset:1224
    ds_read_b64_tr_b16 v[114:115], v21 offset:1216
    v_mfma_f32_16x16x32_bf16 v[212:215], v[116:119], a[96:99], v[212:215]
    v_add_u32 v46, 73728, v11
    v_mfma_f32_16x16x32_bf16 v[216:219], v[116:119], a[100:103], v[216:219]
    v_add_u32 v47, 73728, v25
    v_mfma_f32_16x16x32_bf16 v[220:223], v[116:119], a[104:107], v[220:223]
    s_waitcnt lgkmcnt(14)
    ds_read_b64_tr_b16 v[116:117], v21 offset:1736
    ds_read_b64_tr_b16 v[118:119], v21 offset:1728
    v_mfma_f32_16x16x32_bf16 v[216:219], v[120:123], a[96:99], v[216:219]
    s_add_u32 s87, s85, 20480
    buffer_load_dwordx4 a[32:35], v1, s[16:19], s87 offen offset:0 sc1
    v_add_u32 v48, 73728, v26
    v_mfma_f32_16x16x32_bf16 v[220:223], v[120:123], a[100:103], v[220:223]
    s_waitcnt lgkmcnt(12)
    ds_read_b64_tr_b16 v[120:121], v21 offset:2248
    ds_read_b64_tr_b16 v[122:123], v21 offset:2240
    v_mfma_f32_16x16x32_bf16 v[220:223], v[124:127], a[96:99], v[220:223]
    s_waitcnt lgkmcnt(10)
    ds_read_b64_tr_b16 v[124:125], v21 offset:2760
    ds_read_b64_tr_b16 v[126:127], v21 offset:2752
    v_mfma_f32_16x16x32_bf16 v[192:195], v[104:107], a[160:163], v[192:195]
    ds_read_b128 v[64:67], v24 offset:448
    buffer_load_dwordx4 a[36:39], v1, s[16:19], s87 offen offset:1024 sc1
    v_mfma_f32_16x16x32_bf16 v[196:199], v[104:107], a[164:167], v[196:199]
    ds_read_b128 v[68:71], v24 offset:960
    v_add_u32 v49, 73728, v27
    v_mfma_f32_16x16x32_bf16 v[200:203], v[104:107], a[168:171], v[200:203]
    ds_read_b128 a[96:99], v24 offset:384
    v_add_u32 v50, 73728, v41
    v_mfma_f32_16x16x32_bf16 v[204:207], v[104:107], a[172:175], v[204:207]
    ds_read_b128 a[100:103], v24 offset:896
    v_add_u32 v51, 73728, v42
    v_mfma_f32_16x16x32_bf16 v[208:211], v[104:107], a[176:179], v[208:211]
    v_mfma_f32_16x16x32_bf16 v[212:215], v[104:107], a[180:183], v[212:215]
    s_waitcnt lgkmcnt(15)
    s_xor_b32 s61, s87, 2048
    buffer_load_dwordx4 a[40:43], v1, s[16:19], s61 offen offset:0 sc1
    v_mfma_f32_16x16x32_bf16 v[216:219], v[104:107], a[184:187], v[216:219]
    s_waitcnt lgkmcnt(14)
    v_mfma_f32_16x16x32_bf16 v[220:223], v[104:107], a[188:191], v[220:223]
    s_waitcnt lgkmcnt(12)
    ds_read_b64_tr_b16 v[104:105], v21 offset:3272
    ds_read_b64_tr_b16 v[106:107], v21 offset:3264
    v_mfma_f32_16x16x32_bf16 v[196:199], v[108:111], a[160:163], v[196:199]
    ds_read_b128 v[72:75], v24 offset:1472
    v_mfma_f32_16x16x32_bf16 v[200:203], v[108:111], a[164:167], v[200:203]
    ds_read_b128 v[76:79], v24 offset:1984
    buffer_load_dwordx4 a[44:47], v1, s[16:19], s61 offen offset:1024 sc1
    v_mfma_f32_16x16x32_bf16 v[204:207], v[108:111], a[168:171], v[204:207]
    ds_read_b128 a[104:107], v24 offset:1408
    v_mfma_f32_16x16x32_bf16 v[208:211], v[108:111], a[172:175], v[208:211]
    ds_read_b128 a[108:111], v24 offset:1920
    v_mfma_f32_16x16x32_bf16 v[212:215], v[108:111], a[176:179], v[212:215]
    v_mfma_f32_16x16x32_bf16 v[216:219], v[108:111], a[180:183], v[216:219]
    buffer_load_dwordx4 a[48:51], v58, s[16:19], s87 offen offset:0 sc1
    v_mfma_f32_16x16x32_bf16 v[220:223], v[108:111], a[184:187], v[220:223]
    s_waitcnt lgkmcnt(15)
    ds_read_b64_tr_b16 v[108:109], v21 offset:3784
    ds_read_b64_tr_b16 v[110:111], v21 offset:3776
    v_mfma_f32_16x16x32_bf16 v[200:203], v[112:115], a[160:163], v[200:203]
    ds_read_b128 v[80:83], v24 offset:2496
    v_mfma_f32_16x16x32_bf16 v[204:207], v[112:115], a[164:167], v[204:207]
    ds_read_b128 v[84:87], v24 offset:3008
    v_mfma_f32_16x16x32_bf16 v[208:211], v[112:115], a[168:171], v[208:211]
    ds_read_b128 a[112:115], v24 offset:2432
    v_mfma_f32_16x16x32_bf16 v[212:215], v[112:115], a[172:175], v[212:215]
    ds_read_b128 a[116:119], v24 offset:2944
    buffer_load_dwordx4 a[52:55], v58, s[16:19], s87 offen offset:1024 sc1
    v_mfma_f32_16x16x32_bf16 v[216:219], v[112:115], a[176:179], v[216:219]
    v_mfma_f32_16x16x32_bf16 v[220:223], v[112:115], a[180:183], v[220:223]
    s_waitcnt lgkmcnt(15)
    ds_read_b64_tr_b16 v[112:113], v23 offset:8
    ds_read_b64_tr_b16 v[114:115], v23 offset:0
    v_mfma_f32_16x16x32_bf16 v[204:207], v[116:119], a[160:163], v[204:207]
    ds_read_b128 v[88:91], v24 offset:3520
    v_mfma_f32_16x16x32_bf16 v[208:211], v[116:119], a[164:167], v[208:211]
    ds_read_b128 v[92:95], v24 offset:4032
    buffer_load_dwordx4 a[56:59], v58, s[16:19], s61 offen offset:0 sc1
    v_mfma_f32_16x16x32_bf16 v[212:215], v[116:119], a[168:171], v[212:215]
    ds_read_b128 a[120:123], v24 offset:3456
    v_mfma_f32_16x16x32_bf16 v[216:219], v[116:119], a[172:175], v[216:219]
    ds_read_b128 a[124:127], v24 offset:3968
    v_mfma_f32_16x16x32_bf16 v[220:223], v[116:119], a[176:179], v[220:223]
    ds_read_b64_tr_b16 v[116:117], v23 offset:520
    ds_read_b64_tr_b16 v[118:119], v23 offset:512
    v_mfma_f32_16x16x32_bf16 v[208:211], v[120:123], a[160:163], v[208:211]
    v_mfma_f32_16x16x32_bf16 v[212:215], v[120:123], a[164:167], v[212:215]
    buffer_load_dwordx4 a[60:63], v58, s[16:19], s61 offen offset:1024 sc1
    v_mfma_f32_16x16x32_bf16 v[216:219], v[120:123], a[168:171], v[216:219]
    v_mfma_f32_16x16x32_bf16 v[220:223], v[120:123], a[172:175], v[220:223]
    ds_read_b64_tr_b16 v[120:121], v23 offset:1032
    ds_read_b64_tr_b16 v[122:123], v23 offset:1024
    v_mfma_f32_16x16x32_bf16 v[212:215], v[124:127], a[160:163], v[212:215]
    v_mfma_f32_16x16x32_bf16 v[216:219], v[124:127], a[164:167], v[216:219]
    s_add_u32 s87, s85, 4096
    buffer_load_dwordx4 a[64:67], v1, s[16:19], s87 offen offset:0 sc1
    v_mfma_f32_16x16x32_bf16 v[220:223], v[124:127], a[168:171], v[220:223]
    s_waitcnt lgkmcnt(15)
    ds_read_b64_tr_b16 v[124:125], v23 offset:1544
    ds_read_b64_tr_b16 v[126:127], v23 offset:1536
    v_mfma_f32_16x16x32_bf16 v[216:219], v[104:107], a[160:163], v[216:219]
    v_mfma_f32_16x16x32_bf16 v[220:223], v[104:107], a[164:167], v[220:223]
    s_waitcnt lgkmcnt(15)
    ds_read_b64_tr_b16 v[104:105], v23 offset:2056
    ds_read_b64_tr_b16 v[106:107], v23 offset:2048
    v_mfma_f32_16x16x32_bf16 v[220:223], v[108:111], a[160:163], v[220:223]
    buffer_load_dwordx4 a[68:71], v1, s[16:19], s87 offen offset:1024 sc1
verj_14:
pad_10:
    s_cbranch_execz pad_14
    s_cmp_eq_u32 s5, 1
    s_cbranch_scc1 ver_20
    s_cmp_eq_u32 s5, 2
    s_cbranch_scc1 ver_21
    s_cmp_eq_u32 s5, 3
    s_cbranch_scc1 ver_22
ver_19:
pad_11:
    s_cbranch_execz pad_15
    s_waitcnt lgkmcnt(10)
    v_mfma_f32_16x16x32_bf16 v[240:243], a[244:247], v[92:95], 0
    v_mfma_f32_16x16x32_bf16 v[244:247], a[244:247], v[64:67], 0
    ds_read_b64_tr_b16 v[108:109], v23 offset:2568
    ds_read_b64_tr_b16 v[110:111], v23 offset:2560
    v_mfma_f32_16x16x32_bf16 v[240:243], v[112:115], v[92:95], v[240:243]
    v_mfma_f32_16x16x32_bf16 v[244:247], v[112:115], v[64:67], v[244:247]
    s_waitcnt lgkmcnt(8)
    ds_read_b64_tr_b16 v[112:113], v23 offset:3080
    ds_read_b64_tr_b16 v[114:115], v23 offset:3072
    v_mfma_f32_16x16x32_bf16 v[240:243], v[116:119], v[88:91], v[240:243]
    s_waitcnt lgkmcnt(8)
    ds_read_b64_tr_b16 v[116:117], v23 offset:3592
    ds_read_b64_tr_b16 v[118:119], v23 offset:3584
    s_xor_b32 s61, s87, 2048
    buffer_load_dwordx4 a[72:75], v1, s[16:19], s61 offen offset:0 sc1
    v_mfma_f32_16x16x32_bf16 v[240:243], v[120:123], v[84:87], v[240:243]
    s_waitcnt lgkmcnt(8)
    ds_read_b64_tr_b16 v[120:121], v23 offset:72
    ds_read_b64_tr_b16 v[122:123], v23 offset:64
    v_mfma_f32_16x16x32_bf16 v[240:243], v[124:127], v[80:83], v[240:243]
    s_waitcnt lgkmcnt(8)
    ds_read_b64_tr_b16 v[124:125], v23 offset:584
    ds_read_b64_tr_b16 v[126:127], v23 offset:576
    v_mfma_f32_16x16x32_bf16 v[240:243], v[104:107], v[76:79], v[240:243]
    s_waitcnt lgkmcnt(8)
    ds_read_b64_tr_b16 v[104:105], v23 offset:1096
    ds_read_b64_tr_b16 v[106:107], v23 offset:1088
    v_mfma_f32_16x16x32_bf16 v[240:243], v[108:111], v[72:75], v[240:243]
    s_waitcnt lgkmcnt(8)
    ds_read_b64_tr_b16 v[108:109], v23 offset:1608
    ds_read_b64_tr_b16 v[110:111], v23 offset:1600
    buffer_load_dwordx4 a[76:79], v1, s[16:19], s61 offen offset:1024 sc1
    v_mfma_f32_16x16x32_bf16 v[240:243], v[112:115], v[68:71], v[240:243]
    s_waitcnt lgkmcnt(8)
    ds_read_b64_tr_b16 v[112:113], v23 offset:2120
    ds_read_b64_tr_b16 v[114:115], v23 offset:2112
    v_mfma_f32_16x16x32_bf16 v[240:243], v[116:119], v[64:67], v[240:243]
    s_waitcnt lgkmcnt(8)
    ds_read_b64_tr_b16 v[116:117], v23 offset:2632
    ds_read_b64_tr_b16 v[118:119], v23 offset:2624
    v_mfma_f32_16x16x32_bf16 v[240:243], v[120:123], a[124:127], v[240:243]
    v_mfma_f32_16x16x32_bf16 v[244:247], v[120:123], a[96:99], v[244:247]
    s_waitcnt lgkmcnt(8)
    ds_read_b64_tr_b16 v[120:121], v23 offset:3144
    ds_read_b64_tr_b16 v[122:123], v23 offset:3136
    v_mfma_f32_16x16x32_bf16 v[240:243], v[124:127], a[120:123], v[240:243]
    s_waitcnt lgkmcnt(8)
    ds_read_b64_tr_b16 v[124:125], v23 offset:3656
    ds_read_b64_tr_b16 v[126:127], v23 offset:3648
    buffer_load_dwordx4 a[80:83], v58, s[16:19], s87 offen offset:0 sc1
    v_mfma_f32_16x16x32_bf16 v[240:243], v[104:107], a[116:119], v[240:243]
    s_waitcnt lgkmcnt(8)
    v_mfma_f32_16x16x32_bf16 v[240:243], v[108:111], a[112:115], v[240:243]
    s_waitcnt lgkmcnt(6)
    v_mfma_f32_16x16x32_bf16 v[240:243], v[112:115], a[108:111], v[240:243]
    s_waitcnt lgkmcnt(4)
    ds_read_b64_tr_b16 a[192:193], v43 offset:36864
    ds_read_b64_tr_b16 a[194:195], v43 offset:40960
    v_mfma_f32_16x16x32_bf16 v[240:243], v[116:119], a[104:107], v[240:243]
    s_waitcnt lgkmcnt(4)
    buffer_load_dwordx4 a[84:87], v58, s[16:19], s87 offen offset:1024 sc1
    ds_read_b64_tr_b16 a[196:197], v44 offset:36864
    ds_read_b64_tr_b16 a[198:199], v44 offset:40960
    v_mfma_f32_16x16x32_bf16 v[240:243], v[120:123], a[100:103], v[240:243]
    s_waitcnt lgkmcnt(4)
    ds_read_b64_tr_b16 a[200:201], v45 offset:36864
    ds_read_b64_tr_b16 a[202:203], v45 offset:40960
    v_mfma_f32_16x16x32_bf16 v[240:243], v[124:127], a[96:99], v[240:243]
    ds_read_b64_tr_b16 a[204:205], v46 offset:36864
    ds_read_b64_tr_b16 a[206:207], v46 offset:40960
    s_branch verj_23
ver_20:
pad_12:
    s_cbranch_execz pad_16
    s_waitcnt lgkmcnt(11)
    v_mfma_f32_16x16x32_bf16 v[240:243], a[244:247], v[88:91], 0
    v_mfma_f32_16x16x32_bf16 v[244:247], a[244:247], v[68:71], 0
    ds_read_b64_tr_b16 v[108:109], v23 offset:2568
    ds_read_b64_tr_b16 v[110:111], v23 offset:2560
    v_mfma_f32_16x16x32_bf16 v[240:243], v[112:115], v[88:91], v[240:243]
    v_mfma_f32_16x16x32_bf16 v[244:247], v[112:115], v[68:71], v[244:247]
    s_waitcnt lgkmcnt(8)
    ds_read_b64_tr_b16 v[112:113], v23 offset:3080
    ds_read_b64_tr_b16 v[114:115], v23 offset:3072
    v_mfma_f32_16x16x32_bf16 v[240:243], v[116:119], v[84:87], v[240:243]
    s_xor_b32 s61, s87, 2048
    buffer_load_dwordx4 a[72:75], v1, s[16:19], s61 offen offset:0 sc1
    v_mfma_f32_16x16x32_bf16 v[244:247], v[116:119], v[64:67], v[244:247]
    s_waitcnt lgkmcnt(8)
    ds_read_b64_tr_b16 v[116:117], v23 offset:72
    ds_read_b64_tr_b16 v[118:119], v23 offset:64
    v_mfma_f32_16x16x32_bf16 v[240:243], v[120:123], v[80:83], v[240:243]
    s_waitcnt lgkmcnt(8)
    ds_read_b64_tr_b16 v[120:121], v23 offset:584
    ds_read_b64_tr_b16 v[122:123], v23 offset:576
    v_mfma_f32_16x16x32_bf16 v[240:243], v[124:127], v[76:79], v[240:243]
    s_waitcnt lgkmcnt(8)
    ds_read_b64_tr_b16 v[124:125], v23 offset:1096
    ds_read_b64_tr_b16 v[126:127], v23 offset:1088
    v_mfma_f32_16x16x32_bf16 v[240:243], v[104:107], v[72:75], v[240:243]
    s_waitcnt lgkmcnt(8)
    ds_read_b64_tr_b16 v[104:105], v23 offset:1608
    ds_read_b64_tr_b16 v[106:107], v23 offset:1600
    buffer_load_dwordx4 a[76:79], v1, s[16:19], s61 offen offset:1024 sc1
    v_mfma_f32_16x16x32_bf16 v[240:243], v[108:111], v[68:71], v[240:243]
    s_waitcnt lgkmcnt(8)
    ds_read_b64_tr_b16 v[108:109], v23 offset:2120
    ds_read_b64_tr_b16 v[110:111], v23 offset:2112
    v_mfma_f32_16x16x32_bf16 v[240:243], v[112:115], v[64:67], v[240:243]
    s_waitcnt lgkmcnt(8)
    ds_read_b64_tr_b16 v[112:113], v23 offset:2632
    ds_read_b64_tr_b16 v[114:115], v23 offset:2624
    v_mfma_f32_16x16x32_bf16 v[240:243], v[116:119], a[120:123], v[240:243]
    v_mfma_f32_16x16x32_bf16 v[244:247], v[116:119], a[100:103], v[244:247]
    s_waitcnt lgkmcnt(8)
    ds_read_b64_tr_b16 v[116:117], v23 offset:3144
    ds_read_b64_tr_b16 v[118:119], v23 offset:3136
    v_mfma_f32_16x16x32_bf16 v[240:243], v[120:123], a[116:119], v[240:243]
    buffer_load_dwordx4 a[80:83], v58, s[16:19], s87 offen offset:0 sc1
    v_mfma_f32_16x16x32_bf16 v[244:247], v[120:123], a[96:99], v[244:247]
    s_waitcnt lgkmcnt(8)
    v_mfma_f32_16x16x32_bf16 v[240:243], v[124:127], a[112:115], v[240:243]
    s_waitcnt lgkmcnt(6)
    v_mfma_f32_16x16x32_bf16 v[240:243], v[104:107], a[108:111], v[240:243]
    s_waitcnt lgkmcnt(4)
    ds_read_b64_tr_b16 a[192:193], v43 offset:36864
    ds_read_b64_tr_b16 a[194:195], v43 offset:40960
    v_mfma_f32_16x16x32_bf16 v[240:243], v[108:111], a[104:107], v[240:243]
    s_waitcnt lgkmcnt(4)
    buffer_load_dwordx4 a[84:87], v58, s[16:19], s87 offen offset:1024 sc1
    ds_read_b64_tr_b16 a[196:197], v44 offset:36864
    ds_read_b64_tr_b16 a[198:199], v44 offset:40960
    v_mfma_f32_16x16x32_bf16 v[240:243], v[112:115], a[100:103], v[240:243]
    s_waitcnt lgkmcnt(4)
    ds_read_b64_tr_b16 a[200:201], v45 offset:36864
    ds_read_b64_tr_b16 a[202:203], v45 offset:40960
    v_mfma_f32_16x16x32_bf16 v[240:243], v[116:119], a[96:99], v[240:243]
    ds_read_b64_tr_b16 a[204:205], v46 offset:36864
    ds_read_b64_tr_b16 a[206:207], v46 offset:40960
    s_branch verj_23
ver_21:
pad_13:
    s_cbranch_execz pad_17
    s_waitcnt lgkmcnt(15)
    v_mfma_f32_16x16x32_bf16 v[240:243], a[244:247], v[84:87], 0
    v_mfma_f32_16x16x32_bf16 v[244:247], a[244:247], v[72:75], 0
    s_waitcnt lgkmcnt(12)
    ds_read_b64_tr_b16 v[108:109], v23 offset:2568
    ds_read_b64_tr_b16 v[110:111], v23 offset:2560
    v_mfma_f32_16x16x32_bf16 v[240:243], v[112:115], v[84:87], v[240:243]
    v_mfma_f32_16x16x32_bf16 v[244:247], v[112:115], v[72:75], v[244:247]
    s_waitcnt lgkmcnt(8)
    ds_read_b64_tr_b16 v[112:113], v23 offset:72
    ds_read_b64_tr_b16 v[114:115], v23 offset:64
    v_mfma_f32_16x16x32_bf16 v[240:243], v[116:119], v[80:83], v[240:243]
    s_xor_b32 s61, s87, 2048
    buffer_load_dwordx4 a[72:75], v1, s[16:19], s61 offen offset:0 sc1
    v_mfma_f32_16x16x32_bf16 v[244:247], v[116:119], v[68:71], v[244:247]
    s_waitcnt lgkmcnt(8)
    ds_read_b64_tr_b16 v[116:117], v23 offset:584
    ds_read_b64_tr_b16 v[118:119], v23 offset:576
    v_mfma_f32_16x16x32_bf16 v[240:243], v[120:123], v[76:79], v[240:243]
    v_mfma_f32_16x16x32_bf16 v[244:247], v[120:123], v[64:67], v[244:247]
    s_waitcnt lgkmcnt(8)
    ds_read_b64_tr_b16 v[120:121], v23 offset:1096
    ds_read_b64_tr_b16 v[122:123], v23 offset:1088
    v_mfma_f32_16x16x32_bf16 v[240:243], v[124:127], v[72:75], v[240:243]
    s_waitcnt lgkmcnt(8)
    ds_read_b64_tr_b16 v[124:125], v23 offset:1608
    ds_read_b64_tr_b16 v[126:127], v23 offset:1600
    buffer_load_dwordx4 a[76:79], v1, s[16:19], s61 offen offset:1024 sc1
    v_mfma_f32_16x16x32_bf16 v[240:243], v[104:107], v[68:71], v[240:243]
    s_waitcnt lgkmcnt(8)
    ds_read_b64_tr_b16 v[104:105], v23 offset:2120
    ds_read_b64_tr_b16 v[106:107], v23 offset:2112
    v_mfma_f32_16x16x32_bf16 v[240:243], v[108:111], v[64:67], v[240:243]
    s_waitcnt lgkmcnt(8)
    ds_read_b64_tr_b16 v[108:109], v23 offset:2632
    ds_read_b64_tr_b16 v[110:111], v23 offset:2624
    v_mfma_f32_16x16x32_bf16 v[240:243], v[112:115], a[116:119], v[240:243]
    v_mfma_f32_16x16x32_bf16 v[244:247], v[112:115], a[104:107], v[244:247]
    s_waitcnt lgkmcnt(8)
    v_mfma_f32_16x16x32_bf16 v[240:243], v[116:119], a[112:115], v[240:243]
    buffer_load_dwordx4 a[80:83], v58, s[16:19], s87 offen offset:0 sc1
    v_mfma_f32_16x16x32_bf16 v[244:247], v[116:119], a[100:103], v[244:247]
    s_waitcnt lgkmcnt(6)
    v_mfma_f32_16x16x32_bf16 v[240:243], v[120:123], a[108:111], v[240:243]
    v_mfma_f32_16x16x32_bf16 v[244:247], v[120:123], a[96:99], v[244:247]
    s_waitcnt lgkmcnt(4)
    ds_read_b64_tr_b16 a[192:193], v43 offset:36864
    ds_read_b64_tr_b16 a[194:195], v43 offset:40960
    v_mfma_f32_16x16x32_bf16 v[240:243], v[124:127], a[104:107], v[240:243]
    s_waitcnt lgkmcnt(4)
    buffer_load_dwordx4 a[84:87], v58, s[16:19], s87 offen offset:1024 sc1
    ds_read_b64_tr_b16 a[196:197], v44 offset:36864
    ds_read_b64_tr_b16 a[198:199], v44 offset:40960
    v_mfma_f32_16x16x32_bf16 v[240:243], v[104:107], a[100:103], v[240:243]
    s_waitcnt lgkmcnt(4)
    ds_read_b64_tr_b16 a[200:201], v45 offset:36864
    ds_read_b64_tr_b16 a[202:203], v45 offset:40960
    v_mfma_f32_16x16x32_bf16 v[240:243], v[108:111], a[96:99], v[240:243]
    ds_read_b64_tr_b16 a[204:205], v46 offset:36864
    ds_read_b64_tr_b16 a[206:207], v46 offset:40960
    s_branch verj_23
ver_22:
pad_14:
    s_cbranch_execz pad_18
    v_mfma_f32_16x16x32_bf16 v[240:243], a[244:247], v[80:83], 0
    v_mfma_f32_16x16x32_bf16 v[244:247], a[244:247], v[76:79], 0
    s_waitcnt lgkmcnt(12)
    ds_read_b64_tr_b16 v[108:109], v23 offset:72
    ds_read_b64_tr_b16 v[110:111], v23 offset:64
    v_mfma_f32_16x16x32_bf16 v[240:243], v[112:115], v[80:83], v[240:243]
    v_mfma_f32_16x16x32_bf16 v[244:247], v[112:115], v[76:79], v[244:247]
    s_waitcnt lgkmcnt(8)
    ds_read_b64_tr_b16 v[112:113], v23 offset:584
    ds_read_b64_tr_b16 v[114:115], v23 offset:576
    v_mfma_f32_16x16x32_bf16 v[240:243], v[116:119], v[76:79], v[240:243]
    s_xor_b32 s61, s87, 2048
    buffer_load_dwordx4 a[72:75], v1, s[16:19], s61 offen offset:0 sc1
    v_mfma_f32_16x16x32_bf16 v[244:247], v[116:119], v[72:75], v[244:247]
    s_waitcnt lgkmcnt(8)
    ds_read_b64_tr_b16 v[116:117], v23 offset:1096
    ds_read_b64_tr_b16 v[118:119], v23 offset:1088
    v_mfma_f32_16x16x32_bf16 v[240:243], v[120:123], v[72:75], v[240:243]
    v_mfma_f32_16x16x32_bf16 v[244:247], v[120:123], v[68:71], v[244:247]
    s_waitcnt lgkmcnt(8)
    ds_read_b64_tr_b16 v[120:121], v23 offset:1608
    ds_read_b64_tr_b16 v[122:123], v23 offset:1600
    v_mfma_f32_16x16x32_bf16 v[240:243], v[124:127], v[68:71], v[240:243]
    buffer_load_dwordx4 a[76:79], v1, s[16:19], s61 offen offset:1024 sc1
    v_mfma_f32_16x16x32_bf16 v[244:247], v[124:127], v[64:67], v[244:247]
    s_waitcnt lgkmcnt(8)
    ds_read_b64_tr_b16 v[124:125], v23 offset:2120
    ds_read_b64_tr_b16 v[126:127], v23 offset:2112
    v_mfma_f32_16x16x32_bf16 v[240:243], v[104:107], v[64:67], v[240:243]
    s_waitcnt lgkmcnt(8)
    v_mfma_f32_16x16x32_bf16 v[240:243], v[108:111], a[112:115], v[240:243]
    v_mfma_f32_16x16x32_bf16 v[244:247], v[108:111], a[108:111], v[244:247]
    s_waitcnt lgkmcnt(6)
    v_mfma_f32_16x16x32_bf16 v[240:243], v[112:115], a[108:111], v[240:243]
    buffer_load_dwordx4 a[80:83], v58, s[16:19], s87 offen offset:0 sc1
    v_mfma_f32_16x16x32_bf16 v[244:247], v[112:115], a[104:107], v[244:247]
    s_waitcnt lgkmcnt(4)
    v_mfma_f32_16x16x32_bf16 v[240:243], v[116:119], a[104:107], v[240:243]
    v_mfma_f32_16x16x32_bf16 v[244:247], v[116:119], a[100:103], v[244:247]
    s_waitcnt lgkmcnt(2)
    ds_read_b64_tr_b16 a[192:193], v43 offset:36864
    ds_read_b64_tr_b16 a[194:195], v43 offset:40960
    v_mfma_f32_16x16x32_bf16 v[240:243], v[120:123], a[100:103], v[240:243]
    buffer_load_dwordx4 a[84:87], v58, s[16:19], s87 offen offset:1024 sc1
    ds_read_b64_tr_b16 a[196:197], v44 offset:36864
    ds_read_b64_tr_b16 a[198:199], v44 offset:40960
    v_mfma_f32_16x16x32_bf16 v[244:247], v[120:123], a[96:99], v[244:247]
    s_waitcnt lgkmcnt(4)
    ds_read_b64_tr_b16 a[200:201], v45 offset:36864
    ds_read_b64_tr_b16 a[202:203], v45 offset:40960
    v_mfma_f32_16x16x32_bf16 v[240:243], v[124:127], a[96:99], v[240:243]
    ds_read_b64_tr_b16 a[204:205], v46 offset:36864
    ds_read_b64_tr_b16 a[206:207], v46 offset:40960
verj_23:
pad_15:
    s_cbranch_execz pad_ret
    s_barrier
    v_add_u32 v12, s92, v1
    s_add_u32 s29, s23, 73728
    v_add_u32 v2, s29, v1
    ds_read_b64_tr_b16 a[208:209], v47 offset:36864
    ds_read_b64_tr_b16 a[210:211], v47 offset:40960
    s_waitcnt vmcnt(24) lgkmcnt(8)
    v_mfma_f32_16x16x32_bf16 v[64:67], a[192:195], a[0:3], 0
    s_waitcnt vmcnt(23)
    ds_read_b64_tr_b16 a[212:213], v49 offset:36864
    ds_read_b64_tr_b16 a[214:215], v49 offset:40960
    v_mfma_f32_16x16x32_bf16 v[68:71], a[192:195], a[4:7], 0
    s_waitcnt vmcnt(21)
    ds_write_b128 v2, v[144:147] offset:0
    v_mfma_f32_16x16x32_bf16 v[72:75], a[192:195], a[8:11], 0
    s_waitcnt vmcnt(20)
    buffer_load_dwordx4 a[88:91], v58, s[16:19], s61 offen offset:0 sc1
    v_mfma_f32_16x16x32_bf16 v[76:79], a[192:195], a[12:15], 0
    s_waitcnt lgkmcnt(9)
    v_xor_b32 v13, 4096, v12
    v_mfma_f32_16x16x32_bf16 v[80:83], a[196:199], a[0:3], 0
    ds_read_b64_tr_b16 a[216:217], v43 offset:46080
    ds_read_b64_tr_b16 a[218:219], v43 offset:50176
    v_mfma_f32_16x16x32_bf16 v[84:87], a[196:199], a[4:7], 0
    ds_write_b128 v2, v[148:151] offset:1024
    v_mfma_f32_16x16x32_bf16 v[88:91], a[196:199], a[8:11], 0
    buffer_load_dwordx4 a[92:95], v58, s[16:19], s61 offen offset:1024 sc1
    v_mfma_f32_16x16x32_bf16 v[92:95], a[196:199], a[12:15], 0
    s_waitcnt lgkmcnt(10)
    v_bfe_u32 v3, v0, 4, 1
    v_mfma_f32_16x16x32_bf16 v[96:99], a[200:203], a[0:3], 0
    ds_read_b64_tr_b16 a[220:221], v44 offset:46080
    ds_read_b64_tr_b16 a[222:223], v44 offset:50176
    v_mfma_f32_16x16x32_bf16 v[100:103], a[200:203], a[4:7], 0
    ds_write_b128 v2, v[152:155] offset:2048
    v_mfma_f32_16x16x32_bf16 v[104:107], a[200:203], a[8:11], 0
    s_add_u32 s87, s85, 24576
    buffer_load_dwordx4 a[128:131], v1, s[16:19], s87 offen offset:0 sc1
    v_mfma_f32_16x16x32_bf16 v[108:111], a[200:203], a[12:15], 0
    s_waitcnt lgkmcnt(11)
    v_lshlrev_b32 v14, 9, v3
    v_mfma_f32_16x16x32_bf16 v[112:115], a[204:207], a[0:3], 0
    ds_read_b64_tr_b16 a[224:225], v45 offset:46080
    ds_read_b64_tr_b16 a[226:227], v45 offset:50176
    v_mfma_f32_16x16x32_bf16 v[116:119], a[204:207], a[4:7], 0
    ds_write_b128 v2, v[156:159] offset:3072
    v_mfma_f32_16x16x32_bf16 v[120:123], a[204:207], a[8:11], 0
    buffer_load_dwordx4 a[132:135], v1, s[16:19], s87 offen offset:1024 sc1
    v_mfma_f32_16x16x32_bf16 v[124:127], a[204:207], a[12:15], 0
    s_waitcnt lgkmcnt(12)
    v_and_b32 v3, 15, v0
    v_mfma_f32_16x16x32_bf16 v[128:131], a[208:211], a[0:3], 0
    ds_read_b64_tr_b16 a[228:229], v46 offset:46080
    ds_read_b64_tr_b16 a[230:231], v46 offset:50176
    v_mfma_f32_16x16x32_bf16 v[132:135], a[208:211], a[4:7], 0
    ds_write_b128 v2, a[236:239] offset:8192
    v_mfma_f32_16x16x32_bf16 v[136:139], a[208:211], a[8:11], 0
    s_xor_b32 s61, s87, 2048
    buffer_load_dwordx4 a[136:139], v1, s[16:19], s61 offen offset:0 sc1
    v_mfma_f32_16x16x32_bf16 v[140:143], a[208:211], a[12:15], 0
    s_waitcnt lgkmcnt(13)
    v_lshl_add_u32 v14, v3, 5, v14
    v_mfma_f32_16x16x32_bf16 v[160:163], a[212:215], a[0:3], 0
    ds_read_b64_tr_b16 a[232:233], v47 offset:46080
    ds_read_b64_tr_b16 a[234:235], v47 offset:50176
    s_waitcnt vmcnt(20)
    v_mfma_f32_16x16x32_bf16 v[164:167], a[212:215], a[4:7], 0
    ds_write_b128 v2, v[176:179] offset:4096
    buffer_store_dwordx2 v[62:63], v52, s[32:35], s58 offen sc1
    v_mfma_f32_16x16x32_bf16 v[168:171], a[212:215], a[8:11], 0
    buffer_load_dwordx4 a[140:143], v1, s[16:19], s61 offen offset:1024 sc1
pad_16:
    s_cbranch_execz pad_ret
    v_mfma_f32_16x16x32_bf16 v[172:175], a[212:215], a[12:15], 0
    s_waitcnt lgkmcnt(13)
    v_lshrrev_b32 v3, 5, v0
    v_mfma_f32_16x16x32_bf16 v[64:67], a[216:219], a[16:19], v[64:67]
    ds_read_b64_tr_b16 a[236:237], v49 offset:46080
    ds_read_b64_tr_b16 a[238:239], v49 offset:50176
    v_mfma_f32_16x16x32_bf16 v[68:71], a[216:219], a[20:23], v[68:71]
    ds_write_b128 v2, v[180:183] offset:5120
    v_mfma_f32_16x16x32_bf16 v[72:75], a[216:219], a[24:27], v[72:75]
    s_waitcnt vmcnt(21)
    buffer_load_dwordx4 a[144:147], v58, s[16:19], s87 offen offset:0 sc1
    v_mfma_f32_16x16x32_bf16 v[76:79], a[216:219], a[28:31], v[76:79]
    s_waitcnt lgkmcnt(13)
    v_lshl_add_u32 v14, v3, 4, v14
    v_mfma_f32_16x16x32_bf16 v[80:83], a[220:223], a[16:19], v[80:83]
    ds_read_b64_tr_b16 a[192:193], v48 offset:36864
    ds_read_b64_tr_b16 a[194:195], v48 offset:40960
    v_mfma_f32_16x16x32_bf16 v[84:87], a[220:223], a[20:23], v[84:87]
    ds_write_b128 v2, v[184:187] offset:6144
    v_mfma_f32_16x16x32_bf16 v[88:91], a[220:223], a[24:27], v[88:91]
    s_add_u32 s60, s59, 221184
    s_add_u32 m0, s23, 0
    s_nop 0
    buffer_load_dwordx4 v32, s[40:43], s60 offen offset:0 lds
    v_mfma_f32_16x16x32_bf16 v[92:95], a[220:223], a[28:31], v[92:95]
    s_waitcnt lgkmcnt(13)
    v_mfma_f32_16x16x32_bf16 v[96:99], a[224:227], a[16:19], v[96:99]
    ds_read_b64_tr_b16 a[196:197], v50 offset:36864
    ds_read_b64_tr_b16 a[198:199], v50 offset:40960
    v_mfma_f32_16x16x32_bf16 v[100:103], a[224:227], a[20:23], v[100:103]
    ds_write_b128 v2, v[188:191] offset:7168
    v_mfma_f32_16x16x32_bf16 v[104:107], a[224:227], a[24:27], v[104:107]
    buffer_load_dwordx4 a[148:151], v58, s[16:19], s87 offen offset:1024 sc1
    v_mfma_f32_16x16x32_bf16 v[108:111], a[224:227], a[28:31], v[108:111]
    s_waitcnt lgkmcnt(13)
    v_mfma_f32_16x16x32_bf16 v[112:115], a[228:231], a[16:19], v[112:115]
    ds_read_b64_tr_b16 a[200:201], v51 offset:36864
    ds_read_b64_tr_b16 a[202:203], v51 offset:37376
    v_mfma_f32_16x16x32_bf16 v[116:119], a[228:231], a[20:23], v[116:119]
    ds_write_b128 v12, v[192:195] offset:0
    v_mfma_f32_16x16x32_bf16 v[120:123], a[228:231], a[24:27], v[120:123]
    buffer_load_dwordx4 v33, s[40:43], s60 offen offset:1024 lds
    v_mfma_f32_16x16x32_bf16 v[124:127], a[228:231], a[28:31], v[124:127]
    s_waitcnt lgkmcnt(13)
    v_mfma_f32_16x16x32_bf16 v[128:131], a[232:235], a[16:19], v[128:131]
    ds_read_b64_tr_b16 a[204:205], v48 offset:46080
    ds_read_b64_tr_b16 a[206:207], v48 offset:50176
    v_mfma_f32_16x16x32_bf16 v[132:135], a[232:235], a[20:23], v[132:135]
    ds_write_b128 v12, v[196:199] offset:1024
    v_mfma_f32_16x16x32_bf16 v[136:139], a[232:235], a[24:27], v[136:139]
    buffer_load_dwordx4 a[152:155], v58, s[16:19], s61 offen offset:0 sc1
    v_mfma_f32_16x16x32_bf16 v[140:143], a[232:235], a[28:31], v[140:143]
    s_waitcnt lgkmcnt(13)
    v_mfma_f32_16x16x32_bf16 v[160:163], a[236:239], a[16:19], v[160:163]
    ds_read_b64_tr_b16 a[208:209], v50 offset:46080
    ds_read_b64_tr_b16 a[210:211], v50 offset:50176
    v_mfma_f32_16x16x32_bf16 v[164:167], a[236:239], a[20:23], v[164:167]
    ds_write_b128 v12, v[200:203] offset:2048
    v_mfma_f32_16x16x32_bf16 v[168:171], a[236:239], a[24:27], v[168:171]
    buffer_load_dwordx4 v34, s[40:43], s60 offen offset:2048 lds
    v_mfma_f32_16x16x32_bf16 v[172:175], a[236:239], a[28:31], v[172:175]
    s_waitcnt lgkmcnt(13)
    v_mfma_f32_16x16x32_bf16 v[144:147], a[192:195], a[0:3], 0
    ds_read_b64_tr_b16 a[212:213], v51 offset:46080
    ds_read_b64_tr_b16 a[214:215], v51 offset:46592
    v_mfma_f32_16x16x32_bf16 v[148:151], a[192:195], a[4:7], 0
    ds_write_b128 v12, v[204:207] offset:3072
    v_mfma_f32_16x16x32_bf16 v[152:155], a[192:195], a[8:11], 0
    buffer_load_dwordx4 a[156:159], v58, s[16:19], s61 offen offset:1024 sc1
    v_mfma_f32_16x16x32_bf16 v[156:159], a[192:195], a[12:15], 0
    s_waitcnt lgkmcnt(13)
    v_mfma_f32_16x16x32_bf16 v[176:179], a[196:199], a[0:3], 0
    buffer_load_dwordx4 v35, s[40:43], s60 offen offset:3072 lds
    v_mfma_f32_16x16x32_bf16 v[180:183], a[196:199], a[4:7], 0
    s_add_u32 m0, s23, 4096
    v_mfma_f32_16x16x32_bf16 v[184:187], a[196:199], a[8:11], 0
    v_mfma_f32_16x16x32_bf16 v[188:191], a[196:199], a[12:15], 0
    s_waitcnt lgkmcnt(10)
    s_waitcnt lgkmcnt(0)
    s_barrier
    v_mfma_f32_16x16x32_bf16 v[192:195], a[200:203], a[0:3], 0
    ds_read_b64_tr_b16 a[216:217], v8 offset:36864
    ds_read_b64_tr_b16 a[218:219], v8 offset:40960
    v_mfma_f32_16x16x32_bf16 v[196:199], a[200:203], a[4:7], 0
    ds_read_b64_tr_b16 a[220:221], v9 offset:36864
    ds_read_b128 v[224:227], v13 offset:0
    v_mfma_f32_16x16x32_bf16 v[200:203], a[200:203], a[8:11], 0
    ds_read_b64_tr_b16 a[222:223], v9 offset:40960
    ds_read_b128 v[228:231], v13 offset:1024
    v_mfma_f32_16x16x32_bf16 v[204:207], a[200:203], a[12:15], 0
    ds_read_b128 v[232:235], v13 offset:2048
    ds_read_b128 v[236:239], v13 offset:3072
    s_waitcnt lgkmcnt(4)
    v_mfma_f32_16x16x32_bf16 v[144:147], a[204:207], a[16:19], v[144:147]
    ds_read_b64_tr_b16 a[224:225], v10 offset:36864
    ds_read_b64_tr_b16 a[226:227], v10 offset:40960
    v_mfma_f32_16x16x32_bf16 v[148:151], a[204:207], a[20:23], v[148:151]
    buffer_load_dwordx4 v36, s[40:43], s60 offen offset:0 lds
    v_mfma_f32_16x16x32_bf16 v[152:155], a[204:207], a[24:27], v[152:155]
    v_add_f32 v208, v208, v224
    v_mfma_f32_16x16x32_bf16 v[156:159], a[204:207], a[28:31], v[156:159]
    v_add_f32 v209, v209, v225
    v_mfma_f32_16x16x32_bf16 v[176:179], a[208:211], a[16:19], v[176:179]
    ds_read_b64_tr_b16 a[228:229], v11 offset:36864
    ds_read_b64_tr_b16 a[230:231], v11 offset:40960
    v_mfma_f32_16x16x32_bf16 v[180:183], a[208:211], a[20:23], v[180:183]
    v_add_f32 v210, v210, v226
    v_mfma_f32_16x16x32_bf16 v[184:187], a[208:211], a[24:27], v[184:187]
    v_add_f32 v211, v211, v227
    v_mfma_f32_16x16x32_bf16 v[188:191], a[208:211], a[28:31], v[188:191]
    v_cvt_pk_bf16_f32 v248, v208, v209
    v_mfma_f32_16x16x32_bf16 v[192:195], a[212:215], a[16:19], v[192:195]
    ds_read_b64_tr_b16 a[232:233], v25 offset:36864
    ds_read_b64_tr_b16 a[234:235], v25 offset:40960
    v_mfma_f32_16x16x32_bf16 v[196:199], a[212:215], a[20:23], v[196:199]
    buffer_load_dwordx4 v37, s[40:43], s60 offen offset:1024 lds
    v_mfma_f32_16x16x32_bf16 v[200:203], a[212:215], a[24:27], v[200:203]
    v_cvt_pk_bf16_f32 v249, v210, v211
    v_mfma_f32_16x16x32_bf16 v[204:207], a[212:215], a[28:31], v[204:207]
    s_waitcnt vmcnt(30)
    s_waitcnt lgkmcnt(8)
    v_add_f32 v212, v212, v228
    v_mfma_f32_16x16x32_bf16 v[64:67], a[216:219], a[32:35], v[64:67]
    s_waitcnt vmcnt(29)
    ds_read_b64_tr_b16 a[236:237], v26 offset:36864
    ds_read_b64_tr_b16 a[238:239], v26 offset:40960
    v_mfma_f32_16x16x32_bf16 v[68:71], a[216:219], a[36:39], v[68:71]
    s_waitcnt vmcnt(28)
    v_add_f32 v213, v213, v229
    v_mfma_f32_16x16x32_bf16 v[72:75], a[216:219], a[40:43], v[72:75]
    s_waitcnt vmcnt(27)
    v_add_f32 v214, v214, v230
    v_mfma_f32_16x16x32_bf16 v[76:79], a[216:219], a[44:47], v[76:79]
    v_add_f32 v215, v215, v231
    v_mfma_f32_16x16x32_bf16 v[80:83], a[220:223], a[32:35], v[80:83]
    ds_read_b64_tr_b16 a[192:193], v27 offset:36864
    ds_read_b64_tr_b16 a[194:195], v27 offset:40960
    v_mfma_f32_16x16x32_bf16 v[84:87], a[220:223], a[36:39], v[84:87]
    buffer_load_dwordx4 v38, s[40:43], s60 offen offset:2048 lds
    v_mfma_f32_16x16x32_bf16 v[88:91], a[220:223], a[40:43], v[88:91]
    v_cvt_pk_bf16_f32 v250, v212, v213
    v_mfma_f32_16x16x32_bf16 v[92:95], a[220:223], a[44:47], v[92:95]
    s_waitcnt lgkmcnt(8)
    v_cvt_pk_bf16_f32 v251, v214, v215
    s_barrier
    v_mfma_f32_16x16x32_bf16 v[96:99], a[224:227], a[32:35], v[96:99]
    ds_read_b64_tr_b16 a[196:197], v41 offset:36864
    ds_read_b64_tr_b16 a[198:199], v41 offset:40960
    v_mfma_f32_16x16x32_bf16 v[100:103], a[224:227], a[36:39], v[100:103]
    ds_write_b128 v12, v[240:243]
    v_mfma_f32_16x16x32_bf16 v[104:107], a[224:227], a[40:43], v[104:107]
    ds_write_b128 v12, v[244:247] offset:1024
    v_mfma_f32_16x16x32_bf16 v[108:111], a[224:227], a[44:47], v[108:111]
    s_waitcnt lgkmcnt(10)
    v_permlane16_swap_b32 v248, v250
    v_mfma_f32_16x16x32_bf16 v[112:115], a[228:231], a[32:35], v[112:115]
    ds_read_b64_tr_b16 a[200:201], v42 offset:36864
    ds_read_b64_tr_b16 a[202:203], v42 offset:37376
    v_mfma_f32_16x16x32_bf16 v[116:119], a[228:231], a[36:39], v[116:119]
    buffer_load_dwordx4 v39, s[40:43], s60 offen offset:3072 lds
    v_mfma_f32_16x16x32_bf16 v[120:123], a[228:231], a[40:43], v[120:123]
    s_add_u32 m0, s23, 8192
    v_permlane16_swap_b32 v249, v251
    v_mfma_f32_16x16x32_bf16 v[124:127], a[228:231], a[44:47], v[124:127]
    s_waitcnt lgkmcnt(10)
    buffer_store_dwordx4 v[248:251], v14, s[32:35], s93 offen offset:0 sc1
    v_mfma_f32_16x16x32_bf16 v[128:131], a[232:235], a[32:35], v[128:131]
    ds_read_b64_tr_b16 a[204:205], v8 offset:46080
    ds_read_b64_tr_b16 a[206:207], v8 offset:50176
    v_mfma_f32_16x16x32_bf16 v[132:135], a[232:235], a[36:39], v[132:135]
    v_add_f32 v216, v216, v232
    v_mfma_f32_16x16x32_bf16 v[136:139], a[232:235], a[40:43], v[136:139]
    v_add_f32 v217, v217, v233
    v_mfma_f32_16x16x32_bf16 v[140:143], a[232:235], a[44:47], v[140:143]
    s_waitcnt lgkmcnt(10)
    v_add_f32 v218, v218, v234
    v_mfma_f32_16x16x32_bf16 v[144:147], a[236:239], a[32:35], v[144:147]
    ds_read_b64_tr_b16 a[208:209], v9 offset:46080
    ds_read_b64_tr_b16 a[210:211], v9 offset:50176
    v_mfma_f32_16x16x32_bf16 v[148:151], a[236:239], a[36:39], v[148:151]
    s_add_u32 s60, s3, 6144
    buffer_load_dwordx4 v1, s[16:19], s60 offen lds
    v_mfma_f32_16x16x32_bf16 v[152:155], a[236:239], a[40:43], v[152:155]
    s_add_u32 m0, s23, 110592
    v_add_f32 v219, v219, v235
    v_mfma_f32_16x16x32_bf16 v[156:159], a[236:239], a[44:47], v[156:159]
    s_waitcnt lgkmcnt(10)
    v_cvt_pk_bf16_f32 v252, v216, v217
    v_mfma_f32_16x16x32_bf16 v[160:163], a[192:195], a[32:35], v[160:163]
    ds_read_b64_tr_b16 a[212:213], v10 offset:46080
    ds_read_b64_tr_b16 a[214:215], v10 offset:50176
    v_mfma_f32_16x16x32_bf16 v[164:167], a[192:195], a[36:39], v[164:167]
    s_add_u32 s60, s59, 73728
    buffer_load_dwordx4 v32, s[40:43], s60 offen offset:0 lds
    v_mfma_f32_16x16x32_bf16 v[168:171], a[192:195], a[40:43], v[168:171]
    v_cvt_pk_bf16_f32 v253, v218, v219
    v_mfma_f32_16x16x32_bf16 v[172:175], a[192:195], a[44:47], v[172:175]
    s_waitcnt lgkmcnt(10)
    v_add_f32 v220, v220, v236
    v_mfma_f32_16x16x32_bf16 v[176:179], a[196:199], a[32:35], v[176:179]
    ds_read_b64_tr_b16 a[216:217], v11 offset:46080
    ds_read_b64_tr_b16 a[218:219], v11 offset:50176
    v_mfma_f32_16x16x32_bf16 v[180:183], a[196:199], a[36:39], v[180:183]
    buffer_load_dwordx4 v33, s[40:43], s60 offen offset:1024 lds
    v_mfma_f32_16x16x32_bf16 v[184:187], a[196:199], a[40:43], v[184:187]
    v_add_f32 v221, v221, v237
    v_mfma_f32_16x16x32_bf16 v[188:191], a[196:199], a[44:47], v[188:191]
    s_waitcnt lgkmcnt(8)
    v_add_f32 v222, v222, v238
    v_mfma_f32_16x16x32_bf16 v[192:195], a[200:203], a[32:35], v[192:195]
    ds_read_b64_tr_b16 a[220:221], v25 offset:46080
    ds_read_b64_tr_b16 a[222:223], v25 offset:50176
    v_mfma_f32_16x16x32_bf16 v[196:199], a[200:203], a[36:39], v[196:199]
    buffer_load_dwordx4 v34, s[40:43], s60 offen offset:2048 lds
    v_mfma_f32_16x16x32_bf16 v[200:203], a[200:203], a[40:43], v[200:203]
    v_add_f32 v223, v223, v239
    v_mfma_f32_16x16x32_bf16 v[204:207], a[200:203], a[44:47], v[204:207]
    s_waitcnt vmcnt(33) lgkmcnt(8)
    v_cvt_pk_bf16_f32 v254, v220, v221
    v_mfma_f32_16x16x32_bf16 v[64:67], a[204:207], a[48:51], v[64:67]
    s_waitcnt vmcnt(32)
    ds_read_b64_tr_b16 a[224:225], v26 offset:46080
    ds_read_b64_tr_b16 a[226:227], v26 offset:50176
    v_mfma_f32_16x16x32_bf16 v[68:71], a[204:207], a[52:55], v[68:71]
    s_waitcnt vmcnt(31)
    buffer_load_dwordx4 v35, s[40:43], s60 offen offset:3072 lds
    v_mfma_f32_16x16x32_bf16 v[72:75], a[204:207], a[56:59], v[72:75]
    s_waitcnt vmcnt(31)
    s_add_u32 m0, s23, 114688
    v_cvt_pk_bf16_f32 v255, v222, v223
    v_mfma_f32_16x16x32_bf16 v[76:79], a[204:207], a[60:63], v[76:79]
    s_waitcnt lgkmcnt(8)
    v_permlane16_swap_b32 v252, v254
    v_mfma_f32_16x16x32_bf16 v[80:83], a[208:211], a[48:51], v[80:83]
    ds_read_b64_tr_b16 a[228:229], v27 offset:46080
    ds_read_b64_tr_b16 a[230:231], v27 offset:50176
    v_mfma_f32_16x16x32_bf16 v[84:87], a[208:211], a[52:55], v[84:87]
    buffer_load_dwordx4 v36, s[40:43], s60 offen offset:0 lds
    v_mfma_f32_16x16x32_bf16 v[88:91], a[208:211], a[56:59], v[88:91]
    s_add_u32 s86, s86, 0x60000
    buffer_load_dwordx2 v[54:55], v61, s[32:35], s86 offen sc1
    v_mfma_f32_16x16x32_bf16 v[92:95], a[208:211], a[60:63], v[92:95]
    s_waitcnt lgkmcnt(8)
    v_permlane16_swap_b32 v253, v255
    v_mfma_f32_16x16x32_bf16 v[96:99], a[212:215], a[48:51], v[96:99]
    ds_read_b64_tr_b16 a[232:233], v41 offset:46080
    ds_read_b64_tr_b16 a[234:235], v41 offset:50176
    v_mfma_f32_16x16x32_bf16 v[100:103], a[212:215], a[52:55], v[100:103]
    buffer_load_dwordx4 v37, s[40:43], s60 offen offset:1024 lds
    buffer_store_dwordx4 v[252:255], v14, s[32:35], s93 offen offset:1024 sc1
    v_mfma_f32_16x16x32_bf16 v[104:107], a[212:215], a[56:59], v[104:107]
    s_lshl_b32 s29, s62, 10
    v_mfma_f32_16x16x32_bf16 v[108:111], a[212:215], a[60:63], v[108:111]
    s_waitcnt lgkmcnt(8)
    s_add_u32 s29, s29, 147456
    v_add_u32 v13, s29, v1
    v_mfma_f32_16x16x32_bf16 v[112:115], a[216:219], a[48:51], v[112:115]
    ds_read_b64_tr_b16 a[236:237], v42 offset:46080
    ds_read_b64_tr_b16 a[238:239], v42 offset:46592
    v_mfma_f32_16x16x32_bf16 v[116:119], a[216:219], a[52:55], v[116:119]
    buffer_load_dwordx4 v38, s[40:43], s60 offen offset:2048 lds
    v_mfma_f32_16x16x32_bf16 v[120:123], a[216:219], a[56:59], v[120:123]
    v_and_b32 v3, 15, v0
    v_mfma_f32_16x16x32_bf16 v[124:127], a[216:219], a[60:63], v[124:127]
    s_waitcnt lgkmcnt(8)
    v_lshlrev_b32 v14, 5, v3
    v_mfma_f32_16x16x32_bf16 v[128:131], a[220:223], a[48:51], v[128:131]
    buffer_load_dwordx4 v39, s[40:43], s60 offen offset:3072 lds
    v_mfma_f32_16x16x32_bf16 v[132:135], a[220:223], a[52:55], v[132:135]
    s_add_u32 m0, s23, 118784
    v_lshrrev_b32 v3, 4, v0
    v_mfma_f32_16x16x32_bf16 v[136:139], a[220:223], a[56:59], v[136:139]
    v_lshl_add_u32 v14, v3, 3, v14
    v_mfma_f32_16x16x32_bf16 v[140:143], a[220:223], a[60:63], v[140:143]
    s_waitcnt lgkmcnt(6)
    s_waitcnt lgkmcnt(0)
    s_barrier
    v_mfma_f32_16x16x32_bf16 v[144:147], a[224:227], a[48:51], v[144:147]
    ds_read_b64_tr_b16 a[192:193], v43 offset:0
    ds_read_b64_tr_b16 a[194:195], v43 offset:4096
    v_mfma_f32_16x16x32_bf16 v[148:151], a[224:227], a[52:55], v[148:151]
    ds_read_b64_tr_b16 a[196:197], v44 offset:0
    ds_read_b128 v[224:227], v13 offset:0
    v_mfma_f32_16x16x32_bf16 v[152:155], a[224:227], a[56:59], v[152:155]
    ds_read_b64_tr_b16 a[198:199], v44 offset:4096
    ds_read_b128 v[228:231], v13 offset:4096
    v_mfma_f32_16x16x32_bf16 v[156:159], a[224:227], a[60:63], v[156:159]
    ds_read_b128 v[232:235], v13 offset:8192
    ds_read_b128 v[236:239], v13 offset:12288
    s_waitcnt lgkmcnt(2)
    v_mfma_f32_16x16x32_bf16 v[160:163], a[228:231], a[48:51], v[160:163]
    ds_read_b64_tr_b16 a[200:201], v45 offset:0
    ds_read_b64_tr_b16 a[202:203], v45 offset:4096
    v_mfma_f32_16x16x32_bf16 v[164:167], a[228:231], a[52:55], v[164:167]
    s_add_u32 s60, s3, 2048
    buffer_load_dwordx4 v1, s[16:19], s60 offen lds
    v_mfma_f32_16x16x32_bf16 v[168:171], a[228:231], a[56:59], v[168:171]
    s_add_u32 m0, s23, 36864
    v_add_f32 v224, v224, v228
    v_mfma_f32_16x16x32_bf16 v[172:175], a[228:231], a[60:63], v[172:175]
    v_add_f32 v225, v225, v229
    v_mfma_f32_16x16x32_bf16 v[176:179], a[232:235], a[48:51], v[176:179]
    ds_read_b64_tr_b16 a[204:205], v46 offset:0
    ds_read_b64_tr_b16 a[206:207], v46 offset:4096
    v_mfma_f32_16x16x32_bf16 v[180:183], a[232:235], a[52:55], v[180:183]
    s_add_u32 s60, s59, 258048
    buffer_load_dwordx4 v32, s[40:43], s60 offen offset:0 lds
    v_mfma_f32_16x16x32_bf16 v[184:187], a[232:235], a[56:59], v[184:187]
    v_add_f32 v226, v226, v230
    v_mfma_f32_16x16x32_bf16 v[188:191], a[232:235], a[60:63], v[188:191]
    v_add_f32 v227, v227, v231
    v_mfma_f32_16x16x32_bf16 v[192:195], a[236:239], a[48:51], v[192:195]
    ds_read_b64_tr_b16 a[208:209], v47 offset:0
    ds_read_b64_tr_b16 a[210:211], v47 offset:4096
    s_waitcnt lgkmcnt(6)
    v_mfma_f32_16x16x32_bf16 v[196:199], a[236:239], a[52:55], v[196:199]
    buffer_load_dwordx4 v33, s[40:43], s60 offen offset:1024 lds
    v_mfma_f32_16x16x32_bf16 v[200:203], a[236:239], a[56:59], v[200:203]
    v_add_f32 v232, v232, v236
    v_mfma_f32_16x16x32_bf16 v[204:207], a[236:239], a[60:63], v[204:207]
    s_waitcnt vmcnt(39)
    v_add_f32 v233, v233, v237
    v_mfma_f32_16x16x32_bf16 v[64:67], a[192:195], a[64:67], v[64:67]
    s_waitcnt vmcnt(38)
    ds_read_b64_tr_b16 a[212:213], v48 offset:0
    ds_read_b64_tr_b16 a[214:215], v48 offset:4096
    v_mfma_f32_16x16x32_bf16 v[68:71], a[192:195], a[68:71], v[68:71]
    s_waitcnt vmcnt(37)
    buffer_load_dwordx4 v34, s[40:43], s60 offen offset:2048 lds
    v_mfma_f32_16x16x32_bf16 v[72:75], a[192:195], a[72:75], v[72:75]
    s_waitcnt vmcnt(37)
    v_add_f32 v234, v234, v238
    v_mfma_f32_16x16x32_bf16 v[76:79], a[192:195], a[76:79], v[76:79]
    v_add_f32 v235, v235, v239
    v_mfma_f32_16x16x32_bf16 v[80:83], a[196:199], a[64:67], v[80:83]
    ds_read_b64_tr_b16 a[216:217], v49 offset:0
    ds_read_b64_tr_b16 a[218:219], v49 offset:4096
    v_mfma_f32_16x16x32_bf16 v[84:87], a[196:199], a[68:71], v[84:87]
    buffer_load_dwordx4 v35, s[40:43], s60 offen offset:3072 lds
    v_mfma_f32_16x16x32_bf16 v[88:91], a[196:199], a[72:75], v[88:91]
    s_add_u32 m0, s23, 40960
    v_add_f32 v224, v224, v232
    v_mfma_f32_16x16x32_bf16 v[92:95], a[196:199], a[76:79], v[92:95]
    s_waitcnt lgkmcnt(8)
    v_add_f32 v225, v225, v233
    v_mfma_f32_16x16x32_bf16 v[96:99], a[200:203], a[64:67], v[96:99]
    ds_read_b64_tr_b16 a[220:221], v50 offset:0
    ds_read_b64_tr_b16 a[222:223], v50 offset:4096
    v_mfma_f32_16x16x32_bf16 v[100:103], a[200:203], a[68:71], v[100:103]
    buffer_load_dwordx4 v36, s[40:43], s60 offen offset:0 lds
    v_mfma_f32_16x16x32_bf16 v[104:107], a[200:203], a[72:75], v[104:107]
    v_add_f32 v226, v226, v234
    v_mfma_f32_16x16x32_bf16 v[108:111], a[200:203], a[76:79], v[108:111]
    s_waitcnt lgkmcnt(8)
    v_add_f32 v227, v227, v235
    v_mfma_f32_16x16x32_bf16 v[112:115], a[204:207], a[64:67], v[112:115]
    ds_read_b64_tr_b16 a[224:225], v51 offset:0
    ds_read_b64_tr_b16 a[226:227], v51 offset:512
    v_mfma_f32_16x16x32_bf16 v[116:119], a[204:207], a[68:71], v[116:119]
    buffer_load_dwordx4 v37, s[40:43], s60 offen offset:1024 lds
    v_mfma_f32_16x16x32_bf16 v[120:123], a[204:207], a[72:75], v[120:123]
    s_waitcnt vmcnt(11)
    v_cmp_ne_u64 vcc, v[62:63], v[54:55]
    s_nop 0
    s_cbranch_vccnz fbs_24
fbr_25:
    v_mfma_f32_16x16x32_bf16 v[124:127], a[204:207], a[76:79], v[124:127]
    s_waitcnt lgkmcnt(8)
    v_cvt_pk_bf16_f32 v248, v224, v225
    v_mfma_f32_16x16x32_bf16 v[128:131], a[208:211], a[64:67], v[128:131]
    ds_read_b64_tr_b16 a[228:229], v43 offset:9216
    ds_read_b64_tr_b16 a[230:231], v43 offset:13312
    v_mfma_f32_16x16x32_bf16 v[132:135], a[208:211], a[68:71], v[132:135]
    s_add_u32 s87, s85, 8192
    buffer_load_dwordx4 a[0:3], v1, s[16:19], s87 offen offset:0 sc1
    v_mfma_f32_16x16x32_bf16 v[136:139], a[208:211], a[72:75], v[136:139]
    v_cvt_pk_bf16_f32 v249, v226, v227
    v_mfma_f32_16x16x32_bf16 v[140:143], a[208:211], a[76:79], v[140:143]
    s_waitcnt lgkmcnt(8)
    buffer_store_dwordx2 v[248:249], v14, s[32:35], s56 offen sc1
    v_mfma_f32_16x16x32_bf16 v[144:147], a[212:215], a[64:67], v[144:147]
    ds_read_b64_tr_b16 a[232:233], v44 offset:9216
    ds_read_b64_tr_b16 a[234:235], v44 offset:13312
    v_mfma_f32_16x16x32_bf16 v[148:151], a[212:215], a[68:71], v[148:151]
    buffer_load_dwordx4 a[4:7], v1, s[16:19], s87 offen offset:1024 sc1
    v_mfma_f32_16x16x32_bf16 v[152:155], a[212:215], a[72:75], v[152:155]
    v_bfe_i32 v3, v0, 4, 1
    v_mfma_f32_16x16x32_bf16 v[156:159], a[212:215], a[76:79], v[156:159]
    s_waitcnt lgkmcnt(8)
    s_sub_u32 s95, s95, s94
    v_and_b32 v224, s95, v3
    v_mfma_f32_16x16x32_bf16 v[160:163], a[216:219], a[64:67], v[160:163]
    ds_read_b64_tr_b16 a[236:237], v45 offset:9216
    ds_read_b64_tr_b16 a[238:239], v45 offset:13312
    v_mfma_f32_16x16x32_bf16 v[164:167], a[216:219], a[68:71], v[164:167]
    s_xor_b32 s61, s87, 2048
    buffer_load_dwordx4 a[8:11], v1, s[16:19], s61 offen offset:0 sc1
    v_mfma_f32_16x16x32_bf16 v[168:171], a[216:219], a[72:75], v[168:171]
    v_add_u32 v224, s94, v224
    v_mfma_f32_16x16x32_bf16 v[172:175], a[216:219], a[76:79], v[172:175]
    s_waitcnt lgkmcnt(8)
    v_and_b32 v3, 15, v0
    v_mfma_f32_16x16x32_bf16 v[176:179], a[220:223], a[64:67], v[176:179]
    ds_read_b64_tr_b16 a[192:193], v46 offset:9216
    ds_read_b64_tr_b16 a[194:195], v46 offset:13312
    v_mfma_f32_16x16x32_bf16 v[180:183], a[220:223], a[68:71], v[180:183]
    buffer_load_dwordx4 a[12:15], v1, s[16:19], s61 offen offset:1024 sc1
    v_mfma_f32_16x16x32_bf16 v[184:187], a[220:223], a[72:75], v[184:187]
    v_lshl_add_u32 v224, v3, 3, v224
    v_mfma_f32_16x16x32_bf16 v[188:191], a[220:223], a[76:79], v[188:191]
    s_waitcnt lgkmcnt(8)
    v_mfma_f32_16x16x32_bf16 v[192:195], a[224:227], a[64:67], v[192:195]
    ds_read_b64_tr_b16 a[196:197], v47 offset:9216
    ds_read_b64_tr_b16 a[198:199], v47 offset:13312
    v_mfma_f32_16x16x32_bf16 v[196:199], a[224:227], a[68:71], v[196:199]
    buffer_load_dwordx4 a[16:19], v58, s[16:19], s87 offen offset:0 sc1
    v_mfma_f32_16x16x32_bf16 v[200:203], a[224:227], a[72:75], v[200:203]
    v_mfma_f32_16x16x32_bf16 v[204:207], a[224:227], a[76:79], v[204:207]
    s_waitcnt lgkmcnt(8)
    v_mfma_f32_16x16x32_bf16 v[64:67], a[228:231], a[80:83], v[64:67]
    ds_read_b64_tr_b16 a[200:201], v48 offset:9216
    ds_read_b64_tr_b16 a[202:203], v48 offset:13312
    v_mfma_f32_16x16x32_bf16 v[68:71], a[228:231], a[84:87], v[68:71]
    buffer_load_dwordx4 a[20:23], v58, s[16:19], s87 offen offset:1024 sc1
    v_mfma_f32_16x16x32_bf16 v[72:75], a[228:231], a[88:91], v[72:75]
    v_mfma_f32_16x16x32_bf16 v[76:79], a[228:231], a[92:95], v[76:79]
    s_waitcnt lgkmcnt(8)
    v_mfma_f32_16x16x32_bf16 v[80:83], a[232:235], a[80:83], v[80:83]
    ds_read_b64_tr_b16 a[204:205], v49 offset:9216
    ds_read_b64_tr_b16 a[206:207], v49 offset:13312
    v_mfma_f32_16x16x32_bf16 v[84:87], a[232:235], a[84:87], v[84:87]
    buffer_load_dwordx4 a[24:27], v58, s[16:19], s61 offen offset:0 sc1
    v_mfma_f32_16x16x32_bf16 v[88:91], a[232:235], a[88:91], v[88:91]
    v_mfma_f32_16x16x32_bf16 v[92:95], a[232:235], a[92:95], v[92:95]
    s_waitcnt lgkmcnt(8)
    v_mfma_f32_16x16x32_bf16 v[96:99], a[236:239], a[80:83], v[96:99]
    ds_read_b64_tr_b16 a[208:209], v50 offset:9216
    ds_read_b64_tr_b16 a[210:211], v50 offset:13312
    v_mfma_f32_16x16x32_bf16 v[100:103], a[236:239], a[84:87], v[100:103]
    buffer_load_dwordx4 a[28:31], v58, s[16:19], s61 offen offset:1024 sc1
    v_mfma_f32_16x16x32_bf16 v[104:107], a[236:239], a[88:91], v[104:107]
    v_mfma_f32_16x16x32_bf16 v[108:111], a[236:239], a[92:95], v[108:111]
    s_waitcnt lgkmcnt(8)
    v_mfma_f32_16x16x32_bf16 v[112:115], a[192:195], a[80:83], v[112:115]
    ds_read_b64_tr_b16 a[212:213], v51 offset:9216
    ds_read_b64_tr_b16 a[214:215], v51 offset:9728
    v_mfma_f32_16x16x32_bf16 v[116:119], a[192:195], a[84:87], v[116:119]
    buffer_load_dwordx4 v38, s[40:43], s60 offen offset:2048 lds
    v_mfma_f32_16x16x32_bf16 v[120:123], a[192:195], a[88:91], v[120:123]
    v_mfma_f32_16x16x32_bf16 v[124:127], a[192:195], a[92:95], v[124:127]
    s_waitcnt lgkmcnt(8)
    v_mfma_f32_16x16x32_bf16 v[128:131], a[196:199], a[80:83], v[128:131]
    buffer_load_dwordx4 v39, s[40:43], s60 offen offset:3072 lds
    v_mfma_f32_16x16x32_bf16 v[132:135], a[196:199], a[84:87], v[132:135]
    s_add_u32 m0, s23, 45056
    v_mfma_f32_16x16x32_bf16 v[136:139], a[196:199], a[88:91], v[136:139]
    v_mfma_f32_16x16x32_bf16 v[140:143], a[196:199], a[92:95], v[140:143]
    s_waitcnt lgkmcnt(6)
    s_waitcnt lgkmcnt(0)
    s_barrier
    v_mfma_f32_16x16x32_bf16 v[144:147], a[200:203], a[80:83], v[144:147]
    ds_read_b64_tr_b16 a[216:217], v8 offset:0
    ds_read_b64_tr_b16 a[218:219], v8 offset:4096
    v_mfma_f32_16x16x32_bf16 v[148:151], a[200:203], a[84:87], v[148:151]
    ds_read_b64_tr_b16 a[220:221], v9 offset:0
    v_mfma_f32_16x16x32_bf16 v[152:155], a[200:203], a[88:91], v[152:155]
    ds_read_b64_tr_b16 a[222:223], v9 offset:4096
    v_mfma_f32_16x16x32_bf16 v[156:159], a[200:203], a[92:95], v[156:159]
    s_add_u32 s60, s3, 7168
    buffer_load_dwordx4 v1, s[16:19], s60 offen lds
    v_mfma_f32_16x16x32_bf16 v[160:163], a[204:207], a[80:83], v[160:163]
    s_add_u32 m0, s23, 73728
    ds_read_b64_tr_b16 a[224:225], v10 offset:0
    ds_read_b64_tr_b16 a[226:227], v10 offset:4096
    v_mfma_f32_16x16x32_bf16 v[164:167], a[204:207], a[84:87], v[164:167]
    s_add_u32 s87, s85, 28672
    buffer_load_dwordx4 a[32:35], v1, s[16:19], s87 offen offset:0 sc1
    v_mfma_f32_16x16x32_bf16 v[168:171], a[204:207], a[88:91], v[168:171]
    v_mfma_f32_16x16x32_bf16 v[172:175], a[204:207], a[92:95], v[172:175]
    v_mfma_f32_16x16x32_bf16 v[176:179], a[208:211], a[80:83], v[176:179]
    ds_read_b64_tr_b16 a[228:229], v11 offset:0
    ds_read_b64_tr_b16 a[230:231], v11 offset:4096
    v_mfma_f32_16x16x32_bf16 v[180:183], a[208:211], a[84:87], v[180:183]
    buffer_load_dwordx4 a[36:39], v1, s[16:19], s87 offen offset:1024 sc1
    v_mfma_f32_16x16x32_bf16 v[184:187], a[208:211], a[88:91], v[184:187]
    v_mfma_f32_16x16x32_bf16 v[188:191], a[208:211], a[92:95], v[188:191]
    v_mfma_f32_16x16x32_bf16 v[192:195], a[212:215], a[80:83], v[192:195]
    ds_read_b64_tr_b16 a[232:233], v25 offset:0
    ds_read_b64_tr_b16 a[234:235], v25 offset:4096
    v_mfma_f32_16x16x32_bf16 v[196:199], a[212:215], a[84:87], v[196:199]
    s_xor_b32 s61, s87, 2048
    buffer_load_dwordx4 a[40:43], v1, s[16:19], s61 offen offset:0 sc1
    v_mfma_f32_16x16x32_bf16 v[200:203], a[212:215], a[88:91], v[200:203]
    v_mfma_f32_16x16x32_bf16 v[204:207], a[212:215], a[92:95], v[204:207]
    s_waitcnt lgkmcnt(8)
    v_mfma_f32_16x16x32_bf16 v[64:67], a[216:219], a[128:131], v[64:67]
    ds_read_b64_tr_b16 a[236:237], v26 offset:0
    ds_read_b64_tr_b16 a[238:239], v26 offset:4096
    s_waitcnt vmcnt(13)
    v_mfma_f32_16x16x32_bf16 v[68:71], a[216:219], a[132:135], v[68:71]
    buffer_load_dwordx4 a[44:47], v1, s[16:19], s61 offen offset:1024 sc1
    buffer_store_dwordx2 v[62:63], v224, s[32:35], 0 offen sc1
    v_mfma_f32_16x16x32_bf16 v[72:75], a[216:219], a[136:139], v[72:75]
    v_mfma_f32_16x16x32_bf16 v[76:79], a[216:219], a[140:143], v[76:79]
    s_waitcnt lgkmcnt(8)
    v_mfma_f32_16x16x32_bf16 v[80:83], a[220:223], a[128:131], v[80:83]
    ds_read_b64_tr_b16 a[192:193], v27 offset:0
    ds_read_b64_tr_b16 a[194:195], v27 offset:4096
    v_mfma_f32_16x16x32_bf16 v[84:87], a[220:223], a[132:135], v[84:87]
    s_add_u32 s60, s59, 110592
    buffer_load_dwordx4 v32, s[40:43], s60 offen offset:0 lds
    v_mfma_f32_16x16x32_bf16 v[88:91], a[220:223], a[136:139], v[88:91]
    v_mfma_f32_16x16x32_bf16 v[92:95], a[220:223], a[140:143], v[92:95]
    s_waitcnt lgkmcnt(8)
    v_mfma_f32_16x16x32_bf16 v[96:99], a[224:227], a[128:131], v[96:99]
    ds_read_b64_tr_b16 a[196:197], v41 offset:0
    ds_read_b64_tr_b16 a[198:199], v41 offset:4096
    v_mfma_f32_16x16x32_bf16 v[100:103], a[224:227], a[132:135], v[100:103]
    buffer_load_dwordx4 v33, s[40:43], s60 offen offset:1024 lds
    v_mfma_f32_16x16x32_bf16 v[104:107], a[224:227], a[136:139], v[104:107]
    v_mfma_f32_16x16x32_bf16 v[108:111], a[224:227], a[140:143], v[108:111]
    s_waitcnt lgkmcnt(8)
    v_mfma_f32_16x16x32_bf16 v[112:115], a[228:231], a[128:131], v[112:115]
    ds_read_b64_tr_b16 a[200:201], v42 offset:0
    ds_read_b64_tr_b16 a[202:203], v42 offset:512
    v_mfma_f32_16x16x32_bf16 v[116:119], a[228:231], a[132:135], v[116:119]
    buffer_load_dwordx4 v34, s[40:43], s60 offen offset:2048 lds
    v_mfma_f32_16x16x32_bf16 v[120:123], a[228:231], a[136:139], v[120:123]
    v_mfma_f32_16x16x32_bf16 v[124:127], a[228:231], a[140:143], v[124:127]
    s_waitcnt lgkmcnt(8)
    v_mfma_f32_16x16x32_bf16 v[128:131], a[232:235], a[128:131], v[128:131]
    ds_read_b64_tr_b16 a[204:205], v8 offset:9216
    ds_read_b64_tr_b16 a[206:207], v8 offset:13312
    v_mfma_f32_16x16x32_bf16 v[132:135], a[232:235], a[132:135], v[132:135]
    buffer_load_dwordx4 v35, s[40:43], s60 offen offset:3072 lds
    v_mfma_f32_16x16x32_bf16 v[136:139], a[232:235], a[136:139], v[136:139]
    s_add_u32 m0, s23, 77824
    v_mfma_f32_16x16x32_bf16 v[140:143], a[232:235], a[140:143], v[140:143]
    s_waitcnt lgkmcnt(8)
    v_mfma_f32_16x16x32_bf16 v[144:147], a[236:239], a[128:131], v[144:147]
    ds_read_b64_tr_b16 a[208:209], v9 offset:9216
    ds_read_b64_tr_b16 a[210:211], v9 offset:13312
    v_mfma_f32_16x16x32_bf16 v[148:151], a[236:239], a[132:135], v[148:151]
    buffer_load_dwordx4 v36, s[40:43], s60 offen offset:0 lds
    v_mfma_f32_16x16x32_bf16 v[152:155], a[236:239], a[136:139], v[152:155]
    v_mfma_f32_16x16x32_bf16 v[156:159], a[236:239], a[140:143], v[156:159]
    s_waitcnt lgkmcnt(8)
    v_mfma_f32_16x16x32_bf16 v[160:163], a[192:195], a[128:131], v[160:163]
    ds_read_b64_tr_b16 a[212:213], v10 offset:9216
    ds_read_b64_tr_b16 a[214:215], v10 offset:13312
    v_mfma_f32_16x16x32_bf16 v[164:167], a[192:195], a[132:135], v[164:167]
    buffer_load_dwordx4 v37, s[40:43], s60 offen offset:1024 lds
    v_mfma_f32_16x16x32_bf16 v[168:171], a[192:195], a[136:139], v[168:171]
    v_accvgpr_read_b32 v15, a248
    v_mfma_f32_16x16x32_bf16 v[172:175], a[192:195], a[140:143], v[172:175]
    s_waitcnt lgkmcnt(8)
    v_accvgpr_read_b32 v16, a249
    v_mfma_f32_16x16x32_bf16 v[176:179], a[196:199], a[128:131], v[176:179]
    ds_read_b64_tr_b16 a[216:217], v11 offset:9216
    ds_read_b64_tr_b16 a[218:219], v11 offset:13312
    v_mfma_f32_16x16x32_bf16 v[180:183], a[196:199], a[132:135], v[180:183]
    buffer_load_dwordx4 v38, s[40:43], s60 offen offset:2048 lds
    v_mfma_f32_16x16x32_bf16 v[184:187], a[196:199], a[136:139], v[184:187]
    v_accvgpr_read_b32 v17, a250
    v_mfma_f32_16x16x32_bf16 v[188:191], a[196:199], a[140:143], v[188:191]
    s_waitcnt lgkmcnt(8)
    v_accvgpr_read_b32 v18, a251
    v_mfma_f32_16x16x32_bf16 v[192:195], a[200:203], a[128:131], v[192:195]
    ds_read_b64_tr_b16 a[220:221], v25 offset:9216
    ds_read_b64_tr_b16 a[222:223], v25 offset:13312
    v_mfma_f32_16x16x32_bf16 v[196:199], a[200:203], a[132:135], v[196:199]
pad_17:
    s_cbranch_execz pad_ret
    buffer_load_dwordx4 v39, s[40:43], s60 offen offset:3072 lds
    v_mfma_f32_16x16x32_bf16 v[200:203], a[200:203], a[136:139], v[200:203]
    s_add_u32 m0, s23, 81920
    v_accvgpr_read_b32 v19, a252
    v_mfma_f32_16x16x32_bf16 v[204:207], a[200:203], a[140:143], v[204:207]
    s_waitcnt lgkmcnt(8)
    v_accvgpr_read_b32 v20, a253
    v_mfma_f32_16x16x32_bf16 v[64:67], a[204:207], a[144:147], v[64:67]
    ds_read_b64_tr_b16 a[224:225], v26 offset:9216
    ds_read_b64_tr_b16 a[226:227], v26 offset:13312
    v_mfma_f32_16x16x32_bf16 v[68:71], a[204:207], a[148:151], v[68:71]
    s_add_u32 s60, s3, 3072
    buffer_load_dwordx4 v1, s[16:19], s60 offen lds
    v_mfma_f32_16x16x32_bf16 v[72:75], a[204:207], a[152:155], v[72:75]
    s_add_u32 m0, s23, 0
    v_accvgpr_read_b32 v21, a254
    v_mfma_f32_16x16x32_bf16 v[76:79], a[204:207], a[156:159], v[76:79]
    s_waitcnt lgkmcnt(8)
    v_accvgpr_read_b32 v24, a255
    v_mfma_f32_16x16x32_bf16 v[80:83], a[208:211], a[144:147], v[80:83]
    ds_read_b64_tr_b16 a[228:229], v27 offset:9216
    ds_read_b64_tr_b16 a[230:231], v27 offset:13312
    v_mfma_f32_16x16x32_bf16 v[84:87], a[208:211], a[148:151], v[84:87]
    buffer_load_dwordx4 a[48:51], v58, s[16:19], s87 offen offset:0 sc1
    v_mfma_f32_16x16x32_bf16 v[88:91], a[208:211], a[152:155], v[88:91]
    s_mul_i32 s29, s20, 18432
    v_mfma_f32_16x16x32_bf16 v[92:95], a[208:211], a[156:159], v[92:95]
    s_waitcnt lgkmcnt(8)
    s_add_u32 s30, s29, 36864
    v_add_u32 v12, s30, v1
    v_mfma_f32_16x16x32_bf16 v[96:99], a[212:215], a[144:147], v[96:99]
    ds_read_b64_tr_b16 a[232:233], v41 offset:9216
    ds_read_b64_tr_b16 a[234:235], v41 offset:13312
    v_mfma_f32_16x16x32_bf16 v[100:103], a[212:215], a[148:151], v[100:103]
    buffer_load_dwordx4 a[52:55], v58, s[16:19], s87 offen offset:1024 sc1
    v_mfma_f32_16x16x32_bf16 v[104:107], a[212:215], a[152:155], v[104:107]
    s_xor_b32 s29, s20, 1
    v_mfma_f32_16x16x32_bf16 v[108:111], a[212:215], a[156:159], v[108:111]
    s_waitcnt lgkmcnt(8)
    s_mul_i32 s29, s29, 18432
    v_mfma_f32_16x16x32_bf16 v[112:115], a[216:219], a[144:147], v[112:115]
    ds_read_b64_tr_b16 a[236:237], v42 offset:9216
    ds_read_b64_tr_b16 a[238:239], v42 offset:9728
    v_mfma_f32_16x16x32_bf16 v[116:119], a[216:219], a[148:151], v[116:119]
    buffer_load_dwordx4 a[56:59], v58, s[16:19], s61 offen offset:0 sc1
    v_mfma_f32_16x16x32_bf16 v[120:123], a[216:219], a[152:155], v[120:123]
    s_add_u32 s30, s29, 36864
    v_add_u32 v13, s30, v1
    v_mfma_f32_16x16x32_bf16 v[124:127], a[216:219], a[156:159], v[124:127]
    s_waitcnt lgkmcnt(8)
    v_mfma_f32_16x16x32_bf16 v[128:131], a[220:223], a[144:147], v[128:131]
    buffer_load_dwordx4 a[60:63], v58, s[16:19], s61 offen offset:1024 sc1
    v_mfma_f32_16x16x32_bf16 v[132:135], a[220:223], a[148:151], v[132:135]
    v_mfma_f32_16x16x32_bf16 v[136:139], a[220:223], a[152:155], v[136:139]
    v_mfma_f32_16x16x32_bf16 v[140:143], a[220:223], a[156:159], v[140:143]
    s_waitcnt lgkmcnt(6)
    s_waitcnt lgkmcnt(0)
    s_barrier
    v_mfma_f32_16x16x32_bf16 v[144:147], a[224:227], a[144:147], v[144:147]
    ds_read_b64_tr_b16 a[192:193], v43 offset:36864
    ds_read_b64_tr_b16 a[194:195], v43 offset:40960
    v_mfma_f32_16x16x32_bf16 v[148:151], a[224:227], a[148:151], v[148:151]
    ds_read_b64_tr_b16 a[196:197], v44 offset:36864
    v_mfma_f32_16x16x32_bf16 v[152:155], a[224:227], a[152:155], v[152:155]
    ds_read_b64_tr_b16 a[198:199], v44 offset:40960
    v_mfma_f32_16x16x32_bf16 v[156:159], a[224:227], a[156:159], v[156:159]
    s_add_u32 s87, s85, 12288
    buffer_load_dwordx4 a[64:67], v1, s[16:19], s87 offen offset:0 sc1
    v_mfma_f32_16x16x32_bf16 v[160:163], a[228:231], a[144:147], v[160:163]
    ds_read_b64_tr_b16 a[200:201], v45 offset:36864
    ds_read_b64_tr_b16 a[202:203], v45 offset:40960
    v_mfma_f32_16x16x32_bf16 v[164:167], a[228:231], a[148:151], v[164:167]
    buffer_load_dwordx4 a[68:71], v1, s[16:19], s87 offen offset:1024 sc1
    v_mfma_f32_16x16x32_bf16 v[168:171], a[228:231], a[152:155], v[168:171]
    v_mfma_f32_16x16x32_bf16 v[172:175], a[228:231], a[156:159], v[172:175]
    v_mfma_f32_16x16x32_bf16 v[176:179], a[232:235], a[144:147], v[176:179]
    ds_read_b64_tr_b16 a[204:205], v46 offset:36864
    ds_read_b64_tr_b16 a[206:207], v46 offset:40960
    v_mfma_f32_16x16x32_bf16 v[180:183], a[232:235], a[148:151], v[180:183]
    s_xor_b32 s61, s87, 2048
    buffer_load_dwordx4 a[72:75], v1, s[16:19], s61 offen offset:0 sc1
    v_mfma_f32_16x16x32_bf16 v[184:187], a[232:235], a[152:155], v[184:187]
    v_mfma_f32_16x16x32_bf16 v[188:191], a[232:235], a[156:159], v[188:191]
    v_mfma_f32_16x16x32_bf16 v[192:195], a[236:239], a[144:147], v[192:195]
    ds_read_b64_tr_b16 a[208:209], v47 offset:36864
    ds_read_b64_tr_b16 a[210:211], v47 offset:40960
    v_mfma_f32_16x16x32_bf16 v[196:199], a[236:239], a[148:151], v[196:199]
    buffer_load_dwordx4 a[76:79], v1, s[16:19], s61 offen offset:1024 sc1
    v_mfma_f32_16x16x32_bf16 v[200:203], a[236:239], a[152:155], v[200:203]
    v_mfma_f32_16x16x32_bf16 v[204:207], a[236:239], a[156:159], v[204:207]
    s_waitcnt lgkmcnt(8)
    v_mfma_f32_16x16x32_bf16 v[64:67], a[192:195], a[0:3], v[64:67]
    s_waitcnt vmcnt(31)
    ds_read_b64_tr_b16 a[212:213], v48 offset:36864
    ds_read_b64_tr_b16 a[214:215], v48 offset:40960
    v_mfma_f32_16x16x32_bf16 v[68:71], a[192:195], a[4:7], v[68:71]
    s_waitcnt vmcnt(30)
    s_add_u32 s60, s59, 294912
    buffer_load_dwordx4 v32, s[40:43], s60 offen offset:0 lds
    v_mfma_f32_16x16x32_bf16 v[72:75], a[192:195], a[8:11], v[72:75]
    s_waitcnt vmcnt(30)
    v_mfma_f32_16x16x32_bf16 v[76:79], a[192:195], a[12:15], v[76:79]
    s_waitcnt lgkmcnt(8)
    v_mfma_f32_16x16x32_bf16 v[80:83], a[196:199], a[0:3], v[80:83]
    ds_read_b64_tr_b16 a[216:217], v49 offset:36864
    ds_read_b64_tr_b16 a[218:219], v49 offset:40960
    v_mfma_f32_16x16x32_bf16 v[84:87], a[196:199], a[4:7], v[84:87]
    buffer_load_dwordx4 v33, s[40:43], s60 offen offset:1024 lds
    v_mfma_f32_16x16x32_bf16 v[88:91], a[196:199], a[8:11], v[88:91]
    v_mfma_f32_16x16x32_bf16 v[92:95], a[196:199], a[12:15], v[92:95]
    s_waitcnt lgkmcnt(8)
    v_mfma_f32_16x16x32_bf16 v[96:99], a[200:203], a[0:3], v[96:99]
    ds_read_b64_tr_b16 a[220:221], v50 offset:36864
    ds_read_b64_tr_b16 a[222:223], v50 offset:40960
    v_mfma_f32_16x16x32_bf16 v[100:103], a[200:203], a[4:7], v[100:103]
    buffer_load_dwordx4 v34, s[40:43], s60 offen offset:2048 lds
    v_mfma_f32_16x16x32_bf16 v[104:107], a[200:203], a[8:11], v[104:107]
    v_mfma_f32_16x16x32_bf16 v[108:111], a[200:203], a[12:15], v[108:111]
    s_waitcnt lgkmcnt(8)
    v_mfma_f32_16x16x32_bf16 v[112:115], a[204:207], a[0:3], v[112:115]
    ds_read_b64_tr_b16 a[224:225], v51 offset:36864
    ds_read_b64_tr_b16 a[226:227], v51 offset:37376
    v_mfma_f32_16x16x32_bf16 v[116:119], a[204:207], a[4:7], v[116:119]
    buffer_load_dwordx4 v35, s[40:43], s60 offen offset:3072 lds
    v_mfma_f32_16x16x32_bf16 v[120:123], a[204:207], a[8:11], v[120:123]
    s_add_u32 m0, s23, 4096
    v_mfma_f32_16x16x32_bf16 v[124:127], a[204:207], a[12:15], v[124:127]
    s_waitcnt lgkmcnt(8)
    v_mfma_f32_16x16x32_bf16 v[128:131], a[208:211], a[0:3], v[128:131]
    ds_read_b64_tr_b16 a[228:229], v43 offset:46080
    ds_read_b64_tr_b16 a[230:231], v43 offset:50176
    v_mfma_f32_16x16x32_bf16 v[132:135], a[208:211], a[4:7], v[132:135]
    buffer_load_dwordx4 v36, s[40:43], s60 offen offset:0 lds
    v_mfma_f32_16x16x32_bf16 v[136:139], a[208:211], a[8:11], v[136:139]
    v_mfma_f32_16x16x32_bf16 v[140:143], a[208:211], a[12:15], v[140:143]
    s_waitcnt lgkmcnt(8)
    v_mfma_f32_16x16x32_bf16 v[144:147], a[212:215], a[0:3], v[144:147]
    ds_read_b64_tr_b16 a[232:233], v44 offset:46080
    ds_read_b64_tr_b16 a[234:235], v44 offset:50176
    v_mfma_f32_16x16x32_bf16 v[148:151], a[212:215], a[4:7], v[148:151]
    buffer_load_dwordx4 v37, s[40:43], s60 offen offset:1024 lds
    v_mfma_f32_16x16x32_bf16 v[152:155], a[212:215], a[8:11], v[152:155]
    v_mfma_f32_16x16x32_bf16 v[156:159], a[212:215], a[12:15], v[156:159]
    s_waitcnt lgkmcnt(8)
    v_mfma_f32_16x16x32_bf16 v[160:163], a[216:219], a[0:3], v[160:163]
    ds_read_b64_tr_b16 a[236:237], v45 offset:46080
    ds_read_b64_tr_b16 a[238:239], v45 offset:50176
    v_mfma_f32_16x16x32_bf16 v[164:167], a[216:219], a[4:7], v[164:167]
    buffer_load_dwordx4 v38, s[40:43], s60 offen offset:2048 lds
    v_mfma_f32_16x16x32_bf16 v[168:171], a[216:219], a[8:11], v[168:171]
    v_mfma_f32_16x16x32_bf16 v[172:175], a[216:219], a[12:15], v[172:175]
    s_waitcnt lgkmcnt(8)
    v_mfma_f32_16x16x32_bf16 v[176:179], a[220:223], a[0:3], v[176:179]
    ds_read_b64_tr_b16 a[192:193], v46 offset:46080
    ds_read_b64_tr_b16 a[194:195], v46 offset:50176
    v_mfma_f32_16x16x32_bf16 v[180:183], a[220:223], a[4:7], v[180:183]
    buffer_load_dwordx4 v39, s[40:43], s60 offen offset:3072 lds
    v_mfma_f32_16x16x32_bf16 v[184:187], a[220:223], a[8:11], v[184:187]
    s_add_u32 m0, s23, 8192
    v_mfma_f32_16x16x32_bf16 v[188:191], a[220:223], a[12:15], v[188:191]
    s_waitcnt lgkmcnt(8)
    v_mfma_f32_16x16x32_bf16 v[192:195], a[224:227], a[0:3], v[192:195]
    ds_read_b64_tr_b16 a[196:197], v47 offset:46080
    ds_read_b64_tr_b16 a[198:199], v47 offset:50176
    v_mfma_f32_16x16x32_bf16 v[196:199], a[224:227], a[4:7], v[196:199]
    s_add_u32 s60, s3, 8192
    buffer_load_dwordx4 v1, s[16:19], s60 offen lds
    v_mfma_f32_16x16x32_bf16 v[200:203], a[224:227], a[8:11], v[200:203]
    s_add_u32 m0, s23, 110592
    v_mfma_f32_16x16x32_bf16 v[204:207], a[224:227], a[12:15], v[204:207]
    s_waitcnt vmcnt(37) lgkmcnt(8)
    v_mfma_f32_16x16x32_bf16 v[64:67], a[228:231], a[16:19], v[64:67]
    s_waitcnt vmcnt(36)
    ds_read_b64_tr_b16 a[200:201], v48 offset:46080
    ds_read_b64_tr_b16 a[202:203], v48 offset:50176
    v_mfma_f32_16x16x32_bf16 v[68:71], a[228:231], a[20:23], v[68:71]
    s_waitcnt vmcnt(35)
    buffer_load_dwordx4 a[80:83], v58, s[16:19], s87 offen offset:0 sc1
    v_mfma_f32_16x16x32_bf16 v[72:75], a[228:231], a[24:27], v[72:75]
    s_waitcnt vmcnt(35)
    v_mfma_f32_16x16x32_bf16 v[76:79], a[228:231], a[28:31], v[76:79]
    s_waitcnt lgkmcnt(8)
    v_mfma_f32_16x16x32_bf16 v[80:83], a[232:235], a[16:19], v[80:83]
    ds_read_b64_tr_b16 a[204:205], v49 offset:46080
    ds_read_b64_tr_b16 a[206:207], v49 offset:50176
    v_mfma_f32_16x16x32_bf16 v[84:87], a[232:235], a[20:23], v[84:87]
    buffer_load_dwordx4 a[84:87], v58, s[16:19], s87 offen offset:1024 sc1
    v_mfma_f32_16x16x32_bf16 v[88:91], a[232:235], a[24:27], v[88:91]
    v_mfma_f32_16x16x32_bf16 v[92:95], a[232:235], a[28:31], v[92:95]
    s_waitcnt lgkmcnt(8)
    v_mfma_f32_16x16x32_bf16 v[96:99], a[236:239], a[16:19], v[96:99]
    ds_read_b64_tr_b16 a[208:209], v50 offset:46080
    ds_read_b64_tr_b16 a[210:211], v50 offset:50176
    v_mfma_f32_16x16x32_bf16 v[100:103], a[236:239], a[20:23], v[100:103]
    buffer_load_dwordx4 a[88:91], v58, s[16:19], s61 offen offset:0 sc1
    v_mfma_f32_16x16x32_bf16 v[104:107], a[236:239], a[24:27], v[104:107]
    v_mfma_f32_16x16x32_bf16 v[108:111], a[236:239], a[28:31], v[108:111]
    s_waitcnt lgkmcnt(8)
    v_mfma_f32_16x16x32_bf16 v[112:115], a[192:195], a[16:19], v[112:115]
    ds_read_b64_tr_b16 a[212:213], v51 offset:46080
    ds_read_b64_tr_b16 a[214:215], v51 offset:46592
    v_mfma_f32_16x16x32_bf16 v[116:119], a[192:195], a[20:23], v[116:119]
    buffer_load_dwordx4 a[92:95], v58, s[16:19], s61 offen offset:1024 sc1
    v_mfma_f32_16x16x32_bf16 v[120:123], a[192:195], a[24:27], v[120:123]
    v_mfma_f32_16x16x32_bf16 v[124:127], a[192:195], a[28:31], v[124:127]
    s_waitcnt lgkmcnt(8)
    v_mfma_f32_16x16x32_bf16 v[128:131], a[196:199], a[16:19], v[128:131]
    s_add_u32 s87, s85, 32768
    buffer_load_dwordx4 a[128:131], v1, s[16:19], s87 offen offset:0 sc1
    v_mfma_f32_16x16x32_bf16 v[132:135], a[196:199], a[20:23], v[132:135]
    v_mfma_f32_16x16x32_bf16 v[136:139], a[196:199], a[24:27], v[136:139]
    v_mfma_f32_16x16x32_bf16 v[140:143], a[196:199], a[28:31], v[140:143]
    s_waitcnt lgkmcnt(6)
    s_waitcnt vmcnt(36) lgkmcnt(0)
    s_barrier
    v_mfma_f32_16x16x32_bf16 v[144:147], a[200:203], a[16:19], v[144:147]
    ds_read_b64_tr_b16 a[216:217], v8 offset:36864
    ds_read_b64_tr_b16 a[218:219], v8 offset:40960
    v_mfma_f32_16x16x32_bf16 v[148:151], a[200:203], a[20:23], v[148:151]
    ds_read_b64_tr_b16 a[220:221], v9 offset:36864
    v_mfma_f32_16x16x32_bf16 v[152:155], a[200:203], a[24:27], v[152:155]
    ds_read_b64_tr_b16 a[222:223], v9 offset:40960
    v_mfma_f32_16x16x32_bf16 v[156:159], a[200:203], a[28:31], v[156:159]
    buffer_load_dwordx4 a[132:135], v1, s[16:19], s87 offen offset:1024 sc1
    v_mfma_f32_16x16x32_bf16 v[160:163], a[204:207], a[16:19], v[160:163]
    ds_read_b64_tr_b16 a[224:225], v10 offset:36864
    ds_read_b64_tr_b16 a[226:227], v10 offset:40960
    v_mfma_f32_16x16x32_bf16 v[164:167], a[204:207], a[20:23], v[164:167]
    s_add_u32 s60, s59, 147456
    buffer_load_dwordx4 v32, s[40:43], s60 offen offset:0 lds
    v_mfma_f32_16x16x32_bf16 v[168:171], a[204:207], a[24:27], v[168:171]
    v_mfma_f32_16x16x32_bf16 v[172:175], a[204:207], a[28:31], v[172:175]
    v_mfma_f32_16x16x32_bf16 v[176:179], a[208:211], a[16:19], v[176:179]
    ds_read_b64_tr_b16 a[228:229], v11 offset:36864
    ds_read_b64_tr_b16 a[230:231], v11 offset:40960
    v_mfma_f32_16x16x32_bf16 v[180:183], a[208:211], a[20:23], v[180:183]
    buffer_load_dwordx4 v33, s[40:43], s60 offen offset:1024 lds
    v_mfma_f32_16x16x32_bf16 v[184:187], a[208:211], a[24:27], v[184:187]
    v_mfma_f32_16x16x32_bf16 v[188:191], a[208:211], a[28:31], v[188:191]
    v_mfma_f32_16x16x32_bf16 v[192:195], a[212:215], a[16:19], v[192:195]
    ds_read_b64_tr_b16 a[232:233], v25 offset:36864
    ds_read_b64_tr_b16 a[234:235], v25 offset:40960
    v_mfma_f32_16x16x32_bf16 v[196:199], a[212:215], a[20:23], v[196:199]
    buffer_load_dwordx4 v34, s[40:43], s60 offen offset:2048 lds
    v_mfma_f32_16x16x32_bf16 v[200:203], a[212:215], a[24:27], v[200:203]
    v_mfma_f32_16x16x32_bf16 v[204:207], a[212:215], a[28:31], v[204:207]
    s_waitcnt vmcnt(39) lgkmcnt(8)
    v_mfma_f32_16x16x32_bf16 v[64:67], a[216:219], a[32:35], v[64:67]
    s_waitcnt vmcnt(38)
    ds_read_b64_tr_b16 a[236:237], v26 offset:36864
    ds_read_b64_tr_b16 a[238:239], v26 offset:40960
    v_mfma_f32_16x16x32_bf16 v[68:71], a[216:219], a[36:39], v[68:71]
    s_waitcnt vmcnt(37)
    buffer_load_dwordx4 v35, s[40:43], s60 offen offset:3072 lds
    v_mfma_f32_16x16x32_bf16 v[72:75], a[216:219], a[40:43], v[72:75]
    s_waitcnt vmcnt(37)
    s_add_u32 m0, s23, 114688
    v_mfma_f32_16x16x32_bf16 v[76:79], a[216:219], a[44:47], v[76:79]
    s_waitcnt lgkmcnt(8)
    v_mfma_f32_16x16x32_bf16 v[80:83], a[220:223], a[32:35], v[80:83]
    ds_read_b64_tr_b16 a[192:193], v42 offset:36864
    ds_read_b64_tr_b16 a[194:195], v42 offset:37376
    v_mfma_f32_16x16x32_bf16 v[84:87], a[220:223], a[36:39], v[84:87]
    buffer_load_dwordx4 v36, s[40:43], s60 offen offset:0 lds
    v_mfma_f32_16x16x32_bf16 v[88:91], a[220:223], a[40:43], v[88:91]
    v_mfma_f32_16x16x32_bf16 v[92:95], a[220:223], a[44:47], v[92:95]
    s_waitcnt lgkmcnt(8)
    v_mfma_f32_16x16x32_bf16 v[96:99], a[224:227], a[32:35], v[96:99]
    ds_read_b64_tr_b16 a[196:197], v8 offset:46080
    ds_read_b64_tr_b16 a[198:199], v8 offset:50176
    v_mfma_f32_16x16x32_bf16 v[100:103], a[224:227], a[36:39], v[100:103]
    ds_read_b64_tr_b16 a[96:97], v27 offset:36864
    v_mfma_f32_16x16x32_bf16 v[104:107], a[224:227], a[40:43], v[104:107]
    ds_read_b64_tr_b16 a[98:99], v27 offset:40960
    v_mfma_f32_16x16x32_bf16 v[108:111], a[224:227], a[44:47], v[108:111]
    s_waitcnt lgkmcnt(10)
    buffer_load_dwordx4 v37, s[40:43], s60 offen offset:1024 lds
    v_mfma_f32_16x16x32_bf16 v[112:115], a[228:231], a[32:35], v[112:115]
    ds_read_b64_tr_b16 a[200:201], v9 offset:46080
    ds_read_b64_tr_b16 a[202:203], v9 offset:50176
    v_mfma_f32_16x16x32_bf16 v[116:119], a[228:231], a[36:39], v[116:119]
    buffer_load_dwordx4 v38, s[40:43], s60 offen offset:2048 lds
    v_mfma_f32_16x16x32_bf16 v[120:123], a[228:231], a[40:43], v[120:123]
    v_mfma_f32_16x16x32_bf16 v[124:127], a[228:231], a[44:47], v[124:127]
    s_waitcnt lgkmcnt(10)
    v_mfma_f32_16x16x32_bf16 v[128:131], a[232:235], a[32:35], v[128:131]
    ds_read_b64_tr_b16 a[204:205], v10 offset:46080
    ds_read_b64_tr_b16 a[206:207], v10 offset:50176
    v_mfma_f32_16x16x32_bf16 v[132:135], a[232:235], a[36:39], v[132:135]
    ds_read_b64_tr_b16 a[100:101], v27 offset:46080
    v_mfma_f32_16x16x32_bf16 v[136:139], a[232:235], a[40:43], v[136:139]
    ds_read_b64_tr_b16 a[102:103], v27 offset:50176
    v_mfma_f32_16x16x32_bf16 v[140:143], a[232:235], a[44:47], v[140:143]
    s_waitcnt lgkmcnt(12)
    buffer_load_dwordx4 v39, s[40:43], s60 offen offset:3072 lds
    v_mfma_f32_16x16x32_bf16 v[144:147], a[236:239], a[32:35], v[144:147]
    s_add_u32 m0, s23, 118784
    ds_read_b64_tr_b16 a[208:209], v11 offset:46080
    ds_read_b64_tr_b16 a[210:211], v11 offset:50176
    v_mfma_f32_16x16x32_bf16 v[148:151], a[236:239], a[36:39], v[148:151]
    s_add_u32 s60, s3, 4096
    buffer_load_dwordx4 v1, s[16:19], s60 offen lds
    v_mfma_f32_16x16x32_bf16 v[152:155], a[236:239], a[40:43], v[152:155]
    v_mfma_f32_16x16x32_bf16 v[156:159], a[236:239], a[44:47], v[156:159]
    s_waitcnt lgkmcnt(12)
    v_mfma_f32_16x16x32_bf16 v[192:195], a[192:195], a[32:35], v[192:195]
    ds_read_b64_tr_b16 a[212:213], v25 offset:46080
    ds_read_b64_tr_b16 a[214:215], v25 offset:50176
    v_mfma_f32_16x16x32_bf16 v[196:199], a[192:195], a[36:39], v[196:199]
    ds_read_b64_tr_b16 a[112:113], v41 offset:36864
    buffer_load_dwordx2 v[54:55], v15, s[32:35], 0 offen sc1
    v_mfma_f32_16x16x32_bf16 v[200:203], a[192:195], a[40:43], v[200:203]
    ds_read_b64_tr_b16 a[114:115], v41 offset:40960
    v_mfma_f32_16x16x32_bf16 v[204:207], a[192:195], a[44:47], v[204:207]
    s_waitcnt vmcnt(32) lgkmcnt(14)
    s_xor_b32 s61, s87, 2048
    buffer_load_dwordx4 a[136:139], v1, s[16:19], s61 offen offset:0 sc1
    v_mfma_f32_16x16x32_bf16 v[64:67], a[196:199], a[48:51], v[64:67]
    s_waitcnt vmcnt(32)
    ds_read_b64_tr_b16 a[216:217], v26 offset:46080
    ds_read_b64_tr_b16 a[218:219], v26 offset:50176
    v_mfma_f32_16x16x32_bf16 v[68:71], a[196:199], a[52:55], v[68:71]
    s_waitcnt vmcnt(31)
    buffer_load_dwordx4 a[140:143], v1, s[16:19], s61 offen offset:1024 sc1
    v_mfma_f32_16x16x32_bf16 v[72:75], a[196:199], a[56:59], v[72:75]
    s_waitcnt vmcnt(31)
    v_mfma_f32_16x16x32_bf16 v[76:79], a[196:199], a[60:63], v[76:79]
    s_waitcnt lgkmcnt(12)
    v_mfma_f32_16x16x32_bf16 v[80:83], a[200:203], a[48:51], v[80:83]
    ds_read_b64_tr_b16 a[220:221], v42 offset:46080
    ds_read_b64_tr_b16 a[222:223], v42 offset:46592
    v_mfma_f32_16x16x32_bf16 v[84:87], a[200:203], a[52:55], v[84:87]
    ds_read_b64_tr_b16 a[116:117], v41 offset:46080
    v_mfma_f32_16x16x32_bf16 v[88:91], a[200:203], a[56:59], v[88:91]
    ds_read_b64_tr_b16 a[118:119], v41 offset:50176
    v_mfma_f32_16x16x32_bf16 v[92:95], a[200:203], a[60:63], v[92:95]
    s_waitcnt lgkmcnt(14)
    buffer_load_dwordx4 a[144:147], v58, s[16:19], s87 offen offset:0 sc1
    v_mfma_f32_16x16x32_bf16 v[96:99], a[204:207], a[48:51], v[96:99]
    buffer_load_dwordx4 a[148:151], v58, s[16:19], s87 offen offset:1024 sc1
    v_mfma_f32_16x16x32_bf16 v[100:103], a[204:207], a[52:55], v[100:103]
    v_mfma_f32_16x16x32_bf16 v[104:107], a[204:207], a[56:59], v[104:107]
    v_mfma_f32_16x16x32_bf16 v[108:111], a[204:207], a[60:63], v[108:111]
    s_waitcnt lgkmcnt(10)
    s_waitcnt lgkmcnt(0)
    s_barrier
    v_mfma_f32_16x16x32_bf16 v[112:115], a[208:211], a[48:51], v[112:115]
    ds_read_b64_tr_b16 a[224:225], v43 offset:0
    ds_read_b64_tr_b16 a[226:227], v43 offset:4096
    v_mfma_f32_16x16x32_bf16 v[116:119], a[208:211], a[52:55], v[116:119]
    ds_read_b64_tr_b16 a[228:229], v44 offset:0
    v_mfma_f32_16x16x32_bf16 v[120:123], a[208:211], a[56:59], v[120:123]
    ds_read_b64_tr_b16 a[230:231], v44 offset:4096
    v_mfma_f32_16x16x32_bf16 v[124:127], a[208:211], a[60:63], v[124:127]
    buffer_load_dwordx4 a[152:155], v58, s[16:19], s61 offen offset:0 sc1
    v_mfma_f32_16x16x32_bf16 v[128:131], a[212:215], a[48:51], v[128:131]
    ds_read_b64_tr_b16 a[232:233], v45 offset:0
    ds_read_b64_tr_b16 a[234:235], v45 offset:4096
    v_mfma_f32_16x16x32_bf16 v[132:135], a[212:215], a[52:55], v[132:135]
    buffer_load_dwordx4 a[156:159], v58, s[16:19], s61 offen offset:1024 sc1
    v_mfma_f32_16x16x32_bf16 v[136:139], a[212:215], a[56:59], v[136:139]
    v_mfma_f32_16x16x32_bf16 v[140:143], a[212:215], a[60:63], v[140:143]
    v_mfma_f32_16x16x32_bf16 v[144:147], a[216:219], a[48:51], v[144:147]
    ds_read_b64_tr_b16 a[236:237], v46 offset:0
    ds_read_b64_tr_b16 a[238:239], v46 offset:4096
    v_mfma_f32_16x16x32_bf16 v[148:151], a[216:219], a[52:55], v[148:151]
    s_lshl_b32 s87, s62, 10
    s_sub_u32 s87, s85, s87
    s_add_u32 s87, s87, 16384
    buffer_load_dwordx2 a[0:1], v59, s[16:19], s87 offen offset:0 sc1
    v_mfma_f32_16x16x32_bf16 v[152:155], a[216:219], a[56:59], v[152:155]
    v_mfma_f32_16x16x32_bf16 v[156:159], a[216:219], a[60:63], v[156:159]
    v_mfma_f32_16x16x32_bf16 v[192:195], a[220:223], a[48:51], v[192:195]
    ds_read_b64_tr_b16 a[192:193], v47 offset:0
    ds_read_b64_tr_b16 a[194:195], v47 offset:4096
    v_mfma_f32_16x16x32_bf16 v[196:199], a[220:223], a[52:55], v[196:199]
    buffer_load_dwordx2 a[2:3], v59, s[16:19], s87 offen offset:2048 sc1
    v_mfma_f32_16x16x32_bf16 v[200:203], a[220:223], a[56:59], v[200:203]
    v_mfma_f32_16x16x32_bf16 v[204:207], a[220:223], a[60:63], v[204:207]
    s_waitcnt vmcnt(36) lgkmcnt(8)
    v_mfma_f32_16x16x32_bf16 v[64:67], a[224:227], a[64:67], v[64:67]
    s_waitcnt vmcnt(35)
    ds_read_b64_tr_b16 a[196:197], v48 offset:0
    ds_read_b64_tr_b16 a[198:199], v48 offset:4096
    v_mfma_f32_16x16x32_bf16 v[68:71], a[224:227], a[68:71], v[68:71]
    s_waitcnt vmcnt(34)
    buffer_load_dwordx2 a[4:5], v59, s[16:19], s87 offen offset:512 sc1
    v_mfma_f32_16x16x32_bf16 v[72:75], a[224:227], a[72:75], v[72:75]
    s_waitcnt vmcnt(34)
    v_mfma_f32_16x16x32_bf16 v[76:79], a[224:227], a[76:79], v[76:79]
    s_waitcnt lgkmcnt(8)
    v_mfma_f32_16x16x32_bf16 v[80:83], a[228:231], a[64:67], v[80:83]
    ds_read_b64_tr_b16 a[200:201], v51 offset:0
    ds_read_b64_tr_b16 a[202:203], v51 offset:512
    v_mfma_f32_16x16x32_bf16 v[84:87], a[228:231], a[68:71], v[84:87]
    buffer_load_dwordx2 a[6:7], v59, s[16:19], s87 offen offset:2560 sc1
    v_mfma_f32_16x16x32_bf16 v[88:91], a[228:231], a[72:75], v[88:91]
    v_mfma_f32_16x16x32_bf16 v[92:95], a[228:231], a[76:79], v[92:95]
    s_waitcnt lgkmcnt(8)
    v_mfma_f32_16x16x32_bf16 v[96:99], a[232:235], a[64:67], v[96:99]
    ds_read_b64_tr_b16 a[204:205], v43 offset:9216
    ds_read_b64_tr_b16 a[206:207], v43 offset:13312
    v_mfma_f32_16x16x32_bf16 v[100:103], a[232:235], a[68:71], v[100:103]
    ds_read_b64_tr_b16 a[104:105], v49 offset:0
    v_mfma_f32_16x16x32_bf16 v[104:107], a[232:235], a[72:75], v[104:107]
    ds_read_b64_tr_b16 a[106:107], v49 offset:4096
    v_mfma_f32_16x16x32_bf16 v[108:111], a[232:235], a[76:79], v[108:111]
    s_waitcnt lgkmcnt(10)
    s_xor_b32 s61, s87, 1024
    buffer_load_dwordx2 a[8:9], v59, s[16:19], s61 offen offset:0 sc1
    v_mfma_f32_16x16x32_bf16 v[112:115], a[236:239], a[64:67], v[112:115]
    ds_read_b64_tr_b16 a[208:209], v44 offset:9216
    ds_read_b64_tr_b16 a[210:211], v44 offset:13312
    v_mfma_f32_16x16x32_bf16 v[116:119], a[236:239], a[68:71], v[116:119]
    buffer_load_dwordx2 a[10:11], v59, s[16:19], s61 offen offset:2048 sc1
    v_mfma_f32_16x16x32_bf16 v[120:123], a[236:239], a[72:75], v[120:123]
    v_mfma_f32_16x16x32_bf16 v[124:127], a[236:239], a[76:79], v[124:127]
    s_waitcnt lgkmcnt(10)
    v_mfma_f32_16x16x32_bf16 v[128:131], a[192:195], a[64:67], v[128:131]
    ds_read_b64_tr_b16 a[212:213], v45 offset:9216
    ds_read_b64_tr_b16 a[214:215], v45 offset:13312
    v_mfma_f32_16x16x32_bf16 v[132:135], a[192:195], a[68:71], v[132:135]
    ds_read_b64_tr_b16 a[108:109], v49 offset:9216
    v_mfma_f32_16x16x32_bf16 v[136:139], a[192:195], a[72:75], v[136:139]
    ds_read_b64_tr_b16 a[110:111], v49 offset:13312
    v_mfma_f32_16x16x32_bf16 v[140:143], a[192:195], a[76:79], v[140:143]
    s_waitcnt lgkmcnt(12)
    buffer_load_dwordx2 a[12:13], v59, s[16:19], s61 offen offset:512 sc1
    v_mfma_f32_16x16x32_bf16 v[144:147], a[196:199], a[64:67], v[144:147]
    ds_read_b64_tr_b16 a[216:217], v46 offset:9216
    ds_read_b64_tr_b16 a[218:219], v46 offset:13312
    v_mfma_f32_16x16x32_bf16 v[148:151], a[196:199], a[68:71], v[148:151]
    buffer_load_dwordx2 a[14:15], v59, s[16:19], s61 offen offset:2560 sc1
    v_mfma_f32_16x16x32_bf16 v[152:155], a[196:199], a[72:75], v[152:155]
    v_mfma_f32_16x16x32_bf16 v[156:159], a[196:199], a[76:79], v[156:159]
    s_waitcnt lgkmcnt(12)
    v_mfma_f32_16x16x32_bf16 v[192:195], a[200:203], a[64:67], v[192:195]
    ds_read_b64_tr_b16 a[220:221], v47 offset:9216
    ds_read_b64_tr_b16 a[222:223], v47 offset:13312
    v_mfma_f32_16x16x32_bf16 v[196:199], a[200:203], a[68:71], v[196:199]
    ds_read_b64_tr_b16 a[120:121], v50 offset:0
    v_mfma_f32_16x16x32_bf16 v[200:203], a[200:203], a[72:75], v[200:203]
    ds_read_b64_tr_b16 a[122:123], v50 offset:4096
    v_mfma_f32_16x16x32_bf16 v[204:207], a[200:203], a[76:79], v[204:207]
    s_waitcnt vmcnt(29) lgkmcnt(14)
    buffer_load_dwordx2 a[16:17], v60, s[16:19], s87 offen offset:0 sc1
    v_mfma_f32_16x16x32_bf16 v[64:67], a[204:207], a[80:83], v[64:67]
    s_waitcnt vmcnt(29)
    ds_read_b64_tr_b16 a[224:225], v48 offset:9216
    ds_read_b64_tr_b16 a[226:227], v48 offset:13312
    v_mfma_f32_16x16x32_bf16 v[68:71], a[204:207], a[84:87], v[68:71]
    s_waitcnt vmcnt(28)
    buffer_load_dwordx2 a[18:19], v60, s[16:19], s87 offen offset:2048 sc1
    v_mfma_f32_16x16x32_bf16 v[72:75], a[204:207], a[88:91], v[72:75]
    s_waitcnt vmcnt(28)
    v_mfma_f32_16x16x32_bf16 v[76:79], a[204:207], a[92:95], v[76:79]
    s_waitcnt lgkmcnt(12)
    v_mfma_f32_16x16x32_bf16 v[80:83], a[208:211], a[80:83], v[80:83]
    ds_read_b64_tr_b16 a[228:229], v51 offset:9216
    ds_read_b64_tr_b16 a[230:231], v51 offset:9728
    v_mfma_f32_16x16x32_bf16 v[84:87], a[208:211], a[84:87], v[84:87]
    ds_read_b64_tr_b16 a[124:125], v50 offset:9216
    ds_read_b64_tr_b16 a[126:127], v50 offset:13312
    v_mfma_f32_16x16x32_bf16 v[88:91], a[208:211], a[88:91], v[88:91]
    buffer_load_dwordx2 a[20:21], v60, s[16:19], s87 offen offset:512 sc1
    v_mfma_f32_16x16x32_bf16 v[92:95], a[208:211], a[92:95], v[92:95]
    s_waitcnt lgkmcnt(14)
    s_waitcnt vmcnt(17)
    v_cmp_ne_u64 vcc, v[62:63], v[54:55]
    s_nop 0
    s_cbranch_vccnz eps_26
epr_27:
    v_mfma_f32_16x16x32_bf16 v[96:99], a[212:215], a[80:83], v[96:99]
    buffer_load_dwordx2 a[22:23], v60, s[16:19], s87 offen offset:2560 sc1
    v_mfma_f32_16x16x32_bf16 v[100:103], a[212:215], a[84:87], v[100:103]
    v_mfma_f32_16x16x32_bf16 v[104:107], a[212:215], a[88:91], v[104:107]
    v_mfma_f32_16x16x32_bf16 v[108:111], a[212:215], a[92:95], v[108:111]
    s_waitcnt lgkmcnt(10)
    s_waitcnt lgkmcnt(0)
    s_barrier
    v_mfma_f32_16x16x32_bf16 v[112:115], a[216:219], a[80:83], v[112:115]
    ds_read_b64_tr_b16 a[232:233], v42 offset:0
    ds_read_b64_tr_b16 a[234:235], v42 offset:512
    v_mfma_f32_16x16x32_bf16 v[116:119], a[216:219], a[84:87], v[116:119]
    ds_read_b64_tr_b16 a[236:237], v42 offset:9216
    v_mfma_f32_16x16x32_bf16 v[120:123], a[216:219], a[88:91], v[120:123]
    ds_read_b64_tr_b16 a[238:239], v42 offset:9728
    v_mfma_f32_16x16x32_bf16 v[124:127], a[216:219], a[92:95], v[124:127]
    buffer_load_dwordx2 a[24:25], v60, s[16:19], s61 offen offset:0 sc1
    v_mfma_f32_16x16x32_bf16 v[128:131], a[220:223], a[80:83], v[128:131]
    ds_read_b64_tr_b16 a[192:193], v8 offset:0
    ds_read_b64_tr_b16 a[194:195], v8 offset:4096
    v_mfma_f32_16x16x32_bf16 v[132:135], a[220:223], a[84:87], v[132:135]
    buffer_load_dwordx2 a[26:27], v60, s[16:19], s61 offen offset:2048 sc1
    v_mfma_f32_16x16x32_bf16 v[136:139], a[220:223], a[88:91], v[136:139]
    v_mfma_f32_16x16x32_bf16 v[140:143], a[220:223], a[92:95], v[140:143]
    v_mfma_f32_16x16x32_bf16 v[144:147], a[224:227], a[80:83], v[144:147]
    ds_read_b64_tr_b16 a[196:197], v8 offset:9216
    ds_read_b64_tr_b16 a[198:199], v8 offset:13312
    v_mfma_f32_16x16x32_bf16 v[148:151], a[224:227], a[84:87], v[148:151]
    buffer_load_dwordx2 a[28:29], v60, s[16:19], s61 offen offset:512 sc1
    v_mfma_f32_16x16x32_bf16 v[152:155], a[224:227], a[88:91], v[152:155]
    v_mfma_f32_16x16x32_bf16 v[156:159], a[224:227], a[92:95], v[156:159]
    v_mfma_f32_16x16x32_bf16 v[192:195], a[228:231], a[80:83], v[192:195]
    ds_read_b64_tr_b16 a[200:201], v9 offset:0
    ds_read_b64_tr_b16 a[202:203], v9 offset:4096
    v_mfma_f32_16x16x32_bf16 v[196:199], a[228:231], a[84:87], v[196:199]
    buffer_load_dwordx2 a[30:31], v60, s[16:19], s61 offen offset:2560 sc1
    v_mfma_f32_16x16x32_bf16 v[200:203], a[228:231], a[88:91], v[200:203]
    v_mfma_f32_16x16x32_bf16 v[204:207], a[228:231], a[92:95], v[204:207]
    s_waitcnt lgkmcnt(8)
    v_mfma_f32_16x16x32_bf16 v[192:195], a[232:235], a[128:131], v[192:195]
    ds_read_b64_tr_b16 a[204:205], v9 offset:9216
    ds_read_b64_tr_b16 a[206:207], v9 offset:13312
    v_mfma_f32_16x16x32_bf16 v[196:199], a[232:235], a[132:135], v[196:199]
    s_waitcnt vmcnt(21)
    buffer_load_dwordx4 v[208:211], v17, s[32:35], s88 offen sc1
    v_mfma_f32_16x16x32_bf16 v[200:203], a[232:235], a[136:139], v[200:203]
    s_waitcnt vmcnt(21)
    v_mfma_f32_16x16x32_bf16 v[204:207], a[232:235], a[140:143], v[204:207]
    s_waitcnt vmcnt(20) lgkmcnt(8)
    v_mfma_f32_16x16x32_bf16 v[192:195], a[236:239], a[144:147], v[192:195]
    s_waitcnt vmcnt(19)
    ds_read_b64_tr_b16 a[208:209], v10 offset:0
    ds_read_b64_tr_b16 a[210:211], v10 offset:4096
    v_mfma_f32_16x16x32_bf16 v[196:199], a[236:239], a[148:151], v[196:199]
    s_waitcnt vmcnt(18)
    buffer_load_dwordx4 v[212:215], v17, s[32:35], s89 offen sc1
    v_mfma_f32_16x16x32_bf16 v[200:203], a[236:239], a[152:155], v[200:203]
    s_waitcnt vmcnt(18)
    v_mfma_f32_16x16x32_bf16 v[204:207], a[236:239], a[156:159], v[204:207]
    s_waitcnt lgkmcnt(8)
    v_mfma_f32_16x16x32_bf16 v[64:67], a[192:195], a[128:131], v[64:67]
    ds_read_b64_tr_b16 a[212:213], v10 offset:9216
    ds_read_b64_tr_b16 a[214:215], v10 offset:13312
    v_mfma_f32_16x16x32_bf16 v[68:71], a[192:195], a[132:135], v[68:71]
    buffer_load_dwordx4 v[216:219], v17, s[32:35], s90 offen sc1
    v_mfma_f32_16x16x32_bf16 v[72:75], a[192:195], a[136:139], v[72:75]
    v_mfma_f32_16x16x32_bf16 v[76:79], a[192:195], a[140:143], v[76:79]
    s_waitcnt lgkmcnt(8)
    v_mfma_f32_16x16x32_bf16 v[64:67], a[196:199], a[144:147], v[64:67]
    buffer_load_dword v22, v18, s[32:35], s91 offen offset:0 sc1
    v_mfma_f32_16x16x32_bf16 v[68:71], a[196:199], a[148:151], v[68:71]
    v_mfma_f32_16x16x32_bf16 v[72:75], a[196:199], a[152:155], v[72:75]
    v_mfma_f32_16x16x32_bf16 v[76:79], a[196:199], a[156:159], v[76:79]
    s_waitcnt lgkmcnt(6)
    s_barrier
    v_mfma_f32_16x16x32_bf16 v[80:83], a[200:203], a[128:131], v[80:83]
    ds_read_b64_tr_b16 a[216:217], v51 offset:36864
    ds_read_b64_tr_b16 a[218:219], v51 offset:37376
    v_mfma_f32_16x16x32_bf16 v[84:87], a[200:203], a[132:135], v[84:87]
    ds_read_b64_tr_b16 a[220:221], v51 offset:46080
    buffer_load_dword v23, v18, s[32:35], s91 offen offset:64 sc1
    v_mfma_f32_16x16x32_bf16 v[88:91], a[200:203], a[136:139], v[88:91]
    ds_read_b64_tr_b16 a[222:223], v51 offset:46592
    v_mfma_f32_16x16x32_bf16 v[92:95], a[200:203], a[140:143], v[92:95]
    s_waitcnt lgkmcnt(8)
    v_mfma_f32_16x16x32_bf16 v[80:83], a[204:207], a[144:147], v[80:83]
pad_18:
    s_cbranch_execz pad_ret
    ds_read_b64_tr_b16 a[224:225], v11 offset:0
    ds_read_b64_tr_b16 a[226:227], v11 offset:4096
    v_mfma_f32_16x16x32_bf16 v[84:87], a[204:207], a[148:151], v[84:87]
    v_mfma_f32_16x16x32_bf16 v[88:91], a[204:207], a[152:155], v[88:91]
    v_mfma_f32_16x16x32_bf16 v[92:95], a[204:207], a[156:159], v[92:95]
    s_waitcnt lgkmcnt(8)
    v_mfma_f32_16x16x32_bf16 v[96:99], a[208:211], a[128:131], v[96:99]
    ds_read_b64_tr_b16 a[228:229], v43 offset:36864
    ds_read_b64_tr_b16 a[230:231], v43 offset:40960
    v_mfma_f32_16x16x32_bf16 v[100:103], a[208:211], a[132:135], v[100:103]
    v_mfma_f32_16x16x32_bf16 v[104:107], a[208:211], a[136:139], v[104:107]
    v_mfma_f32_16x16x32_bf16 v[108:111], a[208:211], a[140:143], v[108:111]
    s_waitcnt lgkmcnt(8)
    v_mfma_f32_16x16x32_bf16 v[96:99], a[212:215], a[144:147], v[96:99]
    ds_read_b64_tr_b16 a[232:233], v43 offset:46080
    ds_read_b64_tr_b16 a[234:235], v43 offset:50176
    v_mfma_f32_16x16x32_bf16 v[100:103], a[212:215], a[148:151], v[100:103]
    v_mfma_f32_16x16x32_bf16 v[104:107], a[212:215], a[152:155], v[104:107]
    v_mfma_f32_16x16x32_bf16 v[108:111], a[212:215], a[156:159], v[108:111]
    s_waitcnt vmcnt(19) lgkmcnt(8)
    v_mfma_f32_16x16x32_bf16 v[192:195], a[216:219], a[0:3], v[192:195]
    s_waitcnt vmcnt(17)
    ds_read_b64_tr_b16 a[236:237], v11 offset:9216
    ds_read_b64_tr_b16 a[238:239], v11 offset:13312
    v_mfma_f32_16x16x32_bf16 v[196:199], a[216:219], a[4:7], v[196:199]
    s_waitcnt vmcnt(15)
    v_mfma_f32_16x16x32_bf16 v[200:203], a[216:219], a[8:11], v[200:203]
    s_waitcnt vmcnt(13)
    v_mfma_f32_16x16x32_bf16 v[204:207], a[216:219], a[12:15], v[204:207]
    s_waitcnt vmcnt(11) lgkmcnt(8)
    v_mfma_f32_16x16x32_bf16 v[192:195], a[220:223], a[16:19], v[192:195]
    s_waitcnt vmcnt(9)
    ds_read_b64_tr_b16 a[192:193], v44 offset:36864
    ds_read_b64_tr_b16 a[194:195], v44 offset:40960
    v_mfma_f32_16x16x32_bf16 v[196:199], a[220:223], a[20:23], v[196:199]
    s_waitcnt vmcnt(7)
    v_mfma_f32_16x16x32_bf16 v[200:203], a[220:223], a[24:27], v[200:203]
    s_waitcnt vmcnt(5)
    v_mfma_f32_16x16x32_bf16 v[204:207], a[220:223], a[28:31], v[204:207]
    s_waitcnt lgkmcnt(8)
    v_mfma_f32_16x16x32_bf16 v[112:115], a[224:227], a[128:131], v[112:115]
    ds_read_b64_tr_b16 a[196:197], v44 offset:46080
    ds_read_b64_tr_b16 a[198:199], v44 offset:50176
    v_mfma_f32_16x16x32_bf16 v[116:119], a[224:227], a[132:135], v[116:119]
    v_mfma_f32_16x16x32_bf16 v[120:123], a[224:227], a[136:139], v[120:123]
    v_mfma_f32_16x16x32_bf16 v[124:127], a[224:227], a[140:143], v[124:127]
    s_waitcnt lgkmcnt(8)
    v_mfma_f32_16x16x32_bf16 v[64:67], a[228:231], a[0:3], v[64:67]
    ds_read_b64_tr_b16 a[200:201], v25 offset:0
    ds_read_b64_tr_b16 a[202:203], v25 offset:4096
    v_mfma_f32_16x16x32_bf16 v[68:71], a[228:231], a[4:7], v[68:71]
    ds_write_b128 v12, v[200:203] offset:0
    v_mfma_f32_16x16x32_bf16 v[72:75], a[228:231], a[8:11], v[72:75]
    ds_write_b128 v12, v[204:207] offset:1024
    v_mfma_f32_16x16x32_bf16 v[76:79], a[228:231], a[12:15], v[76:79]
    s_waitcnt lgkmcnt(10)
    v_mfma_f32_16x16x32_bf16 v[64:67], a[232:235], a[16:19], v[64:67]
    ds_read_b64_tr_b16 a[204:205], v45 offset:36864
    ds_read_b64_tr_b16 a[206:207], v45 offset:40960
    v_mfma_f32_16x16x32_bf16 v[68:71], a[232:235], a[20:23], v[68:71]
    v_mfma_f32_16x16x32_bf16 v[72:75], a[232:235], a[24:27], v[72:75]
    v_mfma_f32_16x16x32_bf16 v[76:79], a[232:235], a[28:31], v[76:79]
    s_waitcnt lgkmcnt(10)
    v_mfma_f32_16x16x32_bf16 v[112:115], a[236:239], a[144:147], v[112:115]
    ds_read_b64_tr_b16 a[208:209], v45 offset:46080
    ds_read_b64_tr_b16 a[210:211], v45 offset:50176
    v_mfma_f32_16x16x32_bf16 v[116:119], a[236:239], a[148:151], v[116:119]
    v_mfma_f32_16x16x32_bf16 v[120:123], a[236:239], a[152:155], v[120:123]
    v_mfma_f32_16x16x32_bf16 v[124:127], a[236:239], a[156:159], v[124:127]
    s_waitcnt lgkmcnt(10)
    v_mfma_f32_16x16x32_bf16 v[80:83], a[192:195], a[0:3], v[80:83]
    ds_read_b64_tr_b16 a[212:213], v25 offset:9216
    ds_read_b64_tr_b16 a[214:215], v25 offset:13312
    v_mfma_f32_16x16x32_bf16 v[84:87], a[192:195], a[4:7], v[84:87]
    ds_write_b128 v12, v[72:75] offset:2048
    v_mfma_f32_16x16x32_bf16 v[88:91], a[192:195], a[8:11], v[88:91]
    ds_write_b128 v12, v[76:79] offset:3072
    v_mfma_f32_16x16x32_bf16 v[92:95], a[192:195], a[12:15], v[92:95]
    s_waitcnt lgkmcnt(12)
    v_mfma_f32_16x16x32_bf16 v[80:83], a[196:199], a[16:19], v[80:83]
    ds_read_b64_tr_b16 a[216:217], v46 offset:36864
    ds_read_b64_tr_b16 a[218:219], v46 offset:40960
    v_mfma_f32_16x16x32_bf16 v[84:87], a[196:199], a[20:23], v[84:87]
    v_mfma_f32_16x16x32_bf16 v[88:91], a[196:199], a[24:27], v[88:91]
    v_mfma_f32_16x16x32_bf16 v[92:95], a[196:199], a[28:31], v[92:95]
    s_waitcnt lgkmcnt(12)
    s_waitcnt lgkmcnt(2)
    s_barrier
    v_mfma_f32_16x16x32_bf16 v[128:131], a[200:203], a[128:131], v[128:131]
    ds_read_b64_tr_b16 a[220:221], v46 offset:46080
    ds_read_b64_tr_b16 a[222:223], v46 offset:50176
    v_mfma_f32_16x16x32_bf16 v[132:135], a[200:203], a[132:135], v[132:135]
    ds_read_b128 v[224:227], v13 offset:0
    ds_read_b128 v[228:231], v13 offset:1024
    v_mfma_f32_16x16x32_bf16 v[136:139], a[200:203], a[136:139], v[136:139]
    ds_read_b128 v[232:235], v13 offset:2048
    ds_read_b128 v[236:239], v13 offset:3072
    v_mfma_f32_16x16x32_bf16 v[140:143], a[200:203], a[140:143], v[140:143]
    v_mfma_f32_16x16x32_bf16 v[96:99], a[204:207], a[0:3], v[96:99]
    ds_read_b64_tr_b16 a[224:225], v26 offset:0
    ds_read_b64_tr_b16 a[226:227], v26 offset:4096
    v_mfma_f32_16x16x32_bf16 v[100:103], a[204:207], a[4:7], v[100:103]
    ds_write_b128 v12, v[88:91] offset:4096
    v_mfma_f32_16x16x32_bf16 v[104:107], a[204:207], a[8:11], v[104:107]
    ds_write_b128 v12, v[92:95] offset:5120
    v_mfma_f32_16x16x32_bf16 v[108:111], a[204:207], a[12:15], v[108:111]
    v_mfma_f32_16x16x32_bf16 v[96:99], a[208:211], a[16:19], v[96:99]
    ds_read_b64_tr_b16 a[228:229], v47 offset:36864
    ds_read_b64_tr_b16 a[230:231], v47 offset:40960
    s_waitcnt lgkmcnt(9)
    v_mfma_f32_16x16x32_bf16 v[100:103], a[208:211], a[20:23], v[100:103]
    v_add_f32 v192, v192, v224
    v_add_f32 v193, v193, v225
    v_mfma_f32_16x16x32_bf16 v[104:107], a[208:211], a[24:27], v[104:107]
    v_add_f32 v194, v194, v226
    v_add_f32 v195, v195, v227
    v_mfma_f32_16x16x32_bf16 v[108:111], a[208:211], a[28:31], v[108:111]
    v_cvt_pk_bf16_f32 v240, v192, v193
    v_cvt_pk_bf16_f32 v241, v194, v195
    v_mfma_f32_16x16x32_bf16 v[128:131], a[212:215], a[144:147], v[128:131]
    ds_read_b64_tr_b16 a[232:233], v47 offset:46080
    ds_read_b64_tr_b16 a[234:235], v47 offset:50176
    s_waitcnt lgkmcnt(10)
    v_mfma_f32_16x16x32_bf16 v[132:135], a[212:215], a[148:151], v[132:135]
    v_add_f32 v196, v196, v228
    v_add_f32 v197, v197, v229
    v_mfma_f32_16x16x32_bf16 v[136:139], a[212:215], a[152:155], v[136:139]
    v_add_f32 v198, v198, v230
    v_add_f32 v199, v199, v231
    v_mfma_f32_16x16x32_bf16 v[140:143], a[212:215], a[156:159], v[140:143]
    v_cvt_pk_bf16_f32 v242, v196, v197
    v_cvt_pk_bf16_f32 v243, v198, v199
    v_mfma_f32_16x16x32_bf16 v[112:115], a[216:219], a[0:3], v[112:115]
    ds_read_b64_tr_b16 a[236:237], v26 offset:9216
    ds_read_b64_tr_b16 a[238:239], v26 offset:13312
    v_mfma_f32_16x16x32_bf16 v[116:119], a[216:219], a[4:7], v[116:119]
    ds_write_b128 v12, v[104:107] offset:6144
    buffer_store_dwordx4 v[240:243], v1, s[68:71], s96 offen offset:2048 sc1
    s_waitcnt lgkmcnt(12)
    v_mfma_f32_16x16x32_bf16 v[120:123], a[216:219], a[8:11], v[120:123]
    ds_write_b128 v12, v[108:111] offset:7168
    v_add_f32 v64, v64, v232
    v_mfma_f32_16x16x32_bf16 v[124:127], a[216:219], a[12:15], v[124:127]
    v_add_f32 v65, v65, v233
    v_add_f32 v66, v66, v234
    v_mfma_f32_16x16x32_bf16 v[112:115], a[220:223], a[16:19], v[112:115]
    ds_read_b64_tr_b16 a[192:193], v48 offset:36864
    ds_read_b64_tr_b16 a[194:195], v48 offset:40960
    v_mfma_f32_16x16x32_bf16 v[116:119], a[220:223], a[20:23], v[116:119]
    v_add_f32 v67, v67, v235
    v_cvt_pk_bf16_f32 v244, v64, v65
    v_mfma_f32_16x16x32_bf16 v[120:123], a[220:223], a[24:27], v[120:123]
    v_cvt_pk_bf16_f32 v245, v66, v67
    v_mfma_f32_16x16x32_bf16 v[124:127], a[220:223], a[28:31], v[124:127]
    s_waitcnt lgkmcnt(12)
    v_add_f32 v68, v68, v236
    v_add_f32 v69, v69, v237
    s_waitcnt lgkmcnt(2)
    s_barrier
    v_mfma_f32_16x16x32_bf16 v[144:147], a[224:227], a[128:131], v[144:147]
    ds_read_b64_tr_b16 a[196:197], v48 offset:46080
    ds_read_b64_tr_b16 a[198:199], v48 offset:50176
    v_mfma_f32_16x16x32_bf16 v[148:151], a[224:227], a[132:135], v[148:151]
    v_add_f32 v70, v70, v238
    v_add_f32 v71, v71, v239
    v_mfma_f32_16x16x32_bf16 v[152:155], a[224:227], a[136:139], v[152:155]
    v_cvt_pk_bf16_f32 v246, v68, v69
    v_cvt_pk_bf16_f32 v247, v70, v71
    v_mfma_f32_16x16x32_bf16 v[156:159], a[224:227], a[140:143], v[156:159]
    buffer_store_dwordx4 v[244:247], v1, s[68:71], s50 offen offset:0 sc1
    ds_read_b128 v[224:227], v13 offset:4096
    v_mfma_f32_16x16x32_bf16 v[128:131], a[228:231], a[0:3], v[128:131]
    ds_write_b128 v12, v[120:123] offset:8192
    ds_write_b128 v12, v[124:127] offset:9216
    v_mfma_f32_16x16x32_bf16 v[132:135], a[228:231], a[4:7], v[132:135]
    ds_read_b128 v[228:231], v13 offset:5120
    ds_read_b128 v[232:235], v13 offset:6144
    v_mfma_f32_16x16x32_bf16 v[136:139], a[228:231], a[8:11], v[136:139]
    ds_read_b128 v[236:239], v13 offset:7168
    v_mfma_f32_16x16x32_bf16 v[140:143], a[228:231], a[12:15], v[140:143]
    v_mfma_f32_16x16x32_bf16 v[128:131], a[232:235], a[16:19], v[128:131]
    s_waitcnt lgkmcnt(5)
    v_add_f32 v80, v80, v224
    v_add_f32 v81, v81, v225
    v_mfma_f32_16x16x32_bf16 v[132:135], a[232:235], a[20:23], v[132:135]
    v_add_f32 v82, v82, v226
    v_add_f32 v83, v83, v227
    v_mfma_f32_16x16x32_bf16 v[136:139], a[232:235], a[24:27], v[136:139]
    v_cvt_pk_bf16_f32 v248, v80, v81
    v_cvt_pk_bf16_f32 v249, v82, v83
    v_mfma_f32_16x16x32_bf16 v[140:143], a[232:235], a[28:31], v[140:143]
    s_waitcnt lgkmcnt(2)
    v_add_f32 v84, v84, v228
    v_add_f32 v85, v85, v229
    v_mfma_f32_16x16x32_bf16 v[144:147], a[236:239], a[144:147], v[144:147]
    v_add_f32 v86, v86, v230
    v_add_f32 v87, v87, v231
    v_mfma_f32_16x16x32_bf16 v[148:151], a[236:239], a[148:151], v[148:151]
    v_cvt_pk_bf16_f32 v250, v84, v85
    v_cvt_pk_bf16_f32 v251, v86, v87
    v_mfma_f32_16x16x32_bf16 v[152:155], a[236:239], a[152:155], v[152:155]
    buffer_store_dwordx4 v[248:251], v1, s[68:71], s50 offen offset:1024 sc1
    s_waitcnt lgkmcnt(1)
    v_add_f32 v96, v96, v232
    v_mfma_f32_16x16x32_bf16 v[156:159], a[236:239], a[156:159], v[156:159]
    v_add_f32 v97, v97, v233
    v_add_f32 v98, v98, v234
    v_mfma_f32_16x16x32_bf16 v[144:147], a[192:195], a[0:3], v[144:147]
    ds_write_b128 v12, v[136:139] offset:10240
    ds_write_b128 v12, v[140:143] offset:11264
    v_mfma_f32_16x16x32_bf16 v[148:151], a[192:195], a[4:7], v[148:151]
    v_add_f32 v99, v99, v235
    v_cvt_pk_bf16_f32 v252, v96, v97
    v_mfma_f32_16x16x32_bf16 v[152:155], a[192:195], a[8:11], v[152:155]
    v_cvt_pk_bf16_f32 v253, v98, v99
    v_mfma_f32_16x16x32_bf16 v[156:159], a[192:195], a[12:15], v[156:159]
    s_waitcnt lgkmcnt(2)
    v_add_f32 v100, v100, v236
    v_add_f32 v101, v101, v237
    v_mfma_f32_16x16x32_bf16 v[144:147], a[196:199], a[16:19], v[144:147]
    ds_read_b64_tr_b16 a[216:217], v27 offset:0
    ds_read_b64_tr_b16 a[218:219], v27 offset:4096
    v_mfma_f32_16x16x32_bf16 v[148:151], a[196:199], a[20:23], v[148:151]
    v_add_f32 v102, v102, v238
    v_add_f32 v103, v103, v239
    v_mfma_f32_16x16x32_bf16 v[152:155], a[196:199], a[24:27], v[152:155]
    v_cvt_pk_bf16_f32 v254, v100, v101
    v_cvt_pk_bf16_f32 v255, v102, v103
    v_mfma_f32_16x16x32_bf16 v[156:159], a[196:199], a[28:31], v[156:159]
    buffer_store_dwordx4 v[252:255], v1, s[68:71], s54 offen offset:0 sc1
    s_waitcnt lgkmcnt(2)
    s_barrier
    v_mfma_f32_16x16x32_bf16 v[160:163], a[96:99], a[32:35], v[160:163]
    ds_read_b64_tr_b16 a[220:221], v27 offset:9216
    ds_read_b64_tr_b16 a[222:223], v27 offset:13312
    v_mfma_f32_16x16x32_bf16 v[164:167], a[96:99], a[36:39], v[164:167]
    ds_read_b128 v[224:227], v13 offset:8192
    ds_read_b128 v[228:231], v13 offset:9216
    v_mfma_f32_16x16x32_bf16 v[168:171], a[96:99], a[40:43], v[168:171]
    ds_read_b128 v[232:235], v13 offset:10240
    ds_read_b128 v[236:239], v13 offset:11264
    v_mfma_f32_16x16x32_bf16 v[172:175], a[96:99], a[44:47], v[172:175]
    v_mfma_f32_16x16x32_bf16 v[160:163], a[100:103], a[48:51], v[160:163]
    ds_read_b64_tr_b16 a[224:225], v49 offset:36864
    ds_read_b64_tr_b16 a[226:227], v49 offset:40960
    v_mfma_f32_16x16x32_bf16 v[164:167], a[100:103], a[52:55], v[164:167]
    ds_write_b128 v12, v[152:155] offset:12288
    v_mfma_f32_16x16x32_bf16 v[168:171], a[100:103], a[56:59], v[168:171]
    ds_write_b128 v12, v[156:159] offset:13312
    v_mfma_f32_16x16x32_bf16 v[172:175], a[100:103], a[60:63], v[172:175]
    v_mfma_f32_16x16x32_bf16 v[160:163], a[104:107], a[64:67], v[160:163]
    ds_read_b64_tr_b16 a[228:229], v49 offset:46080
    ds_read_b64_tr_b16 a[230:231], v49 offset:50176
    s_waitcnt lgkmcnt(9)
    v_mfma_f32_16x16x32_bf16 v[164:167], a[104:107], a[68:71], v[164:167]
    v_add_f32 v112, v112, v224
    v_add_f32 v113, v113, v225
    v_mfma_f32_16x16x32_bf16 v[168:171], a[104:107], a[72:75], v[168:171]
    v_add_f32 v114, v114, v226
    v_add_f32 v115, v115, v227
    v_mfma_f32_16x16x32_bf16 v[172:175], a[104:107], a[76:79], v[172:175]
    v_cvt_pk_bf16_f32 v240, v112, v113
    v_cvt_pk_bf16_f32 v241, v114, v115
    s_waitcnt lgkmcnt(2)
    s_barrier
    v_mfma_f32_16x16x32_bf16 v[160:163], a[108:111], a[80:83], v[160:163]
    v_add_f32 v116, v116, v228
    v_add_f32 v117, v117, v229
    v_mfma_f32_16x16x32_bf16 v[164:167], a[108:111], a[84:87], v[164:167]
    v_add_f32 v118, v118, v230
    v_add_f32 v119, v119, v231
    v_mfma_f32_16x16x32_bf16 v[168:171], a[108:111], a[88:91], v[168:171]
    v_cvt_pk_bf16_f32 v242, v116, v117
    v_cvt_pk_bf16_f32 v243, v118, v119
    v_mfma_f32_16x16x32_bf16 v[172:175], a[108:111], a[92:95], v[172:175]
    buffer_store_dwordx4 v[240:243], v1, s[68:71], s54 offen offset:1024 sc1
    v_add_f32 v128, v128, v232
    v_mfma_f32_16x16x32_bf16 v[160:163], a[216:219], a[128:131], v[160:163]
    v_add_f32 v129, v129, v233
    v_add_f32 v130, v130, v234
    v_mfma_f32_16x16x32_bf16 v[164:167], a[216:219], a[132:135], v[164:167]
    v_add_f32 v131, v131, v235
    v_cvt_pk_bf16_f32 v244, v128, v129
    v_mfma_f32_16x16x32_bf16 v[168:171], a[216:219], a[136:139], v[168:171]
    v_cvt_pk_bf16_f32 v245, v130, v131
    v_mfma_f32_16x16x32_bf16 v[172:175], a[216:219], a[140:143], v[172:175]
    v_add_f32 v132, v132, v236
    v_add_f32 v133, v133, v237
    v_mfma_f32_16x16x32_bf16 v[160:163], a[220:223], a[144:147], v[160:163]
    v_add_f32 v134, v134, v238
    v_add_f32 v135, v135, v239
    v_mfma_f32_16x16x32_bf16 v[164:167], a[220:223], a[148:151], v[164:167]
    v_cvt_pk_bf16_f32 v246, v132, v133
    v_cvt_pk_bf16_f32 v247, v134, v135
    v_mfma_f32_16x16x32_bf16 v[168:171], a[220:223], a[152:155], v[168:171]
    buffer_store_dwordx4 v[244:247], v1, s[68:71], s55 offen offset:0 sc1
    ds_read_b128 v[224:227], v13 offset:12288
    v_mfma_f32_16x16x32_bf16 v[172:175], a[220:223], a[156:159], v[172:175]
    ds_read_b128 v[228:231], v13 offset:13312
    s_waitcnt lgkmcnt(1)
    v_add_f32 v144, v144, v224
    v_mfma_f32_16x16x32_bf16 v[160:163], a[224:227], a[0:3], v[160:163]
    v_add_f32 v145, v145, v225
    v_add_f32 v146, v146, v226
    v_mfma_f32_16x16x32_bf16 v[164:167], a[224:227], a[4:7], v[164:167]
    v_add_f32 v147, v147, v227
    v_cvt_pk_bf16_f32 v248, v144, v145
    v_mfma_f32_16x16x32_bf16 v[168:171], a[224:227], a[8:11], v[168:171]
    v_cvt_pk_bf16_f32 v249, v146, v147
    v_mfma_f32_16x16x32_bf16 v[172:175], a[224:227], a[12:15], v[172:175]
    s_waitcnt lgkmcnt(0)
    v_add_f32 v148, v148, v228
    v_add_f32 v149, v149, v229
    v_mfma_f32_16x16x32_bf16 v[160:163], a[228:231], a[16:19], v[160:163]
    ds_read_b64_tr_b16 a[200:201], v41 offset:0
    ds_read_b64_tr_b16 a[202:203], v41 offset:4096
    v_mfma_f32_16x16x32_bf16 v[164:167], a[228:231], a[20:23], v[164:167]
    v_add_f32 v150, v150, v230
    v_add_f32 v151, v151, v231
    v_mfma_f32_16x16x32_bf16 v[168:171], a[228:231], a[24:27], v[168:171]
    v_cvt_pk_bf16_f32 v250, v148, v149
    v_cvt_pk_bf16_f32 v251, v150, v151
    v_mfma_f32_16x16x32_bf16 v[172:175], a[228:231], a[28:31], v[172:175]
    buffer_store_dwordx4 v[248:251], v1, s[68:71], s55 offen offset:1024 sc1
    v_mfma_f32_16x16x32_bf16 v[176:179], a[112:115], a[32:35], v[176:179]
    ds_read_b64_tr_b16 a[204:205], v41 offset:9216
    ds_read_b64_tr_b16 a[206:207], v41 offset:13312
    s_waitcnt vmcnt(11)
    v_mfma_f32_16x16x32_bf16 v[180:183], a[112:115], a[36:39], v[180:183]
    ds_write_b128 v19, v[208:211] offset:0
    v_mfma_f32_16x16x32_bf16 v[184:187], a[112:115], a[40:43], v[184:187]
    v_mfma_f32_16x16x32_bf16 v[188:191], a[112:115], a[44:47], v[188:191]
    v_mfma_f32_16x16x32_bf16 v[176:179], a[116:119], a[48:51], v[176:179]
    ds_read_b64_tr_b16 a[208:209], v50 offset:36864
    ds_read_b64_tr_b16 a[210:211], v50 offset:40960
    s_waitcnt vmcnt(10)
    v_mfma_f32_16x16x32_bf16 v[180:183], a[116:119], a[52:55], v[180:183]
    ds_write_b128 v12, v[168:171] offset:14336
    ds_write_b128 v19, v[212:215] offset:1280
    v_mfma_f32_16x16x32_bf16 v[184:187], a[116:119], a[56:59], v[184:187]
    ds_write_b128 v12, v[172:175] offset:15360
    v_mfma_f32_16x16x32_bf16 v[188:191], a[116:119], a[60:63], v[188:191]
    v_mfma_f32_16x16x32_bf16 v[176:179], a[120:123], a[64:67], v[176:179]
    ds_read_b64_tr_b16 a[212:213], v50 offset:46080
    ds_read_b64_tr_b16 a[214:215], v50 offset:50176
    s_waitcnt vmcnt(9)
    v_mfma_f32_16x16x32_bf16 v[180:183], a[120:123], a[68:71], v[180:183]
    ds_write_b128 v19, v[216:219] offset:2560
    v_mfma_f32_16x16x32_bf16 v[184:187], a[120:123], a[72:75], v[184:187]
    v_mfma_f32_16x16x32_bf16 v[188:191], a[120:123], a[76:79], v[188:191]
    v_mfma_f32_16x16x32_bf16 v[176:179], a[124:127], a[80:83], v[176:179]
    v_mfma_f32_16x16x32_bf16 v[180:183], a[124:127], a[84:87], v[180:183]
    v_mfma_f32_16x16x32_bf16 v[184:187], a[124:127], a[88:91], v[184:187]
    v_mfma_f32_16x16x32_bf16 v[188:191], a[124:127], a[92:95], v[188:191]
    s_waitcnt lgkmcnt(11)
    v_mfma_f32_16x16x32_bf16 v[176:179], a[200:203], a[128:131], v[176:179]
    v_mfma_f32_16x16x32_bf16 v[180:183], a[200:203], a[132:135], v[180:183]
    v_mfma_f32_16x16x32_bf16 v[184:187], a[200:203], a[136:139], v[184:187]
    v_mfma_f32_16x16x32_bf16 v[188:191], a[200:203], a[140:143], v[188:191]
    s_waitcnt lgkmcnt(9)
    v_mfma_f32_16x16x32_bf16 v[176:179], a[204:207], a[144:147], v[176:179]
    v_mfma_f32_16x16x32_bf16 v[180:183], a[204:207], a[148:151], v[180:183]
    v_mfma_f32_16x16x32_bf16 v[184:187], a[204:207], a[152:155], v[184:187]
    v_mfma_f32_16x16x32_bf16 v[188:191], a[204:207], a[156:159], v[188:191]
    s_waitcnt lgkmcnt(6)
    v_mfma_f32_16x16x32_bf16 v[176:179], a[208:211], a[0:3], v[176:179]
    s_waitcnt vmcnt(0)
    buffer_store_dwordx2 v[62:63], v52, s[32:35], s73 offen sc1
    v_mfma_f32_16x16x32_bf16 v[180:183], a[208:211], a[4:7], v[180:183]
    v_mfma_f32_16x16x32_bf16 v[184:187], a[208:211], a[8:11], v[184:187]
    v_mfma_f32_16x16x32_bf16 v[188:191], a[208:211], a[12:15], v[188:191]
    s_waitcnt lgkmcnt(1)
    v_mfma_f32_16x16x32_bf16 v[176:179], a[212:215], a[16:19], v[176:179]
    v_mfma_f32_16x16x32_bf16 v[180:183], a[212:215], a[20:23], v[180:183]
    v_mfma_f32_16x16x32_bf16 v[184:187], a[212:215], a[24:27], v[184:187]
    v_mfma_f32_16x16x32_bf16 v[188:191], a[212:215], a[28:31], v[188:191]
    buffer_load_dwordx2 v[54:55], v16, s[32:35], s49 offen sc1
    s_add_u32 s44, s37, s97
    s_add_u32 s45, s38, s97
    s_add_u32 s46, s39, s97
    s_mov_b32 s29, 0xffff0000
    s_movk_i32 s36, 18432
    v_sub_f32 v2, 1.0, v22
    v_sub_f32 v4, 1.0, v23
    v_cvt_pk_bf16_f32 v2, v2, v2
    v_cvt_pk_bf16_f32 v4, v4, v4
    v_and_b32 v3, s29, v2
    v_lshrrev_b32 v2, 16, v2
    v_and_b32 v5, s29, v4
    v_lshrrev_b32 v4, 16, v4
    ds_write_b128 v12, v[184:187] offset:16384
    ds_write_b128 v12, v[188:191] offset:17408
    s_waitcnt lgkmcnt(0)
    s_barrier
    ds_read_b128 v[232:235], v13 offset:14336
    ds_read_b128 v[236:239], v13 offset:15360
    ds_read_b128 v[224:227], v13 offset:16384
    ds_read_b128 v[228:231], v13 offset:17408
    ds_read_b64_tr_b16 v[156:157], v20 offset:2560
    ds_read_b64_tr_b16 v[158:159], v20 offset:2592
    ds_read_b64_tr_b16 v[148:149], v20 offset:0
    ds_read_b64_tr_b16 v[150:151], v20 offset:32
    ds_read_b64_tr_b16 v[152:153], v20 offset:1280
    ds_read_b64_tr_b16 v[154:155], v20 offset:1312
    s_waitcnt lgkmcnt(9)
    v_add_f32 v160, v160, v232
    v_add_f32 v161, v161, v233
    v_add_f32 v162, v162, v234
    v_add_f32 v163, v163, v235
    s_waitcnt lgkmcnt(8)
    v_add_f32 v164, v164, v236
    v_add_f32 v165, v165, v237
    v_add_f32 v166, v166, v238
    v_add_f32 v167, v167, v239
    buffer_load_dwordx2 v[56:57], v16, s[32:35], s49 offen sc1
    s_waitcnt lgkmcnt(7)
    v_add_f32 v176, v176, v224
    v_add_f32 v177, v177, v225
    v_add_f32 v178, v178, v226
    v_add_f32 v179, v179, v227
    s_waitcnt lgkmcnt(6)
    v_add_f32 v180, v180, v228
    v_add_f32 v181, v181, v229
    v_add_f32 v182, v182, v230
    v_add_f32 v183, v183, v231
    s_waitcnt lgkmcnt(5)
    v_lshlrev_b32 v224, 16, v156
    v_and_b32 v225, s29, v156
    v_mul_f32 v192, v3, v192
    v_mul_f32 v193, v3, v193
    v_fmac_f32 v192, v22, v224
    v_fmac_f32 v193, v22, v225
    v_lshlrev_b32 v226, 16, v157
    v_and_b32 v227, s29, v157
    v_mul_f32 v194, v3, v194
    v_mul_f32 v195, v3, v195
    v_fmac_f32 v194, v22, v226
    v_fmac_f32 v195, v22, v227
    s_waitcnt lgkmcnt(4)
    v_lshlrev_b32 v224, 16, v158
    v_and_b32 v225, s29, v158
    v_mul_f32 v196, v5, v196
    v_mul_f32 v197, v5, v197
    v_fmac_f32 v196, v23, v224
    v_fmac_f32 v197, v23, v225
    v_lshlrev_b32 v226, 16, v159
    v_and_b32 v227, s29, v159
    v_mul_f32 v198, v5, v198
    v_mul_f32 v199, v5, v199
    v_fmac_f32 v198, v23, v226
    v_fmac_f32 v199, v23, v227
    buffer_load_dwordx2 v[58:59], v16, s[32:35], s49 offen sc1
    s_waitcnt lgkmcnt(3)
    v_lshlrev_b32 v224, 16, v148
    v_and_b32 v225, s29, v148
    v_mul_f32 v160, v3, v160
    v_mul_f32 v161, v3, v161
    v_fmac_f32 v160, v22, v224
    v_fmac_f32 v161, v22, v225
    v_lshlrev_b32 v226, 16, v149
    v_and_b32 v227, s29, v149
    v_mul_f32 v162, v3, v162
    v_mul_f32 v163, v3, v163
    v_fmac_f32 v162, v22, v226
    v_fmac_f32 v163, v22, v227
    s_waitcnt lgkmcnt(2)
    v_lshlrev_b32 v224, 16, v150
    v_and_b32 v225, s29, v150
    v_mul_f32 v164, v5, v164
    v_mul_f32 v165, v5, v165
    v_fmac_f32 v164, v23, v224
    v_fmac_f32 v165, v23, v225
    v_lshlrev_b32 v226, 16, v151
    v_and_b32 v227, s29, v151
    v_mul_f32 v166, v5, v166
    v_mul_f32 v167, v5, v167
    v_fmac_f32 v166, v23, v226
    v_fmac_f32 v167, v23, v227
    s_waitcnt lgkmcnt(1)
    v_lshlrev_b32 v224, 16, v152
    v_and_b32 v225, s29, v152
    v_mul_f32 v176, v3, v176
    v_mul_f32 v177, v3, v177
    v_fmac_f32 v176, v22, v224
    v_fmac_f32 v177, v22, v225
    v_lshlrev_b32 v226, 16, v153
    v_and_b32 v227, s29, v153
    v_mul_f32 v178, v3, v178
    v_mul_f32 v179, v3, v179
    v_fmac_f32 v178, v22, v226
    v_fmac_f32 v179, v22, v227
    s_waitcnt lgkmcnt(0)
    v_lshlrev_b32 v224, 16, v154
    v_and_b32 v225, s29, v154
    v_mul_f32 v180, v5, v180
    v_mul_f32 v181, v5, v181
    v_fmac_f32 v180, v23, v224
    v_fmac_f32 v181, v23, v225
    v_lshlrev_b32 v226, 16, v155
    v_and_b32 v227, s29, v155
    v_mul_f32 v182, v5, v182
    v_mul_f32 v183, v5, v183
    v_fmac_f32 v182, v23, v226
    v_fmac_f32 v183, v23, v227
    s_mov_b32 s98, 0
pl_28:
    s_waitcnt vmcnt(2)
    v_cmp_ne_u64 vcc, v[62:63], v[54:55]
    s_add_u32 s98, s98, 1
    s_cbranch_vccz pd_29
    buffer_load_dwordx2 v[54:55], v16, s[32:35], s49 offen sc1
    s_waitcnt vmcnt(2)
    v_cmp_ne_u64 vcc, v[62:63], v[56:57]
    s_add_u32 s98, s98, 1
    s_cbranch_vccz pd_29
    buffer_load_dwordx2 v[56:57], v16, s[32:35], s49 offen sc1
    s_waitcnt vmcnt(2)
    v_cmp_ne_u64 vcc, v[62:63], v[58:59]
    s_add_u32 s98, s98, 1
    s_cbranch_vccz pd_29
    buffer_load_dwordx2 v[58:59], v16, s[32:35], s49 offen sc1
    s_cmp_gt_u32 s98, 0x40000
    s_cbranch_scc0 pl_28
pd_29:
    s_cmp_eq_u32 s20, s82
    s_cbranch_scc0 nx_30
    buffer_load_dwordx4 v[88:91], v1, s[68:71], s44 offen offset:2048 sc1
    buffer_load_dwordx4 v[92:95], v1, s[68:71], s45 offen offset:2048 sc1
    buffer_load_dwordx4 v[96:99], v1, s[68:71], s46 offen offset:2048 sc1
nx_30:
    buffer_load_dwordx4 v[64:67], v1, s[68:71], s37 offen offset:0 sc1
    buffer_load_dwordx4 v[68:71], v1, s[68:71], s38 offen offset:0 sc1
    buffer_load_dwordx4 v[72:75], v1, s[68:71], s39 offen offset:0 sc1
    buffer_load_dwordx4 v[76:79], v1, s[68:71], s37 offen offset:1024 sc1
    buffer_load_dwordx4 v[80:83], v1, s[68:71], s38 offen offset:1024 sc1
    buffer_load_dwordx4 v[84:87], v1, s[68:71], s39 offen offset:1024 sc1
    s_cmp_eq_u32 s20, s82
    s_cbranch_scc0 nx_31
    s_waitcnt vmcnt(6)
    v_dot2c_f32_bf16 v192, v2, v88
    v_dot2c_f32_bf16 v193, v3, v88
    v_dot2c_f32_bf16 v194, v2, v89
    v_dot2c_f32_bf16 v195, v3, v89
    v_dot2c_f32_bf16 v196, v4, v90
    v_dot2c_f32_bf16 v197, v5, v90
    v_dot2c_f32_bf16 v198, v4, v91
    v_dot2c_f32_bf16 v199, v5, v91
    v_dot2c_f32_bf16 v192, v2, v92
    v_dot2c_f32_bf16 v193, v3, v92
    v_dot2c_f32_bf16 v194, v2, v93
    v_dot2c_f32_bf16 v195, v3, v93
    v_dot2c_f32_bf16 v196, v4, v94
    v_dot2c_f32_bf16 v197, v5, v94
    v_dot2c_f32_bf16 v198, v4, v95
    v_dot2c_f32_bf16 v199, v5, v95
    v_dot2c_f32_bf16 v192, v2, v96
    v_dot2c_f32_bf16 v193, v3, v96
    v_dot2c_f32_bf16 v194, v2, v97
    v_dot2c_f32_bf16 v195, v3, v97
    v_dot2c_f32_bf16 v196, v4, v98
    v_dot2c_f32_bf16 v197, v5, v98
    v_dot2c_f32_bf16 v198, v4, v99
    v_dot2c_f32_bf16 v199, v5, v99
nx_31:
    s_waitcnt vmcnt(5)
    v_dot2c_f32_bf16 v160, v2, v64
    v_dot2c_f32_bf16 v161, v3, v64
    v_dot2c_f32_bf16 v162, v2, v65
    v_dot2c_f32_bf16 v163, v3, v65
    v_dot2c_f32_bf16 v164, v4, v66
    v_dot2c_f32_bf16 v165, v5, v66
    v_dot2c_f32_bf16 v166, v4, v67
    v_dot2c_f32_bf16 v167, v5, v67
    s_waitcnt vmcnt(4)
    v_dot2c_f32_bf16 v160, v2, v68
    v_dot2c_f32_bf16 v161, v3, v68
    v_dot2c_f32_bf16 v162, v2, v69
    v_dot2c_f32_bf16 v163, v3, v69
    v_dot2c_f32_bf16 v164, v4, v70
    v_dot2c_f32_bf16 v165, v5, v70
    v_dot2c_f32_bf16 v166, v4, v71
    v_dot2c_f32_bf16 v167, v5, v71
    s_waitcnt vmcnt(3)
    v_dot2c_f32_bf16 v160, v2, v72
    v_dot2c_f32_bf16 v161, v3, v72
    v_dot2c_f32_bf16 v162, v2, v73
    v_dot2c_f32_bf16 v163, v3, v73
    v_dot2c_f32_bf16 v164, v4, v74
    v_dot2c_f32_bf16 v165, v5, v74
    v_dot2c_f32_bf16 v166, v4, v75
    v_dot2c_f32_bf16 v167, v5, v75
    s_nop 2
    v_cvt_pk_bf16_f32 v240, v160, v161
    v_cvt_pk_bf16_f32 v241, v162, v163
    buffer_store_dwordx2 v[240:241], v21, s[64:67], 0 offen offset:0
    v_cvt_pk_bf16_f32 v242, v164, v165
    v_cvt_pk_bf16_f32 v243, v166, v167
    buffer_store_dwordx2 v[242:243], v21, s[64:67], s36 offen offset:0
    s_waitcnt vmcnt(4)
    v_dot2c_f32_bf16 v176, v2, v76
    v_dot2c_f32_bf16 v177, v3, v76
    v_dot2c_f32_bf16 v178, v2, v77
    v_dot2c_f32_bf16 v179, v3, v77
    v_dot2c_f32_bf16 v180, v4, v78
    v_dot2c_f32_bf16 v181, v5, v78
    v_dot2c_f32_bf16 v182, v4, v79
    v_dot2c_f32_bf16 v183, v5, v79
    s_waitcnt vmcnt(3)
    v_dot2c_f32_bf16 v176, v2, v80
    v_dot2c_f32_bf16 v177, v3, v80
    v_dot2c_f32_bf16 v178, v2, v81
    v_dot2c_f32_bf16 v179, v3, v81
    v_dot2c_f32_bf16 v180, v4, v82
    v_dot2c_f32_bf16 v181, v5, v82
    v_dot2c_f32_bf16 v182, v4, v83
    v_dot2c_f32_bf16 v183, v5, v83
    s_waitcnt vmcnt(2)
    v_dot2c_f32_bf16 v176, v2, v84
    v_dot2c_f32_bf16 v177, v3, v84
    v_dot2c_f32_bf16 v178, v2, v85
    v_dot2c_f32_bf16 v179, v3, v85
    v_dot2c_f32_bf16 v180, v4, v86
    v_dot2c_f32_bf16 v181, v5, v86
    v_dot2c_f32_bf16 v182, v4, v87
    v_dot2c_f32_bf16 v183, v5, v87
    s_nop 2
    v_cvt_pk_bf16_f32 v244, v176, v177
    v_cvt_pk_bf16_f32 v245, v178, v179
    buffer_store_dwordx2 v[244:245], v21, s[64:67], 0 offen offset:32
    v_cvt_pk_bf16_f32 v246, v180, v181
    v_cvt_pk_bf16_f32 v247, v182, v183
    buffer_store_dwordx2 v[246:247], v21, s[64:67], s36 offen offset:32
    s_cbranch_scc0 nx_32
    v_cvt_pk_bf16_f32 v248, v192, v193
    v_cvt_pk_bf16_f32 v249, v194, v195
    buffer_store_dwordx2 v[248:249], v24, s[64:67], 0 offen
    v_cvt_pk_bf16_f32 v250, v196, v197
    v_cvt_pk_bf16_f32 v251, v198, v199
    buffer_store_dwordx2 v[250:251], v24, s[64:67], s36 offen
nx_32:
    s_nop 2
kf_kernel_end:
    s_endpgm
dbs_6:
    s_mov_b32 s98, 0
sp_33:
    buffer_load_dword v62, off, s[44:47], 0 sc1
    s_add_u32 s98, s98, 1
    s_waitcnt vmcnt(0)
    v_cmp_eq_u32 vcc, 0, v62
    s_cmp_gt_u32 s98, 0x20000
    s_cbranch_scc1 spx_34
    s_cbranch_vccz spx_34
    s_sleep 2
    s_branch sp_33
spx_34:
    s_branch dbr_7
wxs_8:
    s_mov_b32 s98, 0
sp_35:
    buffer_load_dwordx2 v[54:55], v61, s[32:35], 0 offen sc1
    s_add_u32 s98, s98, 1
    s_waitcnt vmcnt(0)
    v_cmp_ne_u64 vcc, v[62:63], v[54:55]
    s_cmp_gt_u32 s98, 0x20000
    s_cbranch_scc1 spx_36
    s_cbranch_vccz spx_36
    s_sleep 2
    s_branch sp_35
spx_36:
    s_branch wxr_9
ups_10:
    s_mov_b32 s98, 0
sp_37:
    buffer_load_dwordx2 v[54:55], v53, s[32:35], 0 offen sc1
    s_add_u32 s98, s98, 1
    s_waitcnt vmcnt(0)
    v_cmp_ne_u64 vcc, v[62:63], v[54:55]
    s_cmp_gt_u32 s98, 0x20000
    s_cbranch_scc1 spx_38
    s_cbranch_vccz spx_38
    s_sleep 2
    s_branch sp_37
spx_38:
    s_branch upr_11
fas_15:
    s_mov_b32 s98, 0
sp_39:
    buffer_load_dwordx2 v[54:55], v61, s[32:35], s86 offen sc1
    s_add_u32 s98, s98, 1
    s_waitcnt vmcnt(0)
    v_cmp_ne_u64 vcc, v[62:63], v[54:55]
    s_cmp_gt_u32 s98, 0x20000
    s_cbranch_scc1 spx_40
    s_cbranch_vccz spx_40
    s_sleep 2
    s_branch sp_39
spx_40:
    s_branch far_16
fas_17:
    s_mov_b32 s98, 0
sp_41:
    buffer_load_dwordx2 v[54:55], v61, s[32:35], s86 offen sc1
    s_add_u32 s98, s98, 1
    s_waitcnt vmcnt(0)
    v_cmp_ne_u64 vcc, v[62:63], v[54:55]
    s_cmp_gt_u32 s98, 0x20000
    s_cbranch_scc1 spx_42
    s_cbranch_vccz spx_42
    s_sleep 2
    s_branch sp_41
spx_42:
    s_branch far_18
fbs_24:
    s_mov_b32 s98, 0
sp_43:
    buffer_load_dwordx2 v[54:55], v61, s[32:35], s86 offen sc1
    s_add_u32 s98, s98, 1
    s_waitcnt vmcnt(0)
    v_cmp_ne_u64 vcc, v[62:63], v[54:55]
    s_cmp_gt_u32 s98, 0x20000
    s_cbranch_scc1 spx_44
    s_cbranch_vccz spx_44
    s_sleep 2
    s_branch sp_43
spx_44:
    s_branch fbr_25
eps_26:
    s_mov_b32 s98, 0
sp_45:
    buffer_load_dwordx2 v[54:55], v15, s[32:35], 0 offen sc1
    s_add_u32 s98, s98, 1
    s_waitcnt vmcnt(0)
    v_cmp_ne_u64 vcc, v[62:63], v[54:55]
    s_cmp_gt_u32 s98, 0x20000
    s_cbranch_scc1 spx_46
    s_cbranch_vccz spx_46
    s_sleep 2
    s_branch sp_45
spx_46:
    s_branch epr_27
cp_end:
.section .rodata,"a"
.p2align 6
.amdhsa_kernel kf_kernel
  .amdhsa_next_free_vgpr 512
  .amdhsa_next_free_sgpr 102
  .amdhsa_accum_offset 256
  .amdhsa_group_segment_fixed_size 0
  .amdhsa_kernarg_size 136
  .amdhsa_user_sgpr_count 2
  .amdhsa_user_sgpr_kernarg_segment_ptr 1
  .amdhsa_system_sgpr_workgroup_id_x 1
  .amdhsa_float_denorm_mode_32 3
.end_amdhsa_kernel
```
